```python
import torch

def _softmax(x, axis=-1):
    return torch.softmax(x, dim=axis)
def _gelu(x):
    return torch.nn.functional.gelu(x, approximate="tanh")
def _silu(x):
    return torch.nn.functional.silu(x)
def _sigmoid(x):
    return torch.sigmoid(x)
def _layernorm(x, axis=-1, eps=1e-5):
    m = x.mean(dim=axis, keepdim=True)
    v = x.var(dim=axis, keepdim=True, unbiased=False)
    return (x - m) / torch.sqrt(v + eps)
def _scatter_add(tgt, idx, src, axis=0):
    return tgt.clone().index_add_(axis, idx, src)
def _segment_sum(src, seg, n):
    out = torch.zeros((n,) + src.shape[1:], dtype=src.dtype)
    return out.index_add_(0, seg, src)
def _pad(x, pw):
    flat = tuple(v for pair in reversed(pw) for v in pair)
    return torch.nn.functional.pad(x, flat)

kernel_name = 'gated_mix__softmax_full_mha__geglu_ffn__prompt'

def setup_inputs():

    _w = (lambda a: (lambda t: t.to(torch.bfloat16) if t.is_floating_point() else t)(torch.as_tensor(a)))
    def _A_setup():
        B, S, D = 1, 2048, 576
        return {
            "x": _w((lambda *s: torch.randn(*s, dtype=torch.bfloat16) * 0.05)(B, S, D)),
            "wqkv": _w((lambda *s: torch.randn(*s, dtype=torch.bfloat16) * 0.8)(D, 3 * D)),
            "wo": _w((lambda *s: torch.randn(*s, dtype=torch.bfloat16) * 0.05)(D, D)),
        }
    _A_in = _A_setup()

    def _B_setup():
        B, S, D, F = 1, 2048, 576, 4608
        return {
            "x": _w((lambda *s: torch.randn(*s, dtype=torch.bfloat16) * 0.05)(B, S, D)),
            "w_gate": _w((lambda *s: torch.randn(*s, dtype=torch.bfloat16) * 0.1)(D, F)),
            "w_up": _w((lambda *s: torch.randn(*s, dtype=torch.bfloat16) * 0.1)(D, F)),
            "w_down": _w((lambda *s: torch.randn(*s, dtype=torch.bfloat16) * 0.1)(F, D)),
        }
    _B_in = _B_setup()

    return {
        "A_x": _A_in["x"],
        "A_wqkv": _A_in["wqkv"],
        "A_wo": _A_in["wo"],
        "B_x": _B_in["x"],
        "B_w_gate": _B_in["w_gate"],
        "B_w_up": _B_in["w_up"],
        "B_w_down": _B_in["w_down"],
        "gate_w": _w((lambda *s: torch.randn(*s, dtype=torch.bfloat16) * 0.05)(576) * 16.0),
    }

def reference(A_x, A_wqkv, A_wo, B_x, B_w_gate, B_w_up, B_w_down, gate_w):
    def _A_ref(x, wqkv, wo):
        B, S, D = x.shape
        H = 32; Dh = D // H
        qkv = (lambda x, *d: x.permute(*d))((x @ wqkv).reshape(B, S, 3, H, Dh), 2, 0, 3, 1, 4)
        q, k, v = qkv[0], qkv[1], qkv[2]
        scale = Dh ** -0.5
        scores = torch.einsum("bhqd,bhkd->bhqk", q, k) * scale
        p = _softmax(scores, axis=-1)
        o = torch.einsum("bhqk,bhkd->bhqd", p, v)
        return (lambda x, *d: x.permute(*d))(o, 0, 2, 1, 3).reshape(B, S, D) @ wo

    def _B_ref(x, w_gate, w_up, w_down):
        return (_gelu(x @ w_gate) * (x @ w_up)) @ w_down

    x = A_x
    g = _sigmoid((x * gate_w).sum(-1, keepdims=True))
    a = _A_ref(x, A_wqkv, A_wo)
    b = _B_ref(x, B_w_gate, B_w_up, B_w_down)
    return g * a + (1 - g) * b
```

```asm
; @launch grid=(256,1,1) block=(512,1,1) lds=163840
.amdgcn_target "amdgcn-amd-amdhsa--gfx950"
.text
.globl gated_mix__softmax_full_mha__geglu_ffn__prompt_kernel
.p2align 8
.type gated_mix__softmax_full_mha__geglu_ffn__prompt_kernel,@function
gated_mix__softmax_full_mha__geglu_ffn__prompt_kernel:
  s_cmp_ge_u32 s2, 256
  s_cbranch_scc1 gated_mix__softmax_full_mha__geglu_ffn__prompt_kernel_end
  s_load_dwordx16 s[4:19], s[0:1], 0
  s_load_dwordx4 s[20:23], s[0:1], 64
  s_load_dwordx2 s[24:25], s[0:1], 80
  v_lshrrev_b32 v1, 6, v0
  v_and_b32 v0, 63, v0
  s_and_b32 s57, s2, 7
  v_readfirstlane_b32 s56, v1
  s_lshr_b32 s63, s2, 3
  s_and_b32 s58, s63, 3
  s_lshr_b32 s59, s63, 2
  s_getpc_b64 s[26:27]
gated_mix__softmax_full_mha__geglu_ffn__prompt_kernel_pc:
  s_lshl_b32 s63, s63, 3
  s_add_u32 s63, s63, s56
  s_lshl_b32 s63, s63, 8
  v_and_b32 v8, 1, v0
  v_lshlrev_b32 v8, 7, v8
  v_add_u32 v8, s63, v8
  v_min_u32 v8, all_code_end-gated_mix__softmax_full_mha__geglu_ffn__prompt_kernel_pc-4, v8
  s_mov_b32 m0, 163584
  s_lshl_b32 s60, s57, 2
  global_load_lds_dword v8, s[26:27]
  s_add_u32 s60, s60, s58
  s_lshl_b32 s79, s59, 3
  s_add_u32 s79, s79, s56
  s_mul_i32 s62, s79, 36864
  s_lshl_b32 s85, s56, 10
  s_lshl_b32 s78, s56, 12
  s_add_u32 s78, s78, 16384
  s_mul_i32 s69, s57, 1152
  s_add_u32 s69, s69, 1024
  s_lshl_b32 s63, s58, 5
  s_add_u32 s69, s69, s63
  s_mul_i32 s70, s60, 108
  v_lshrrev_b32 v8, 3, v0
  v_lshrrev_b32 v9, 4, v0
  v_xor_b32 v9, v9, v0
  v_and_b32 v9, 7, v9
  v_mul_u32_u24 v10, 1152, v8
  v_lshl_add_u32 v5, v9, 4, v10
  v_xor_b32 v9, 4, v9
  v_add_u32 v10, 9216, v10
  v_lshl_add_u32 v6, v9, 4, v10
  s_and_b32 s64, s56, 1
  s_lshl_b32 s63, s64, 1
  v_bfe_u32 v13, v0, 4, 1
  v_or_b32 v13, s63, v13
  v_bfe_u32 v14, v0, 1, 2
  v_xor_b32 v13, v13, v14
  v_lshlrev_b32 v13, 5, v13
  v_and_b32 v14, 1, v0
  v_lshl_add_u32 v13, v14, 4, v13
  s_lshl_b32 s63, s56, 3
  v_add_u32 v14, s63, v8
  v_mul_u32_u24 v15, 3456, v14
  v_add_u32 v15, v13, v15
  v_cmp_eq_u32 vcc, 112, v13
  v_mov_b32 v16, 2147483648
  s_nop 0
  v_cndmask_b32 v3, v15, v16, vcc
  v_lshrrev_b32 v8, 1, v0
  v_and_b32 v9, 0x13, v8
  v_bfe_u32 v10, v8, 2, 1
  v_lshl_or_b32 v9, v10, 3, v9
  v_bfe_u32 v10, v8, 3, 1
  v_lshl_or_b32 v9, v10, 2, v9
  s_lshl_b32 s63, s64, 5
  v_add_u32 v9, s63, v9
  v_mul_u32_u24 v9, 9216, v9
  v_and_b32 v10, 1, v0
  v_lshl_add_u32 v96, v10, 4, v9
  s_lshr_b32 s63, s56, 2
  s_lshl_b32 s71, s63, 11
  s_lshl_b32 s64, s64, 10
  s_add_u32 s71, s71, s64
  s_bitcmp1_b32 s56, 1
  s_cselect_b32 s71, 4096, s71
  s_mul_i32 s84, s59, 1
  s_mul_i32 s63, s58, 2
  s_add_u32 s84, s84, s63
  s_mul_i32 s63, s57, 1
  s_add_u32 s84, s84, s63
  s_mul_i32 s63, s84, 57
  s_lshr_b32 s63, s63, 9
  s_mul_i32 s63, s63, 9
  s_sub_u32 s84, s84, s63
  s_mul_i32 s97, s84, 128
  s_add_u32 s62, s62, s97
  s_sub_u32 s97, s62, 1152
  s_mul_i32 s98, s84, 221184
  s_add_u32 s70, s70, s98
  s_sub_u32 s98, s70, 1990656
  s_mul_i32 s3, s84, 589824
  s_add_u32 s69, s69, s3
  s_sub_u32 s3, s69, 5308416
  s_waitcnt lgkmcnt(0)
  s_mov_b32 s28, s4
  s_and_b32 s29, s5, 0xffff
  s_mov_b32 s30, 2359296
  s_mov_b32 s31, 0x00020000
  s_mov_b32 s40, s6
  s_and_b32 s41, s7, 0xffff
  s_mov_b32 s42, 1990656
  s_mov_b32 s43, 0x00020000
  s_mov_b32 s32, s12
  s_and_b32 s33, s13, 0xffff
  s_mov_b32 s34, 5308416
  s_mov_b32 s35, 0x00020000
  s_mov_b32 s36, s14
  s_and_b32 s37, s15, 0xffff
  s_mov_b32 s38, 5308416
  s_mov_b32 s39, 0x00020000
  s_cmp_ge_u32 s56, 4
  s_cselect_b32 s12, s36, s32
  s_cselect_b32 s13, s37, s33
  s_bitcmp1_b32 s56, 1
  s_cselect_b32 s14, 0, s34
  s_mov_b32 s15, 0x00020000
  s_cmp_ge_u32 s84, 9
  s_cselect_b32 s63, s3, s69
  s_add_u32 m0, s71, 0
  s_add_u32 s63, s63, 0
  buffer_load_dwordx4 v96, s[12:15], s63 offen lds
  s_cmp_ge_u32 s84, 9
  s_cselect_b32 s63, s98, s70
  s_add_u32 m0, s85, 8192
  s_add_u32 s63, s63, 0
  buffer_load_dwordx4 v3, s[40:43], s63 offen lds
  s_cmp_ge_u32 s84, 9
  s_cselect_b32 s63, s97, s62
  s_add_u32 m0, s78, 0
  s_add_u32 s63, s63, 0
  buffer_load_dwordx4 v5, s[28:31], s63 offen lds
  s_cmp_ge_u32 s84, 9
  s_cselect_b32 s63, s97, s62
  s_add_u32 m0, s78, 1024
  s_add_u32 s63, s63, 0
  buffer_load_dwordx4 v6, s[28:31], s63 offen lds
  s_cmp_ge_u32 s84, 9
  s_cselect_b32 s63, s97, s62
  s_add_u32 m0, s78, 2048
  s_add_u32 s63, s63, 18432
  buffer_load_dwordx4 v5, s[28:31], s63 offen lds
  s_cmp_ge_u32 s84, 9
  s_cselect_b32 s63, s97, s62
  s_add_u32 m0, s78, 3072
  s_add_u32 s63, s63, 18432
  buffer_load_dwordx4 v6, s[28:31], s63 offen lds
  s_add_u32 s10, s24, 45219840
  s_addc_u32 s11, s25, 0
  s_load_dword s0, s[10:11], 0
  v_mul_u32_u24 v15, 9216, v14
  v_add_u32 v2, v13, v15
  v_lshrrev_b32 v12, 4, v0
  v_bfe_u32 v13, v0, 2, 2
  v_lshl_add_u32 v14, v12, 3, v13
  v_lshlrev_b32 v14, 7, v14
  v_bfe_u32 v15, v0, 3, 2
  v_lshl_add_u32 v14, v15, 5, v14
  v_and_b32 v15, 3, v0
  v_lshl_add_u32 v1, v15, 3, v14
  v_lshrrev_b32 v9, 5, v0
  v_lshl_add_u32 v9, v9, 4, v13
  v_bfe_u32 v10, v0, 4, 1
  v_lshl_add_u32 v9, v10, 2, v9
  v_lshlrev_b32 v9, 5, v9
  v_lshl_add_u32 v97, v15, 3, v9
  s_cmp_ge_u32 s84, 8
  s_cselect_b32 s63, s3, s69
  s_add_u32 m0, s71, 49152
  s_add_u32 s63, s63, 589824
  buffer_load_dwordx4 v96, s[12:15], s63 offen lds
  v_lshrrev_b32 v14, 5, v0
  v_lshlrev_b32 v14, 12, v14
  v_lshl_add_u32 v14, v10, 9, v14
  v_and_b32 v15, 15, v0
  v_lshl_add_u32 v4, v15, 4, v14
  v_bfe_u32 v14, v0, 1, 3
  v_xor_b32 v14, v14, v12
  v_lshlrev_b32 v14, 4, v14
  v_lshl_add_u32 v14, v15, 7, v14
  v_add_u32 v7, s78, v14
  s_cmp_ge_u32 s84, 8
  s_cselect_b32 s63, s98, s70
  s_add_u32 m0, s85, 57344
  s_add_u32 s63, s63, 221184
  buffer_load_dwordx4 v3, s[40:43], s63 offen lds
  s_mov_b32 s44, s24
  s_and_b32 s45, s25, 0xffff
  s_mov_b32 s46, 45219968
  s_mov_b32 s47, 0x00020000
  s_mov_b32 s52, s18
  s_and_b32 s53, s19, 0xffff
  s_mov_b32 s54, 1152
  s_mov_b32 s55, 0x00020000
  s_mov_b32 s48, s22
  s_and_b32 s49, s23, 0xffff
  s_mov_b32 s50, 256
  s_mov_b32 s51, 0x00020000
  s_lshl_b32 s99, s2, 9
  s_add_u32 s99, s99, 45088768
  s_cmp_ge_u32 s84, 8
  s_cselect_b32 s63, s97, s62
  s_add_u32 m0, s78, 49152
  s_add_u32 s63, s63, 128
  buffer_load_dwordx4 v5, s[28:31], s63 offen lds
  s_mul_i32 s61, s57, 9
  s_lshl_b32 s64, s58, 1
  s_add_u32 s61, s61, s64
  s_lshl_b32 s67, s61, 7
  s_lshr_b32 s68, s79, 2
  s_mul_i32 s68, s68, 1179648
  s_and_b32 s64, s79, 3
  s_lshl_b32 s64, s64, 10
  s_add_u32 s68, s68, s64
  s_mov_b32 s76, 1102244143
  s_mov_b32 s77, 3184710632
  s_lshl_b32 s65, s59, 8
  s_lshl_b32 s64, s60, 3
  s_add_u32 s65, s65, s64
  s_add_u32 s80, s65, s56
  s_mul_i32 s96, s84, 589824
  s_add_u32 s67, s67, s96
  s_sub_u32 s96, s67, 5308416
  s_cmp_ge_u32 s84, 8
  s_cselect_b32 s63, s97, s62
  s_add_u32 m0, s78, 50176
  s_add_u32 s63, s63, 128
  buffer_load_dwordx4 v6, s[28:31], s63 offen lds
  s_mul_i32 s64, s60, 3
  s_cmp_lt_u32 s64, 32
  s_cselect_b32 s93, 1051597459, 1.0
  s_cmp_lt_u32 s64, 31
  s_cselect_b32 s94, 1051597459, 1.0
  s_cmp_lt_u32 s64, 30
  s_cselect_b32 s95, 1051597459, 1.0
  s_lshl_b32 s82, s60, 6
  s_add_u32 s82, s82, s79
  s_lshl_b32 s82, s82, 12
  s_add_u32 s82, s82, 24846336
  s_mul_i32 s83, s57, 36
  s_add_u32 s83, s83, 32
  s_add_u32 s83, s83, s58
  s_lshl_b32 s83, s83, 12
  s_add_u32 s83, s83, s68
  s_lshl_b32 s66, s61, 14
  s_add_u32 s68, s68, s66
  s_cmp_ge_u32 s84, 8
  s_cselect_b32 s63, s97, s62
  s_add_u32 m0, s78, 51200
  s_add_u32 s63, s63, 18560
  buffer_load_dwordx4 v5, s[28:31], s63 offen lds
  v_add_u32 v22, 0, v1
  v_add_u32 v99, 0, v7
  v_xor_b32 v100, 64, v99
  v_add_u32 v98, 0, v97
  s_cmp_ge_u32 s84, 8
  s_cselect_b32 s63, s97, s62
  s_add_u32 m0, s78, 52224
  s_add_u32 s63, s63, 18560
  buffer_load_dwordx4 v6, s[28:31], s63 offen lds
  s_waitcnt vmcnt(6)
  s_waitcnt lgkmcnt(0)
  s_add_u32 s0, s0, 1
  s_barrier
  s_cmp_ge_u32 s56, 4
  s_cbranch_scc0 gated_mix__softmax_full_mha__geglu_ffn__prompt_kernel_l1
  s_cmp_ge_u32 s84, 7
  s_cselect_b32 s63, s3, s69
  s_add_u32 m0, s71, 98304
  s_add_u32 s63, s63, 1179648
  buffer_load_dwordx4 v96, s[12:15], s63 offen lds
  s_cmp_ge_u32 s84, 7
  s_cselect_b32 s63, s98, s70
  s_add_u32 m0, s85, 106496
  s_add_u32 s63, s63, 442368
  buffer_load_dwordx4 v3, s[40:43], s63 offen lds
  s_cmp_ge_u32 s84, 7
  s_cselect_b32 s63, s97, s62
  s_add_u32 m0, s78, 98304
  s_add_u32 s63, s63, 256
  buffer_load_dwordx4 v5, s[28:31], s63 offen lds
  s_cmp_ge_u32 s84, 7
  s_cselect_b32 s63, s97, s62
  s_add_u32 m0, s78, 99328
  s_add_u32 s63, s63, 256
  buffer_load_dwordx4 v6, s[28:31], s63 offen lds
  s_cmp_ge_u32 s84, 7
  s_cselect_b32 s63, s97, s62
  s_add_u32 m0, s78, 100352
  s_add_u32 s63, s63, 18688
  buffer_load_dwordx4 v5, s[28:31], s63 offen lds
  s_cmp_ge_u32 s84, 7
  s_cselect_b32 s63, s97, s62
  s_add_u32 m0, s78, 101376
  s_add_u32 s63, s63, 18688
  buffer_load_dwordx4 v6, s[28:31], s63 offen lds
gated_mix__softmax_full_mha__geglu_ffn__prompt_kernel_l1:
  ds_read_b64_tr_b16 v[24:25], v98 offset:0
  ds_read_b64_tr_b16 v[26:27], v98 offset:256
  ds_read_b128 v[112:115], v99 offset:0
  ds_read_b64_tr_b16 v[28:29], v98 offset:1024
  ds_read_b64_tr_b16 v[30:31], v98 offset:1280
  ds_read_b128 v[120:123], v100 offset:0
  ds_read_b128 v[116:119], v99 offset:2048
  ds_read_b128 v[124:127], v100 offset:2048
  ds_read_b64_tr_b16 v[32:33], v98 offset:2048
  ds_read_b64_tr_b16 v[34:35], v98 offset:2304
  ds_read_b64_tr_b16 v[36:37], v98 offset:3072
  ds_read_b64_tr_b16 v[38:39], v98 offset:3328
  v_xor_b32 v21, 0, v22
  ds_read_b64_tr_b16 v[40:41], v21 offset:8192
  s_waitcnt lgkmcnt(10)
  v_mfma_f32_16x16x32_bf16 v[48:51], v[24:27], v[112:115], 0
  ds_read_b64_tr_b16 v[42:43], v21 offset:8704
  s_waitcnt lgkmcnt(8)
  v_mfma_f32_16x16x32_bf16 v[48:51], v[28:31], v[120:123], v[48:51]
  ds_read_b64_tr_b16 v[44:45], v21 offset:12288
  s_waitcnt lgkmcnt(8)
  v_mfma_f32_16x16x32_bf16 v[52:55], v[24:27], v[116:119], 0
  ds_read_b64_tr_b16 v[46:47], v21 offset:12800
  s_waitcnt lgkmcnt(8)
  v_mfma_f32_16x16x32_bf16 v[52:55], v[28:31], v[124:127], v[52:55]
  v_xor_b32 v20, 32, v22
  ds_read_b64_tr_b16 v[24:25], v20 offset:8192
  s_waitcnt lgkmcnt(7)
  v_mfma_f32_16x16x32_bf16 v[56:59], v[32:35], v[112:115], 0
  ds_read_b64_tr_b16 v[26:27], v20 offset:8704
  s_waitcnt lgkmcnt(6)
  v_mfma_f32_16x16x32_bf16 v[56:59], v[36:39], v[120:123], v[56:59]
  ds_read_b64_tr_b16 v[28:29], v20 offset:12288
  v_mfma_f32_16x16x32_bf16 v[60:63], v[32:35], v[116:119], 0
  ds_read_b64_tr_b16 v[30:31], v20 offset:12800
  v_mfma_f32_16x16x32_bf16 v[60:63], v[36:39], v[124:127], v[60:63]
  v_xor_b32 v21, 64, v22
  ds_read_b64_tr_b16 v[32:33], v21 offset:8192
  s_waitcnt lgkmcnt(7)
  v_mfma_f32_16x16x32_bf16 v[64:67], v[112:115], v[40:43], 0
  ds_read_b64_tr_b16 v[34:35], v21 offset:8704
  s_waitcnt lgkmcnt(6)
  v_mfma_f32_16x16x32_bf16 v[64:67], v[120:123], v[44:47], v[64:67]
  ds_read_b64_tr_b16 v[36:37], v21 offset:12288
  v_mfma_f32_16x16x32_bf16 v[68:71], v[116:119], v[40:43], 0
  ds_read_b64_tr_b16 v[38:39], v21 offset:12800
  v_mfma_f32_16x16x32_bf16 v[68:71], v[124:127], v[44:47], v[68:71]
  v_xor_b32 v20, 96, v22
  ds_read_b64_tr_b16 v[40:41], v20 offset:8192
  s_waitcnt lgkmcnt(7)
  v_mfma_f32_16x16x32_bf16 v[72:75], v[112:115], v[24:27], 0
  ds_read_b64_tr_b16 v[42:43], v20 offset:8704
  s_waitcnt lgkmcnt(6)
  v_mfma_f32_16x16x32_bf16 v[72:75], v[120:123], v[28:31], v[72:75]
  ds_read_b64_tr_b16 v[44:45], v20 offset:12288
  v_mfma_f32_16x16x32_bf16 v[76:79], v[116:119], v[24:27], 0
  ds_read_b64_tr_b16 v[46:47], v20 offset:12800
  s_cmp_lt_u32 s56, 4
  s_cbranch_scc1 gated_mix__softmax_full_mha__geglu_ffn__prompt_kernel_l2
  v_mfma_f32_16x16x32_bf16 v[76:79], v[124:127], v[28:31], v[76:79]
  s_waitcnt lgkmcnt(6)
  v_mfma_f32_16x16x32_bf16 v[80:83], v[112:115], v[32:35], 0
  s_waitcnt lgkmcnt(4)
  v_mfma_f32_16x16x32_bf16 v[80:83], v[120:123], v[36:39], v[80:83]
  v_mfma_f32_16x16x32_bf16 v[84:87], v[116:119], v[32:35], 0
  v_mfma_f32_16x16x32_bf16 v[84:87], v[124:127], v[36:39], v[84:87]
  s_waitcnt lgkmcnt(2)
  v_mfma_f32_16x16x32_bf16 v[88:91], v[112:115], v[40:43], 0
  s_waitcnt vmcnt(6)
  s_waitcnt lgkmcnt(0)
  s_barrier
  v_mfma_f32_16x16x32_bf16 v[88:91], v[120:123], v[44:47], v[88:91]
  v_mfma_f32_16x16x32_bf16 v[92:95], v[116:119], v[40:43], 0
  v_mfma_f32_16x16x32_bf16 v[92:95], v[124:127], v[44:47], v[92:95]
  s_cmp_ge_u32 s84, 6
  s_cselect_b32 s63, s3, s69
  s_add_u32 m0, s71, 0
  s_add_u32 s63, s63, 1769472
  buffer_load_dwordx4 v96, s[12:15], s63 offen lds
  s_cmp_ge_u32 s84, 6
  s_cselect_b32 s63, s98, s70
  s_add_u32 m0, s85, 8192
  s_add_u32 s63, s63, 663552
  buffer_load_dwordx4 v3, s[40:43], s63 offen lds
  s_cmp_ge_u32 s84, 6
  s_cselect_b32 s63, s97, s62
  s_add_u32 m0, s78, 0
  s_add_u32 s63, s63, 384
  buffer_load_dwordx4 v5, s[28:31], s63 offen lds
  s_cmp_ge_u32 s84, 6
  s_cselect_b32 s63, s97, s62
  s_add_u32 m0, s78, 1024
  s_add_u32 s63, s63, 384
  buffer_load_dwordx4 v6, s[28:31], s63 offen lds
  s_cmp_ge_u32 s84, 6
  s_cselect_b32 s63, s97, s62
  s_add_u32 m0, s78, 2048
  s_add_u32 s63, s63, 18816
  buffer_load_dwordx4 v5, s[28:31], s63 offen lds
  s_cmp_ge_u32 s84, 6
  s_cselect_b32 s63, s97, s62
  s_add_u32 m0, s78, 3072
  s_add_u32 s63, s63, 18816
  buffer_load_dwordx4 v6, s[28:31], s63 offen lds
  v_add_u32 v22, 49152, v1
  v_add_u32 v99, 49152, v7
  v_xor_b32 v100, 64, v99
  v_add_u32 v98, 49152, v97
  ds_read_b64_tr_b16 v[24:25], v98 offset:0
  ds_read_b64_tr_b16 v[26:27], v98 offset:256
  ds_read_b128 v[128:131], v99 offset:0
  ds_read_b64_tr_b16 v[28:29], v98 offset:1024
  ds_read_b64_tr_b16 v[30:31], v98 offset:1280
  ds_read_b128 v[136:139], v100 offset:0
  ds_read_b128 v[132:135], v99 offset:2048
  ds_read_b128 v[140:143], v100 offset:2048
  ds_read_b64_tr_b16 v[32:33], v98 offset:2048
  ds_read_b64_tr_b16 v[34:35], v98 offset:2304
  ds_read_b64_tr_b16 v[36:37], v98 offset:3072
  ds_read_b64_tr_b16 v[38:39], v98 offset:3328
  v_xor_b32 v21, 0, v22
  ds_read_b64_tr_b16 v[40:41], v21 offset:8192
  s_branch gated_mix__softmax_full_mha__geglu_ffn__prompt_kernel_l3
gated_mix__softmax_full_mha__geglu_ffn__prompt_kernel_l2:
  s_cmp_ge_u32 s84, 7
  s_cselect_b32 s63, s3, s69
  s_add_u32 m0, s71, 98304
  s_add_u32 s63, s63, 1179648
  buffer_load_dwordx4 v96, s[12:15], s63 offen lds
  s_cmp_ge_u32 s84, 7
  s_cselect_b32 s63, s98, s70
  s_add_u32 m0, s85, 106496
  s_add_u32 s63, s63, 442368
  buffer_load_dwordx4 v3, s[40:43], s63 offen lds
  s_cmp_ge_u32 s84, 7
  s_cselect_b32 s63, s97, s62
  s_add_u32 m0, s78, 98304
  s_add_u32 s63, s63, 256
  buffer_load_dwordx4 v5, s[28:31], s63 offen lds
  s_cmp_ge_u32 s84, 7
  s_cselect_b32 s63, s97, s62
  s_add_u32 m0, s78, 99328
  s_add_u32 s63, s63, 256
  buffer_load_dwordx4 v6, s[28:31], s63 offen lds
  s_cmp_ge_u32 s84, 7
  s_cselect_b32 s63, s97, s62
  s_add_u32 m0, s78, 100352
  s_add_u32 s63, s63, 18688
  buffer_load_dwordx4 v5, s[28:31], s63 offen lds
  s_cmp_ge_u32 s84, 7
  s_cselect_b32 s63, s97, s62
  s_add_u32 m0, s78, 101376
  s_add_u32 s63, s63, 18688
  buffer_load_dwordx4 v6, s[28:31], s63 offen lds
  v_add_u32 v22, 49152, v1
  v_add_u32 v99, 49152, v7
  v_xor_b32 v100, 64, v99
  v_add_u32 v98, 49152, v97
  s_waitcnt vmcnt(6)
  s_waitcnt lgkmcnt(0)
  s_barrier
  ds_read_b64_tr_b16 v[24:25], v98 offset:0
  ds_read_b64_tr_b16 v[26:27], v98 offset:256
  ds_read_b128 v[128:131], v99 offset:0
  v_mfma_f32_16x16x32_bf16 v[76:79], v[124:127], v[28:31], v[76:79]
  ds_read_b64_tr_b16 v[28:29], v98 offset:1024
  ds_read_b64_tr_b16 v[30:31], v98 offset:1280
  v_mfma_f32_16x16x32_bf16 v[80:83], v[112:115], v[32:35], 0
  ds_read_b128 v[136:139], v100 offset:0
  ds_read_b128 v[132:135], v99 offset:2048
  v_mfma_f32_16x16x32_bf16 v[80:83], v[120:123], v[36:39], v[80:83]
  ds_read_b128 v[140:143], v100 offset:2048
  v_mfma_f32_16x16x32_bf16 v[84:87], v[116:119], v[32:35], 0
  ds_read_b64_tr_b16 v[32:33], v98 offset:2048
  ds_read_b64_tr_b16 v[34:35], v98 offset:2304
  v_mfma_f32_16x16x32_bf16 v[84:87], v[124:127], v[36:39], v[84:87]
  ds_read_b64_tr_b16 v[36:37], v98 offset:3072
  ds_read_b64_tr_b16 v[38:39], v98 offset:3328
  v_mfma_f32_16x16x32_bf16 v[88:91], v[112:115], v[40:43], 0
  v_mfma_f32_16x16x32_bf16 v[88:91], v[120:123], v[44:47], v[88:91]
  v_mfma_f32_16x16x32_bf16 v[92:95], v[116:119], v[40:43], 0
  v_xor_b32 v21, 0, v22
  ds_read_b64_tr_b16 v[40:41], v21 offset:8192
  v_mfma_f32_16x16x32_bf16 v[92:95], v[124:127], v[44:47], v[92:95]
gated_mix__softmax_full_mha__geglu_ffn__prompt_kernel_l3:
  s_waitcnt lgkmcnt(10)
  v_mfma_f32_16x16x32_bf16 v[48:51], v[24:27], v[128:131], v[48:51]
  ds_read_b64_tr_b16 v[42:43], v21 offset:8704
  s_waitcnt lgkmcnt(8)
  v_mfma_f32_16x16x32_bf16 v[48:51], v[28:31], v[136:139], v[48:51]
  ds_read_b64_tr_b16 v[44:45], v21 offset:12288
  s_waitcnt lgkmcnt(8)
  v_mfma_f32_16x16x32_bf16 v[52:55], v[24:27], v[132:135], v[52:55]
  ds_read_b64_tr_b16 v[46:47], v21 offset:12800
  s_waitcnt lgkmcnt(8)
  v_mfma_f32_16x16x32_bf16 v[52:55], v[28:31], v[140:143], v[52:55]
  v_xor_b32 v20, 32, v22
  ds_read_b64_tr_b16 v[24:25], v20 offset:8192
  s_waitcnt lgkmcnt(7)
  v_mfma_f32_16x16x32_bf16 v[56:59], v[32:35], v[128:131], v[56:59]
  ds_read_b64_tr_b16 v[26:27], v20 offset:8704
  s_waitcnt lgkmcnt(6)
  v_mfma_f32_16x16x32_bf16 v[56:59], v[36:39], v[136:139], v[56:59]
  ds_read_b64_tr_b16 v[28:29], v20 offset:12288
  v_mfma_f32_16x16x32_bf16 v[60:63], v[32:35], v[132:135], v[60:63]
  ds_read_b64_tr_b16 v[30:31], v20 offset:12800
  v_mfma_f32_16x16x32_bf16 v[60:63], v[36:39], v[140:143], v[60:63]
  v_xor_b32 v21, 64, v22
  ds_read_b64_tr_b16 v[32:33], v21 offset:8192
  s_waitcnt lgkmcnt(7)
  v_mfma_f32_16x16x32_bf16 v[64:67], v[128:131], v[40:43], v[64:67]
  ds_read_b64_tr_b16 v[34:35], v21 offset:8704
  s_waitcnt lgkmcnt(6)
  v_mfma_f32_16x16x32_bf16 v[64:67], v[136:139], v[44:47], v[64:67]
  ds_read_b64_tr_b16 v[36:37], v21 offset:12288
  v_mfma_f32_16x16x32_bf16 v[68:71], v[132:135], v[40:43], v[68:71]
  ds_read_b64_tr_b16 v[38:39], v21 offset:12800
  v_mfma_f32_16x16x32_bf16 v[68:71], v[140:143], v[44:47], v[68:71]
  v_xor_b32 v20, 96, v22
  ds_read_b64_tr_b16 v[40:41], v20 offset:8192
  s_waitcnt lgkmcnt(7)
  v_mfma_f32_16x16x32_bf16 v[72:75], v[128:131], v[24:27], v[72:75]
  ds_read_b64_tr_b16 v[42:43], v20 offset:8704
  s_waitcnt lgkmcnt(6)
  v_mfma_f32_16x16x32_bf16 v[72:75], v[136:139], v[28:31], v[72:75]
  ds_read_b64_tr_b16 v[44:45], v20 offset:12288
  v_mfma_f32_16x16x32_bf16 v[76:79], v[132:135], v[24:27], v[76:79]
  ds_read_b64_tr_b16 v[46:47], v20 offset:12800
  s_cmp_lt_u32 s56, 4
  s_cbranch_scc1 gated_mix__softmax_full_mha__geglu_ffn__prompt_kernel_l4
  v_mfma_f32_16x16x32_bf16 v[76:79], v[140:143], v[28:31], v[76:79]
  s_waitcnt lgkmcnt(6)
  v_mfma_f32_16x16x32_bf16 v[80:83], v[128:131], v[32:35], v[80:83]
  s_waitcnt lgkmcnt(4)
  v_mfma_f32_16x16x32_bf16 v[80:83], v[136:139], v[36:39], v[80:83]
  v_mfma_f32_16x16x32_bf16 v[84:87], v[132:135], v[32:35], v[84:87]
  v_mfma_f32_16x16x32_bf16 v[84:87], v[140:143], v[36:39], v[84:87]
  s_waitcnt lgkmcnt(2)
  v_mfma_f32_16x16x32_bf16 v[88:91], v[128:131], v[40:43], v[88:91]
  s_waitcnt vmcnt(6)
  s_waitcnt lgkmcnt(0)
  s_barrier
  v_mfma_f32_16x16x32_bf16 v[88:91], v[136:139], v[44:47], v[88:91]
  v_mfma_f32_16x16x32_bf16 v[92:95], v[132:135], v[40:43], v[92:95]
  v_mfma_f32_16x16x32_bf16 v[92:95], v[140:143], v[44:47], v[92:95]
  s_cmp_ge_u32 s84, 5
  s_cselect_b32 s63, s3, s69
  s_add_u32 m0, s71, 49152
  s_add_u32 s63, s63, 2359296
  buffer_load_dwordx4 v96, s[12:15], s63 offen lds
  s_cmp_ge_u32 s84, 5
  s_cselect_b32 s63, s98, s70
  s_add_u32 m0, s85, 57344
  s_add_u32 s63, s63, 884736
  buffer_load_dwordx4 v3, s[40:43], s63 offen lds
  s_cmp_ge_u32 s84, 5
  s_cselect_b32 s63, s97, s62
  s_add_u32 m0, s78, 49152
  s_add_u32 s63, s63, 512
  buffer_load_dwordx4 v5, s[28:31], s63 offen lds
  s_cmp_ge_u32 s84, 5
  s_cselect_b32 s63, s97, s62
  s_add_u32 m0, s78, 50176
  s_add_u32 s63, s63, 512
  buffer_load_dwordx4 v6, s[28:31], s63 offen lds
  s_cmp_ge_u32 s84, 5
  s_cselect_b32 s63, s97, s62
  s_add_u32 m0, s78, 51200
  s_add_u32 s63, s63, 18944
  buffer_load_dwordx4 v5, s[28:31], s63 offen lds
  s_cmp_ge_u32 s84, 5
  s_cselect_b32 s63, s97, s62
  s_add_u32 m0, s78, 52224
  s_add_u32 s63, s63, 18944
  buffer_load_dwordx4 v6, s[28:31], s63 offen lds
  v_add_u32 v22, 98304, v1
  v_add_u32 v99, 98304, v7
  v_xor_b32 v100, 64, v99
  v_add_u32 v98, 98304, v97
  ds_read_b64_tr_b16 v[24:25], v98 offset:0
  ds_read_b64_tr_b16 v[26:27], v98 offset:256
  ds_read_b128 v[144:147], v99 offset:0
  ds_read_b64_tr_b16 v[28:29], v98 offset:1024
  ds_read_b64_tr_b16 v[30:31], v98 offset:1280
  ds_read_b128 v[152:155], v100 offset:0
  ds_read_b128 v[148:151], v99 offset:2048
  ds_read_b128 v[156:159], v100 offset:2048
  ds_read_b64_tr_b16 v[32:33], v98 offset:2048
  ds_read_b64_tr_b16 v[34:35], v98 offset:2304
  ds_read_b64_tr_b16 v[36:37], v98 offset:3072
  ds_read_b64_tr_b16 v[38:39], v98 offset:3328
  v_xor_b32 v21, 0, v22
  ds_read_b64_tr_b16 v[40:41], v21 offset:8192
  s_branch gated_mix__softmax_full_mha__geglu_ffn__prompt_kernel_l5
gated_mix__softmax_full_mha__geglu_ffn__prompt_kernel_l4:
  s_cmp_ge_u32 s84, 6
  s_cselect_b32 s63, s3, s69
  s_add_u32 m0, s71, 0
  s_add_u32 s63, s63, 1769472
  buffer_load_dwordx4 v96, s[12:15], s63 offen lds
  s_cmp_ge_u32 s84, 6
  s_cselect_b32 s63, s98, s70
  s_add_u32 m0, s85, 8192
  s_add_u32 s63, s63, 663552
  buffer_load_dwordx4 v3, s[40:43], s63 offen lds
  s_cmp_ge_u32 s84, 6
  s_cselect_b32 s63, s97, s62
  s_add_u32 m0, s78, 0
  s_add_u32 s63, s63, 384
  buffer_load_dwordx4 v5, s[28:31], s63 offen lds
  s_cmp_ge_u32 s84, 6
  s_cselect_b32 s63, s97, s62
  s_add_u32 m0, s78, 1024
  s_add_u32 s63, s63, 384
  buffer_load_dwordx4 v6, s[28:31], s63 offen lds
  s_cmp_ge_u32 s84, 6
  s_cselect_b32 s63, s97, s62
  s_add_u32 m0, s78, 2048
  s_add_u32 s63, s63, 18816
  buffer_load_dwordx4 v5, s[28:31], s63 offen lds
  s_cmp_ge_u32 s84, 6
  s_cselect_b32 s63, s97, s62
  s_add_u32 m0, s78, 3072
  s_add_u32 s63, s63, 18816
  buffer_load_dwordx4 v6, s[28:31], s63 offen lds
  v_add_u32 v22, 98304, v1
  v_add_u32 v99, 98304, v7
  v_xor_b32 v100, 64, v99
  v_add_u32 v98, 98304, v97
  s_waitcnt vmcnt(6)
  s_waitcnt lgkmcnt(0)
  s_barrier
  ds_read_b64_tr_b16 v[24:25], v98 offset:0
  ds_read_b64_tr_b16 v[26:27], v98 offset:256
  ds_read_b128 v[144:147], v99 offset:0
  v_mfma_f32_16x16x32_bf16 v[76:79], v[140:143], v[28:31], v[76:79]
  ds_read_b64_tr_b16 v[28:29], v98 offset:1024
  ds_read_b64_tr_b16 v[30:31], v98 offset:1280
  v_mfma_f32_16x16x32_bf16 v[80:83], v[128:131], v[32:35], v[80:83]
  ds_read_b128 v[152:155], v100 offset:0
  ds_read_b128 v[148:151], v99 offset:2048
  v_mfma_f32_16x16x32_bf16 v[80:83], v[136:139], v[36:39], v[80:83]
  ds_read_b128 v[156:159], v100 offset:2048
  v_mfma_f32_16x16x32_bf16 v[84:87], v[132:135], v[32:35], v[84:87]
  ds_read_b64_tr_b16 v[32:33], v98 offset:2048
  ds_read_b64_tr_b16 v[34:35], v98 offset:2304
  v_mfma_f32_16x16x32_bf16 v[84:87], v[140:143], v[36:39], v[84:87]
  ds_read_b64_tr_b16 v[36:37], v98 offset:3072
  ds_read_b64_tr_b16 v[38:39], v98 offset:3328
  v_mfma_f32_16x16x32_bf16 v[88:91], v[128:131], v[40:43], v[88:91]
  v_mfma_f32_16x16x32_bf16 v[88:91], v[136:139], v[44:47], v[88:91]
  v_mfma_f32_16x16x32_bf16 v[92:95], v[132:135], v[40:43], v[92:95]
  v_xor_b32 v21, 0, v22
  ds_read_b64_tr_b16 v[40:41], v21 offset:8192
  v_mfma_f32_16x16x32_bf16 v[92:95], v[140:143], v[44:47], v[92:95]
gated_mix__softmax_full_mha__geglu_ffn__prompt_kernel_l5:
  s_waitcnt lgkmcnt(10)
  v_mfma_f32_16x16x32_bf16 v[48:51], v[24:27], v[144:147], v[48:51]
  ds_read_b64_tr_b16 v[42:43], v21 offset:8704
  s_waitcnt lgkmcnt(8)
  v_mfma_f32_16x16x32_bf16 v[48:51], v[28:31], v[152:155], v[48:51]
  ds_read_b64_tr_b16 v[44:45], v21 offset:12288
  s_waitcnt lgkmcnt(8)
  v_mfma_f32_16x16x32_bf16 v[52:55], v[24:27], v[148:151], v[52:55]
  ds_read_b64_tr_b16 v[46:47], v21 offset:12800
  s_waitcnt lgkmcnt(8)
  v_mfma_f32_16x16x32_bf16 v[52:55], v[28:31], v[156:159], v[52:55]
  v_xor_b32 v20, 32, v22
  ds_read_b64_tr_b16 v[24:25], v20 offset:8192
  s_waitcnt lgkmcnt(7)
  v_mfma_f32_16x16x32_bf16 v[56:59], v[32:35], v[144:147], v[56:59]
  ds_read_b64_tr_b16 v[26:27], v20 offset:8704
  s_waitcnt lgkmcnt(6)
  v_mfma_f32_16x16x32_bf16 v[56:59], v[36:39], v[152:155], v[56:59]
  ds_read_b64_tr_b16 v[28:29], v20 offset:12288
  v_mfma_f32_16x16x32_bf16 v[60:63], v[32:35], v[148:151], v[60:63]
  ds_read_b64_tr_b16 v[30:31], v20 offset:12800
  v_mfma_f32_16x16x32_bf16 v[60:63], v[36:39], v[156:159], v[60:63]
  v_xor_b32 v21, 64, v22
  ds_read_b64_tr_b16 v[32:33], v21 offset:8192
  s_waitcnt lgkmcnt(7)
  v_mfma_f32_16x16x32_bf16 v[64:67], v[144:147], v[40:43], v[64:67]
  ds_read_b64_tr_b16 v[34:35], v21 offset:8704
  s_waitcnt lgkmcnt(6)
  v_mfma_f32_16x16x32_bf16 v[64:67], v[152:155], v[44:47], v[64:67]
  ds_read_b64_tr_b16 v[36:37], v21 offset:12288
  v_mfma_f32_16x16x32_bf16 v[68:71], v[148:151], v[40:43], v[68:71]
  ds_read_b64_tr_b16 v[38:39], v21 offset:12800
  v_mfma_f32_16x16x32_bf16 v[68:71], v[156:159], v[44:47], v[68:71]
  v_xor_b32 v20, 96, v22
  ds_read_b64_tr_b16 v[40:41], v20 offset:8192
  s_waitcnt lgkmcnt(7)
  v_mfma_f32_16x16x32_bf16 v[72:75], v[144:147], v[24:27], v[72:75]
  ds_read_b64_tr_b16 v[42:43], v20 offset:8704
  s_waitcnt lgkmcnt(6)
  v_mfma_f32_16x16x32_bf16 v[72:75], v[152:155], v[28:31], v[72:75]
  ds_read_b64_tr_b16 v[44:45], v20 offset:12288
  v_mfma_f32_16x16x32_bf16 v[76:79], v[148:151], v[24:27], v[76:79]
  ds_read_b64_tr_b16 v[46:47], v20 offset:12800
  s_cmp_lt_u32 s56, 4
  s_cbranch_scc1 gated_mix__softmax_full_mha__geglu_ffn__prompt_kernel_l6
  v_mfma_f32_16x16x32_bf16 v[76:79], v[156:159], v[28:31], v[76:79]
  s_waitcnt lgkmcnt(6)
  v_mfma_f32_16x16x32_bf16 v[80:83], v[144:147], v[32:35], v[80:83]
  s_waitcnt lgkmcnt(4)
  v_mfma_f32_16x16x32_bf16 v[80:83], v[152:155], v[36:39], v[80:83]
  v_mfma_f32_16x16x32_bf16 v[84:87], v[148:151], v[32:35], v[84:87]
  v_mfma_f32_16x16x32_bf16 v[84:87], v[156:159], v[36:39], v[84:87]
  s_waitcnt lgkmcnt(2)
  v_mfma_f32_16x16x32_bf16 v[88:91], v[144:147], v[40:43], v[88:91]
  s_waitcnt vmcnt(6)
  s_waitcnt lgkmcnt(0)
  s_barrier
  v_mfma_f32_16x16x32_bf16 v[88:91], v[152:155], v[44:47], v[88:91]
  v_mfma_f32_16x16x32_bf16 v[92:95], v[148:151], v[40:43], v[92:95]
  v_mfma_f32_16x16x32_bf16 v[92:95], v[156:159], v[44:47], v[92:95]
  s_cmp_ge_u32 s84, 4
  s_cselect_b32 s63, s3, s69
  s_add_u32 m0, s71, 98304
  s_add_u32 s63, s63, 2949120
  buffer_load_dwordx4 v96, s[12:15], s63 offen lds
  s_cmp_ge_u32 s84, 4
  s_cselect_b32 s63, s98, s70
  s_add_u32 m0, s85, 106496
  s_add_u32 s63, s63, 1105920
  buffer_load_dwordx4 v3, s[40:43], s63 offen lds
  s_cmp_ge_u32 s84, 4
  s_cselect_b32 s63, s97, s62
  s_add_u32 m0, s78, 98304
  s_add_u32 s63, s63, 640
  buffer_load_dwordx4 v5, s[28:31], s63 offen lds
  s_cmp_ge_u32 s84, 4
  s_cselect_b32 s63, s97, s62
  s_add_u32 m0, s78, 99328
  s_add_u32 s63, s63, 640
  buffer_load_dwordx4 v6, s[28:31], s63 offen lds
  s_cmp_ge_u32 s84, 4
  s_cselect_b32 s63, s97, s62
  s_add_u32 m0, s78, 100352
  s_add_u32 s63, s63, 19072
  buffer_load_dwordx4 v5, s[28:31], s63 offen lds
  s_cmp_ge_u32 s84, 4
  s_cselect_b32 s63, s97, s62
  s_add_u32 m0, s78, 101376
  s_add_u32 s63, s63, 19072
  buffer_load_dwordx4 v6, s[28:31], s63 offen lds
  v_add_u32 v22, 0, v1
  v_add_u32 v99, 0, v7
  v_xor_b32 v100, 64, v99
  v_add_u32 v98, 0, v97
  ds_read_b64_tr_b16 v[24:25], v98 offset:0
  ds_read_b64_tr_b16 v[26:27], v98 offset:256
  ds_read_b128 v[160:163], v99 offset:0
  ds_read_b64_tr_b16 v[28:29], v98 offset:1024
  ds_read_b64_tr_b16 v[30:31], v98 offset:1280
  ds_read_b128 v[168:171], v100 offset:0
  ds_read_b128 v[164:167], v99 offset:2048
  ds_read_b128 v[172:175], v100 offset:2048
  ds_read_b64_tr_b16 v[32:33], v98 offset:2048
  ds_read_b64_tr_b16 v[34:35], v98 offset:2304
  ds_read_b64_tr_b16 v[36:37], v98 offset:3072
  ds_read_b64_tr_b16 v[38:39], v98 offset:3328
  v_xor_b32 v21, 0, v22
  ds_read_b64_tr_b16 v[40:41], v21 offset:8192
  s_branch gated_mix__softmax_full_mha__geglu_ffn__prompt_kernel_l7
gated_mix__softmax_full_mha__geglu_ffn__prompt_kernel_l6:
  s_cmp_ge_u32 s84, 5
  s_cselect_b32 s63, s3, s69
  s_add_u32 m0, s71, 49152
  s_add_u32 s63, s63, 2359296
  buffer_load_dwordx4 v96, s[12:15], s63 offen lds
  s_cmp_ge_u32 s84, 5
  s_cselect_b32 s63, s98, s70
  s_add_u32 m0, s85, 57344
  s_add_u32 s63, s63, 884736
  buffer_load_dwordx4 v3, s[40:43], s63 offen lds
  s_cmp_ge_u32 s84, 5
  s_cselect_b32 s63, s97, s62
  s_add_u32 m0, s78, 49152
  s_add_u32 s63, s63, 512
  buffer_load_dwordx4 v5, s[28:31], s63 offen lds
  s_cmp_ge_u32 s84, 5
  s_cselect_b32 s63, s97, s62
  s_add_u32 m0, s78, 50176
  s_add_u32 s63, s63, 512
  buffer_load_dwordx4 v6, s[28:31], s63 offen lds
  s_cmp_ge_u32 s84, 5
  s_cselect_b32 s63, s97, s62
  s_add_u32 m0, s78, 51200
  s_add_u32 s63, s63, 18944
  buffer_load_dwordx4 v5, s[28:31], s63 offen lds
  s_cmp_ge_u32 s84, 5
  s_cselect_b32 s63, s97, s62
  s_add_u32 m0, s78, 52224
  s_add_u32 s63, s63, 18944
  buffer_load_dwordx4 v6, s[28:31], s63 offen lds
  v_add_u32 v22, 0, v1
  v_add_u32 v99, 0, v7
  v_xor_b32 v100, 64, v99
  v_add_u32 v98, 0, v97
  s_waitcnt vmcnt(6)
  s_waitcnt lgkmcnt(0)
  s_barrier
  ds_read_b64_tr_b16 v[24:25], v98 offset:0
  ds_read_b64_tr_b16 v[26:27], v98 offset:256
  ds_read_b128 v[160:163], v99 offset:0
  v_mfma_f32_16x16x32_bf16 v[76:79], v[156:159], v[28:31], v[76:79]
  ds_read_b64_tr_b16 v[28:29], v98 offset:1024
  ds_read_b64_tr_b16 v[30:31], v98 offset:1280
  v_mfma_f32_16x16x32_bf16 v[80:83], v[144:147], v[32:35], v[80:83]
  ds_read_b128 v[168:171], v100 offset:0
  ds_read_b128 v[164:167], v99 offset:2048
  v_mfma_f32_16x16x32_bf16 v[80:83], v[152:155], v[36:39], v[80:83]
  ds_read_b128 v[172:175], v100 offset:2048
  v_mfma_f32_16x16x32_bf16 v[84:87], v[148:151], v[32:35], v[84:87]
  ds_read_b64_tr_b16 v[32:33], v98 offset:2048
  ds_read_b64_tr_b16 v[34:35], v98 offset:2304
  v_mfma_f32_16x16x32_bf16 v[84:87], v[156:159], v[36:39], v[84:87]
  ds_read_b64_tr_b16 v[36:37], v98 offset:3072
  ds_read_b64_tr_b16 v[38:39], v98 offset:3328
  v_mfma_f32_16x16x32_bf16 v[88:91], v[144:147], v[40:43], v[88:91]
  v_mfma_f32_16x16x32_bf16 v[88:91], v[152:155], v[44:47], v[88:91]
  v_mfma_f32_16x16x32_bf16 v[92:95], v[148:151], v[40:43], v[92:95]
  v_xor_b32 v21, 0, v22
  ds_read_b64_tr_b16 v[40:41], v21 offset:8192
  v_mfma_f32_16x16x32_bf16 v[92:95], v[156:159], v[44:47], v[92:95]
gated_mix__softmax_full_mha__geglu_ffn__prompt_kernel_l7:
  s_waitcnt lgkmcnt(10)
  v_mfma_f32_16x16x32_bf16 v[48:51], v[24:27], v[160:163], v[48:51]
  ds_read_b64_tr_b16 v[42:43], v21 offset:8704
  s_waitcnt lgkmcnt(8)
  v_mfma_f32_16x16x32_bf16 v[48:51], v[28:31], v[168:171], v[48:51]
  ds_read_b64_tr_b16 v[44:45], v21 offset:12288
  s_waitcnt lgkmcnt(8)
  v_mfma_f32_16x16x32_bf16 v[52:55], v[24:27], v[164:167], v[52:55]
  ds_read_b64_tr_b16 v[46:47], v21 offset:12800
  s_waitcnt lgkmcnt(8)
  v_mfma_f32_16x16x32_bf16 v[52:55], v[28:31], v[172:175], v[52:55]
  v_xor_b32 v20, 32, v22
  ds_read_b64_tr_b16 v[24:25], v20 offset:8192
  s_waitcnt lgkmcnt(7)
  v_mfma_f32_16x16x32_bf16 v[56:59], v[32:35], v[160:163], v[56:59]
  ds_read_b64_tr_b16 v[26:27], v20 offset:8704
  s_waitcnt lgkmcnt(6)
  v_mfma_f32_16x16x32_bf16 v[56:59], v[36:39], v[168:171], v[56:59]
  ds_read_b64_tr_b16 v[28:29], v20 offset:12288
  v_mfma_f32_16x16x32_bf16 v[60:63], v[32:35], v[164:167], v[60:63]
  ds_read_b64_tr_b16 v[30:31], v20 offset:12800
  v_mfma_f32_16x16x32_bf16 v[60:63], v[36:39], v[172:175], v[60:63]
  v_xor_b32 v21, 64, v22
  ds_read_b64_tr_b16 v[32:33], v21 offset:8192
  s_waitcnt lgkmcnt(7)
  v_mfma_f32_16x16x32_bf16 v[64:67], v[160:163], v[40:43], v[64:67]
  ds_read_b64_tr_b16 v[34:35], v21 offset:8704
  s_waitcnt lgkmcnt(6)
  v_mfma_f32_16x16x32_bf16 v[64:67], v[168:171], v[44:47], v[64:67]
  ds_read_b64_tr_b16 v[36:37], v21 offset:12288
  v_mfma_f32_16x16x32_bf16 v[68:71], v[164:167], v[40:43], v[68:71]
  ds_read_b64_tr_b16 v[38:39], v21 offset:12800
  v_mfma_f32_16x16x32_bf16 v[68:71], v[172:175], v[44:47], v[68:71]
  v_xor_b32 v20, 96, v22
  ds_read_b64_tr_b16 v[40:41], v20 offset:8192
  s_waitcnt lgkmcnt(7)
  v_mfma_f32_16x16x32_bf16 v[72:75], v[160:163], v[24:27], v[72:75]
  ds_read_b64_tr_b16 v[42:43], v20 offset:8704
  s_waitcnt lgkmcnt(6)
  v_mfma_f32_16x16x32_bf16 v[72:75], v[168:171], v[28:31], v[72:75]
  ds_read_b64_tr_b16 v[44:45], v20 offset:12288
  v_mfma_f32_16x16x32_bf16 v[76:79], v[164:167], v[24:27], v[76:79]
  ds_read_b64_tr_b16 v[46:47], v20 offset:12800
  s_cmp_lt_u32 s56, 4
  s_cbranch_scc1 gated_mix__softmax_full_mha__geglu_ffn__prompt_kernel_l8
  v_mfma_f32_16x16x32_bf16 v[76:79], v[172:175], v[28:31], v[76:79]
  s_waitcnt lgkmcnt(6)
  v_mfma_f32_16x16x32_bf16 v[80:83], v[160:163], v[32:35], v[80:83]
  s_waitcnt lgkmcnt(4)
  v_mfma_f32_16x16x32_bf16 v[80:83], v[168:171], v[36:39], v[80:83]
  v_mfma_f32_16x16x32_bf16 v[84:87], v[164:167], v[32:35], v[84:87]
  v_mfma_f32_16x16x32_bf16 v[84:87], v[172:175], v[36:39], v[84:87]
  s_waitcnt lgkmcnt(2)
  v_mfma_f32_16x16x32_bf16 v[88:91], v[160:163], v[40:43], v[88:91]
  s_waitcnt vmcnt(6)
  s_waitcnt lgkmcnt(0)
  s_barrier
  v_mfma_f32_16x16x32_bf16 v[88:91], v[168:171], v[44:47], v[88:91]
  v_mfma_f32_16x16x32_bf16 v[92:95], v[164:167], v[40:43], v[92:95]
  v_mfma_f32_16x16x32_bf16 v[92:95], v[172:175], v[44:47], v[92:95]
  s_cmp_ge_u32 s84, 3
  s_cselect_b32 s63, s3, s69
  s_add_u32 m0, s71, 0
  s_add_u32 s63, s63, 3538944
  buffer_load_dwordx4 v96, s[12:15], s63 offen lds
  s_cmp_ge_u32 s84, 3
  s_cselect_b32 s63, s98, s70
  s_add_u32 m0, s85, 8192
  s_add_u32 s63, s63, 1327104
  buffer_load_dwordx4 v3, s[40:43], s63 offen lds
  s_cmp_ge_u32 s84, 3
  s_cselect_b32 s63, s97, s62
  s_add_u32 m0, s78, 0
  s_add_u32 s63, s63, 768
  buffer_load_dwordx4 v5, s[28:31], s63 offen lds
  s_cmp_ge_u32 s84, 3
  s_cselect_b32 s63, s97, s62
  s_add_u32 m0, s78, 1024
  s_add_u32 s63, s63, 768
  buffer_load_dwordx4 v6, s[28:31], s63 offen lds
  s_cmp_ge_u32 s84, 3
  s_cselect_b32 s63, s97, s62
  s_add_u32 m0, s78, 2048
  s_add_u32 s63, s63, 19200
  buffer_load_dwordx4 v5, s[28:31], s63 offen lds
  s_cmp_ge_u32 s84, 3
  s_cselect_b32 s63, s97, s62
  s_add_u32 m0, s78, 3072
  s_add_u32 s63, s63, 19200
  buffer_load_dwordx4 v6, s[28:31], s63 offen lds
  v_add_u32 v22, 49152, v1
  v_add_u32 v99, 49152, v7
  v_xor_b32 v100, 64, v99
  v_add_u32 v98, 49152, v97
  ds_read_b64_tr_b16 v[24:25], v98 offset:0
  ds_read_b64_tr_b16 v[26:27], v98 offset:256
  ds_read_b128 v[176:179], v99 offset:0
  ds_read_b64_tr_b16 v[28:29], v98 offset:1024
  ds_read_b64_tr_b16 v[30:31], v98 offset:1280
  ds_read_b128 v[184:187], v100 offset:0
  ds_read_b128 v[180:183], v99 offset:2048
  ds_read_b128 v[188:191], v100 offset:2048
  ds_read_b64_tr_b16 v[32:33], v98 offset:2048
  ds_read_b64_tr_b16 v[34:35], v98 offset:2304
  ds_read_b64_tr_b16 v[36:37], v98 offset:3072
  ds_read_b64_tr_b16 v[38:39], v98 offset:3328
  v_xor_b32 v21, 0, v22
  ds_read_b64_tr_b16 v[40:41], v21 offset:8192
  s_branch gated_mix__softmax_full_mha__geglu_ffn__prompt_kernel_l9
gated_mix__softmax_full_mha__geglu_ffn__prompt_kernel_l8:
  s_cmp_ge_u32 s84, 4
  s_cselect_b32 s63, s3, s69
  s_add_u32 m0, s71, 98304
  s_add_u32 s63, s63, 2949120
  buffer_load_dwordx4 v96, s[12:15], s63 offen lds
  s_cmp_ge_u32 s84, 4
  s_cselect_b32 s63, s98, s70
  s_add_u32 m0, s85, 106496
  s_add_u32 s63, s63, 1105920
  buffer_load_dwordx4 v3, s[40:43], s63 offen lds
  s_cmp_ge_u32 s84, 4
  s_cselect_b32 s63, s97, s62
  s_add_u32 m0, s78, 98304
  s_add_u32 s63, s63, 640
  buffer_load_dwordx4 v5, s[28:31], s63 offen lds
  s_cmp_ge_u32 s84, 4
  s_cselect_b32 s63, s97, s62
  s_add_u32 m0, s78, 99328
  s_add_u32 s63, s63, 640
  buffer_load_dwordx4 v6, s[28:31], s63 offen lds
  s_cmp_ge_u32 s84, 4
  s_cselect_b32 s63, s97, s62
  s_add_u32 m0, s78, 100352
  s_add_u32 s63, s63, 19072
  buffer_load_dwordx4 v5, s[28:31], s63 offen lds
  s_cmp_ge_u32 s84, 4
  s_cselect_b32 s63, s97, s62
  s_add_u32 m0, s78, 101376
  s_add_u32 s63, s63, 19072
  buffer_load_dwordx4 v6, s[28:31], s63 offen lds
  v_add_u32 v22, 49152, v1
  v_add_u32 v99, 49152, v7
  v_xor_b32 v100, 64, v99
  v_add_u32 v98, 49152, v97
  s_waitcnt vmcnt(6)
  s_waitcnt lgkmcnt(0)
  s_barrier
  ds_read_b64_tr_b16 v[24:25], v98 offset:0
  ds_read_b64_tr_b16 v[26:27], v98 offset:256
  ds_read_b128 v[176:179], v99 offset:0
  v_mfma_f32_16x16x32_bf16 v[76:79], v[172:175], v[28:31], v[76:79]
  ds_read_b64_tr_b16 v[28:29], v98 offset:1024
  ds_read_b64_tr_b16 v[30:31], v98 offset:1280
  v_mfma_f32_16x16x32_bf16 v[80:83], v[160:163], v[32:35], v[80:83]
  ds_read_b128 v[184:187], v100 offset:0
  ds_read_b128 v[180:183], v99 offset:2048
  v_mfma_f32_16x16x32_bf16 v[80:83], v[168:171], v[36:39], v[80:83]
  ds_read_b128 v[188:191], v100 offset:2048
  v_mfma_f32_16x16x32_bf16 v[84:87], v[164:167], v[32:35], v[84:87]
  ds_read_b64_tr_b16 v[32:33], v98 offset:2048
  ds_read_b64_tr_b16 v[34:35], v98 offset:2304
  v_mfma_f32_16x16x32_bf16 v[84:87], v[172:175], v[36:39], v[84:87]
  ds_read_b64_tr_b16 v[36:37], v98 offset:3072
  ds_read_b64_tr_b16 v[38:39], v98 offset:3328
  v_mfma_f32_16x16x32_bf16 v[88:91], v[160:163], v[40:43], v[88:91]
  v_mfma_f32_16x16x32_bf16 v[88:91], v[168:171], v[44:47], v[88:91]
  v_mfma_f32_16x16x32_bf16 v[92:95], v[164:167], v[40:43], v[92:95]
  v_xor_b32 v21, 0, v22
  ds_read_b64_tr_b16 v[40:41], v21 offset:8192
  v_mfma_f32_16x16x32_bf16 v[92:95], v[172:175], v[44:47], v[92:95]
gated_mix__softmax_full_mha__geglu_ffn__prompt_kernel_l9:
  s_waitcnt lgkmcnt(10)
  v_mfma_f32_16x16x32_bf16 v[48:51], v[24:27], v[176:179], v[48:51]
  ds_read_b64_tr_b16 v[42:43], v21 offset:8704
  s_waitcnt lgkmcnt(8)
  v_mfma_f32_16x16x32_bf16 v[48:51], v[28:31], v[184:187], v[48:51]
  ds_read_b64_tr_b16 v[44:45], v21 offset:12288
  s_waitcnt lgkmcnt(8)
  v_mfma_f32_16x16x32_bf16 v[52:55], v[24:27], v[180:183], v[52:55]
  ds_read_b64_tr_b16 v[46:47], v21 offset:12800
  s_waitcnt lgkmcnt(8)
  v_mfma_f32_16x16x32_bf16 v[52:55], v[28:31], v[188:191], v[52:55]
  v_xor_b32 v20, 32, v22
  ds_read_b64_tr_b16 v[24:25], v20 offset:8192
  s_waitcnt lgkmcnt(7)
  v_mfma_f32_16x16x32_bf16 v[56:59], v[32:35], v[176:179], v[56:59]
  ds_read_b64_tr_b16 v[26:27], v20 offset:8704
  s_waitcnt lgkmcnt(6)
  v_mfma_f32_16x16x32_bf16 v[56:59], v[36:39], v[184:187], v[56:59]
  ds_read_b64_tr_b16 v[28:29], v20 offset:12288
  v_mfma_f32_16x16x32_bf16 v[60:63], v[32:35], v[180:183], v[60:63]
  ds_read_b64_tr_b16 v[30:31], v20 offset:12800
  v_mfma_f32_16x16x32_bf16 v[60:63], v[36:39], v[188:191], v[60:63]
  v_xor_b32 v21, 64, v22
  ds_read_b64_tr_b16 v[32:33], v21 offset:8192
  s_waitcnt lgkmcnt(7)
  v_mfma_f32_16x16x32_bf16 v[64:67], v[176:179], v[40:43], v[64:67]
  ds_read_b64_tr_b16 v[34:35], v21 offset:8704
  s_waitcnt lgkmcnt(6)
  v_mfma_f32_16x16x32_bf16 v[64:67], v[184:187], v[44:47], v[64:67]
  ds_read_b64_tr_b16 v[36:37], v21 offset:12288
  v_mfma_f32_16x16x32_bf16 v[68:71], v[180:183], v[40:43], v[68:71]
  ds_read_b64_tr_b16 v[38:39], v21 offset:12800
  v_mfma_f32_16x16x32_bf16 v[68:71], v[188:191], v[44:47], v[68:71]
  v_xor_b32 v20, 96, v22
  ds_read_b64_tr_b16 v[40:41], v20 offset:8192
  s_waitcnt lgkmcnt(7)
  v_mfma_f32_16x16x32_bf16 v[72:75], v[176:179], v[24:27], v[72:75]
  ds_read_b64_tr_b16 v[42:43], v20 offset:8704
  s_waitcnt lgkmcnt(6)
  v_mfma_f32_16x16x32_bf16 v[72:75], v[184:187], v[28:31], v[72:75]
  ds_read_b64_tr_b16 v[44:45], v20 offset:12288
  v_mfma_f32_16x16x32_bf16 v[76:79], v[180:183], v[24:27], v[76:79]
  ds_read_b64_tr_b16 v[46:47], v20 offset:12800
  s_cmp_lt_u32 s56, 4
  s_cbranch_scc1 gated_mix__softmax_full_mha__geglu_ffn__prompt_kernel_l10
  v_mfma_f32_16x16x32_bf16 v[76:79], v[188:191], v[28:31], v[76:79]
  s_waitcnt lgkmcnt(6)
  v_mfma_f32_16x16x32_bf16 v[80:83], v[176:179], v[32:35], v[80:83]
  s_waitcnt lgkmcnt(4)
  v_mfma_f32_16x16x32_bf16 v[80:83], v[184:187], v[36:39], v[80:83]
  v_mfma_f32_16x16x32_bf16 v[84:87], v[180:183], v[32:35], v[84:87]
  v_mfma_f32_16x16x32_bf16 v[84:87], v[188:191], v[36:39], v[84:87]
  s_waitcnt lgkmcnt(2)
  v_mfma_f32_16x16x32_bf16 v[88:91], v[176:179], v[40:43], v[88:91]
  s_waitcnt vmcnt(6)
  s_waitcnt lgkmcnt(0)
  s_barrier
  v_mfma_f32_16x16x32_bf16 v[88:91], v[184:187], v[44:47], v[88:91]
  v_mfma_f32_16x16x32_bf16 v[92:95], v[180:183], v[40:43], v[92:95]
  v_mfma_f32_16x16x32_bf16 v[92:95], v[188:191], v[44:47], v[92:95]
  s_cmp_ge_u32 s84, 2
  s_cselect_b32 s63, s3, s69
  s_add_u32 m0, s71, 49152
  s_add_u32 s63, s63, 4128768
  buffer_load_dwordx4 v96, s[12:15], s63 offen lds
  s_cmp_ge_u32 s84, 2
  s_cselect_b32 s63, s98, s70
  s_add_u32 m0, s85, 57344
  s_add_u32 s63, s63, 1548288
  buffer_load_dwordx4 v3, s[40:43], s63 offen lds
  s_cmp_ge_u32 s84, 2
  s_cselect_b32 s63, s97, s62
  s_add_u32 m0, s78, 49152
  s_add_u32 s63, s63, 896
  buffer_load_dwordx4 v5, s[28:31], s63 offen lds
  s_cmp_ge_u32 s84, 2
  s_cselect_b32 s63, s97, s62
  s_add_u32 m0, s78, 50176
  s_add_u32 s63, s63, 896
  buffer_load_dwordx4 v6, s[28:31], s63 offen lds
  s_cmp_ge_u32 s84, 2
  s_cselect_b32 s63, s97, s62
  s_add_u32 m0, s78, 51200
  s_add_u32 s63, s63, 19328
  buffer_load_dwordx4 v5, s[28:31], s63 offen lds
  s_cmp_ge_u32 s84, 2
  s_cselect_b32 s63, s97, s62
  s_add_u32 m0, s78, 52224
  s_add_u32 s63, s63, 19328
  buffer_load_dwordx4 v6, s[28:31], s63 offen lds
  v_add_u32 v22, 98304, v1
  v_add_u32 v99, 98304, v7
  v_xor_b32 v100, 64, v99
  v_add_u32 v98, 98304, v97
  ds_read_b64_tr_b16 v[24:25], v98 offset:0
  ds_read_b64_tr_b16 v[26:27], v98 offset:256
  ds_read_b128 v[192:195], v99 offset:0
  ds_read_b64_tr_b16 v[28:29], v98 offset:1024
  ds_read_b64_tr_b16 v[30:31], v98 offset:1280
  ds_read_b128 v[200:203], v100 offset:0
  ds_read_b128 v[196:199], v99 offset:2048
  ds_read_b128 v[204:207], v100 offset:2048
  ds_read_b64_tr_b16 v[32:33], v98 offset:2048
  ds_read_b64_tr_b16 v[34:35], v98 offset:2304
  ds_read_b64_tr_b16 v[36:37], v98 offset:3072
  ds_read_b64_tr_b16 v[38:39], v98 offset:3328
  v_xor_b32 v21, 0, v22
  ds_read_b64_tr_b16 v[40:41], v21 offset:8192
  s_branch gated_mix__softmax_full_mha__geglu_ffn__prompt_kernel_l11
gated_mix__softmax_full_mha__geglu_ffn__prompt_kernel_l10:
  s_cmp_ge_u32 s84, 3
  s_cselect_b32 s63, s3, s69
  s_add_u32 m0, s71, 0
  s_add_u32 s63, s63, 3538944
  buffer_load_dwordx4 v96, s[12:15], s63 offen lds
  s_cmp_ge_u32 s84, 3
  s_cselect_b32 s63, s98, s70
  s_add_u32 m0, s85, 8192
  s_add_u32 s63, s63, 1327104
  buffer_load_dwordx4 v3, s[40:43], s63 offen lds
  s_cmp_ge_u32 s84, 3
  s_cselect_b32 s63, s97, s62
  s_add_u32 m0, s78, 0
  s_add_u32 s63, s63, 768
  buffer_load_dwordx4 v5, s[28:31], s63 offen lds
  s_cmp_ge_u32 s84, 3
  s_cselect_b32 s63, s97, s62
  s_add_u32 m0, s78, 1024
  s_add_u32 s63, s63, 768
  buffer_load_dwordx4 v6, s[28:31], s63 offen lds
  s_cmp_ge_u32 s84, 3
  s_cselect_b32 s63, s97, s62
  s_add_u32 m0, s78, 2048
  s_add_u32 s63, s63, 19200
  buffer_load_dwordx4 v5, s[28:31], s63 offen lds
  s_cmp_ge_u32 s84, 3
  s_cselect_b32 s63, s97, s62
  s_add_u32 m0, s78, 3072
  s_add_u32 s63, s63, 19200
  buffer_load_dwordx4 v6, s[28:31], s63 offen lds
  v_add_u32 v22, 98304, v1
  v_add_u32 v99, 98304, v7
  v_xor_b32 v100, 64, v99
  v_add_u32 v98, 98304, v97
  s_waitcnt vmcnt(6)
  s_waitcnt lgkmcnt(0)
  s_barrier
  ds_read_b64_tr_b16 v[24:25], v98 offset:0
  ds_read_b64_tr_b16 v[26:27], v98 offset:256
  ds_read_b128 v[192:195], v99 offset:0
  v_mfma_f32_16x16x32_bf16 v[76:79], v[188:191], v[28:31], v[76:79]
  ds_read_b64_tr_b16 v[28:29], v98 offset:1024
  ds_read_b64_tr_b16 v[30:31], v98 offset:1280
  v_mfma_f32_16x16x32_bf16 v[80:83], v[176:179], v[32:35], v[80:83]
  ds_read_b128 v[200:203], v100 offset:0
  ds_read_b128 v[196:199], v99 offset:2048
  v_mfma_f32_16x16x32_bf16 v[80:83], v[184:187], v[36:39], v[80:83]
  ds_read_b128 v[204:207], v100 offset:2048
  v_mfma_f32_16x16x32_bf16 v[84:87], v[180:183], v[32:35], v[84:87]
  ds_read_b64_tr_b16 v[32:33], v98 offset:2048
  ds_read_b64_tr_b16 v[34:35], v98 offset:2304
  v_mfma_f32_16x16x32_bf16 v[84:87], v[188:191], v[36:39], v[84:87]
  ds_read_b64_tr_b16 v[36:37], v98 offset:3072
  ds_read_b64_tr_b16 v[38:39], v98 offset:3328
  v_mfma_f32_16x16x32_bf16 v[88:91], v[176:179], v[40:43], v[88:91]
  v_mfma_f32_16x16x32_bf16 v[88:91], v[184:187], v[44:47], v[88:91]
  v_mfma_f32_16x16x32_bf16 v[92:95], v[180:183], v[40:43], v[92:95]
  v_xor_b32 v21, 0, v22
  ds_read_b64_tr_b16 v[40:41], v21 offset:8192
  v_mfma_f32_16x16x32_bf16 v[92:95], v[188:191], v[44:47], v[92:95]
gated_mix__softmax_full_mha__geglu_ffn__prompt_kernel_l11:
  s_waitcnt lgkmcnt(10)
  v_mfma_f32_16x16x32_bf16 v[48:51], v[24:27], v[192:195], v[48:51]
  ds_read_b64_tr_b16 v[42:43], v21 offset:8704
  s_waitcnt lgkmcnt(8)
  v_mfma_f32_16x16x32_bf16 v[48:51], v[28:31], v[200:203], v[48:51]
  ds_read_b64_tr_b16 v[44:45], v21 offset:12288
  s_waitcnt lgkmcnt(8)
  v_mfma_f32_16x16x32_bf16 v[52:55], v[24:27], v[196:199], v[52:55]
  ds_read_b64_tr_b16 v[46:47], v21 offset:12800
  s_waitcnt lgkmcnt(8)
  v_mfma_f32_16x16x32_bf16 v[52:55], v[28:31], v[204:207], v[52:55]
  v_xor_b32 v20, 32, v22
  ds_read_b64_tr_b16 v[24:25], v20 offset:8192
  s_waitcnt lgkmcnt(7)
  v_mfma_f32_16x16x32_bf16 v[56:59], v[32:35], v[192:195], v[56:59]
  ds_read_b64_tr_b16 v[26:27], v20 offset:8704
  s_waitcnt lgkmcnt(6)
  v_mfma_f32_16x16x32_bf16 v[56:59], v[36:39], v[200:203], v[56:59]
  ds_read_b64_tr_b16 v[28:29], v20 offset:12288
  v_mfma_f32_16x16x32_bf16 v[60:63], v[32:35], v[196:199], v[60:63]
  ds_read_b64_tr_b16 v[30:31], v20 offset:12800
  v_mfma_f32_16x16x32_bf16 v[60:63], v[36:39], v[204:207], v[60:63]
  v_xor_b32 v21, 64, v22
  ds_read_b64_tr_b16 v[32:33], v21 offset:8192
  s_waitcnt lgkmcnt(7)
  v_mfma_f32_16x16x32_bf16 v[64:67], v[192:195], v[40:43], v[64:67]
  ds_read_b64_tr_b16 v[34:35], v21 offset:8704
  s_waitcnt lgkmcnt(6)
  v_mfma_f32_16x16x32_bf16 v[64:67], v[200:203], v[44:47], v[64:67]
  ds_read_b64_tr_b16 v[36:37], v21 offset:12288
  v_mfma_f32_16x16x32_bf16 v[68:71], v[196:199], v[40:43], v[68:71]
  ds_read_b64_tr_b16 v[38:39], v21 offset:12800
  v_mfma_f32_16x16x32_bf16 v[68:71], v[204:207], v[44:47], v[68:71]
  v_xor_b32 v20, 96, v22
  ds_read_b64_tr_b16 v[40:41], v20 offset:8192
  s_waitcnt lgkmcnt(7)
  v_mfma_f32_16x16x32_bf16 v[72:75], v[192:195], v[24:27], v[72:75]
  ds_read_b64_tr_b16 v[42:43], v20 offset:8704
  s_waitcnt lgkmcnt(6)
  v_mfma_f32_16x16x32_bf16 v[72:75], v[200:203], v[28:31], v[72:75]
  ds_read_b64_tr_b16 v[44:45], v20 offset:12288
  v_mfma_f32_16x16x32_bf16 v[76:79], v[196:199], v[24:27], v[76:79]
  ds_read_b64_tr_b16 v[46:47], v20 offset:12800
  s_cmp_lt_u32 s56, 4
  s_cbranch_scc1 gated_mix__softmax_full_mha__geglu_ffn__prompt_kernel_l12
  v_mfma_f32_16x16x32_bf16 v[76:79], v[204:207], v[28:31], v[76:79]
  s_waitcnt lgkmcnt(6)
  v_mfma_f32_16x16x32_bf16 v[80:83], v[192:195], v[32:35], v[80:83]
  s_waitcnt lgkmcnt(4)
  v_mfma_f32_16x16x32_bf16 v[80:83], v[200:203], v[36:39], v[80:83]
  v_mfma_f32_16x16x32_bf16 v[84:87], v[196:199], v[32:35], v[84:87]
  v_mfma_f32_16x16x32_bf16 v[84:87], v[204:207], v[36:39], v[84:87]
  s_waitcnt lgkmcnt(2)
  v_mfma_f32_16x16x32_bf16 v[88:91], v[192:195], v[40:43], v[88:91]
  s_waitcnt vmcnt(6)
  s_waitcnt lgkmcnt(0)
  s_barrier
  v_mfma_f32_16x16x32_bf16 v[88:91], v[200:203], v[44:47], v[88:91]
  v_mfma_f32_16x16x32_bf16 v[92:95], v[196:199], v[40:43], v[92:95]
  v_mfma_f32_16x16x32_bf16 v[92:95], v[204:207], v[44:47], v[92:95]
  s_cmp_ge_u32 s84, 1
  s_cselect_b32 s63, s3, s69
  s_add_u32 m0, s71, 98304
  s_add_u32 s63, s63, 4718592
  buffer_load_dwordx4 v96, s[12:15], s63 offen lds
  s_cmp_ge_u32 s84, 1
  s_cselect_b32 s63, s98, s70
  s_add_u32 m0, s85, 106496
  s_add_u32 s63, s63, 1769472
  buffer_load_dwordx4 v3, s[40:43], s63 offen lds
  s_cmp_ge_u32 s84, 1
  s_cselect_b32 s63, s97, s62
  s_add_u32 m0, s78, 98304
  s_add_u32 s63, s63, 1024
  buffer_load_dwordx4 v5, s[28:31], s63 offen lds
  s_cmp_ge_u32 s84, 1
  s_cselect_b32 s63, s97, s62
  s_add_u32 m0, s78, 99328
  s_add_u32 s63, s63, 1024
  buffer_load_dwordx4 v6, s[28:31], s63 offen lds
  s_cmp_ge_u32 s84, 1
  s_cselect_b32 s63, s97, s62
  s_add_u32 m0, s78, 100352
  s_add_u32 s63, s63, 19456
  buffer_load_dwordx4 v5, s[28:31], s63 offen lds
  s_cmp_ge_u32 s84, 1
  s_cselect_b32 s63, s97, s62
  s_add_u32 m0, s78, 101376
  s_add_u32 s63, s63, 19456
  buffer_load_dwordx4 v6, s[28:31], s63 offen lds
  v_add_u32 v22, 0, v1
  v_add_u32 v99, 0, v7
  v_xor_b32 v100, 64, v99
  v_add_u32 v98, 0, v97
  ds_read_b64_tr_b16 v[24:25], v98 offset:0
  ds_read_b64_tr_b16 v[26:27], v98 offset:256
  ds_read_b128 v[208:211], v99 offset:0
  ds_read_b64_tr_b16 v[28:29], v98 offset:1024
  ds_read_b64_tr_b16 v[30:31], v98 offset:1280
  ds_read_b128 v[216:219], v100 offset:0
  ds_read_b128 v[212:215], v99 offset:2048
  ds_read_b128 v[220:223], v100 offset:2048
  ds_read_b64_tr_b16 v[32:33], v98 offset:2048
  ds_read_b64_tr_b16 v[34:35], v98 offset:2304
  ds_read_b64_tr_b16 v[36:37], v98 offset:3072
  ds_read_b64_tr_b16 v[38:39], v98 offset:3328
  v_xor_b32 v21, 0, v22
  ds_read_b64_tr_b16 v[40:41], v21 offset:8192
  s_branch gated_mix__softmax_full_mha__geglu_ffn__prompt_kernel_l13
gated_mix__softmax_full_mha__geglu_ffn__prompt_kernel_l12:
  s_cmp_ge_u32 s84, 2
  s_cselect_b32 s63, s3, s69
  s_add_u32 m0, s71, 49152
  s_add_u32 s63, s63, 4128768
  buffer_load_dwordx4 v96, s[12:15], s63 offen lds
  s_cmp_ge_u32 s84, 2
  s_cselect_b32 s63, s98, s70
  s_add_u32 m0, s85, 57344
  s_add_u32 s63, s63, 1548288
  buffer_load_dwordx4 v3, s[40:43], s63 offen lds
  s_cmp_ge_u32 s84, 2
  s_cselect_b32 s63, s97, s62
  s_add_u32 m0, s78, 49152
  s_add_u32 s63, s63, 896
  buffer_load_dwordx4 v5, s[28:31], s63 offen lds
  s_cmp_ge_u32 s84, 2
  s_cselect_b32 s63, s97, s62
  s_add_u32 m0, s78, 50176
  s_add_u32 s63, s63, 896
  buffer_load_dwordx4 v6, s[28:31], s63 offen lds
  s_cmp_ge_u32 s84, 2
  s_cselect_b32 s63, s97, s62
  s_add_u32 m0, s78, 51200
  s_add_u32 s63, s63, 19328
  buffer_load_dwordx4 v5, s[28:31], s63 offen lds
  s_cmp_ge_u32 s84, 2
  s_cselect_b32 s63, s97, s62
  s_add_u32 m0, s78, 52224
  s_add_u32 s63, s63, 19328
  buffer_load_dwordx4 v6, s[28:31], s63 offen lds
  v_add_u32 v22, 0, v1
  v_add_u32 v99, 0, v7
  v_xor_b32 v100, 64, v99
  v_add_u32 v98, 0, v97
  s_waitcnt vmcnt(6)
  s_waitcnt lgkmcnt(0)
  s_barrier
  ds_read_b64_tr_b16 v[24:25], v98 offset:0
  ds_read_b64_tr_b16 v[26:27], v98 offset:256
  ds_read_b128 v[208:211], v99 offset:0
  v_mfma_f32_16x16x32_bf16 v[76:79], v[204:207], v[28:31], v[76:79]
  ds_read_b64_tr_b16 v[28:29], v98 offset:1024
  ds_read_b64_tr_b16 v[30:31], v98 offset:1280
  v_mfma_f32_16x16x32_bf16 v[80:83], v[192:195], v[32:35], v[80:83]
  ds_read_b128 v[216:219], v100 offset:0
  ds_read_b128 v[212:215], v99 offset:2048
  v_mfma_f32_16x16x32_bf16 v[80:83], v[200:203], v[36:39], v[80:83]
  ds_read_b128 v[220:223], v100 offset:2048
  v_mfma_f32_16x16x32_bf16 v[84:87], v[196:199], v[32:35], v[84:87]
  ds_read_b64_tr_b16 v[32:33], v98 offset:2048
  ds_read_b64_tr_b16 v[34:35], v98 offset:2304
  v_mfma_f32_16x16x32_bf16 v[84:87], v[204:207], v[36:39], v[84:87]
  ds_read_b64_tr_b16 v[36:37], v98 offset:3072
  ds_read_b64_tr_b16 v[38:39], v98 offset:3328
  v_mfma_f32_16x16x32_bf16 v[88:91], v[192:195], v[40:43], v[88:91]
  v_mfma_f32_16x16x32_bf16 v[88:91], v[200:203], v[44:47], v[88:91]
  v_mfma_f32_16x16x32_bf16 v[92:95], v[196:199], v[40:43], v[92:95]
  v_xor_b32 v21, 0, v22
  ds_read_b64_tr_b16 v[40:41], v21 offset:8192
  v_mfma_f32_16x16x32_bf16 v[92:95], v[204:207], v[44:47], v[92:95]
gated_mix__softmax_full_mha__geglu_ffn__prompt_kernel_l13:
  s_waitcnt lgkmcnt(10)
  v_mfma_f32_16x16x32_bf16 v[48:51], v[24:27], v[208:211], v[48:51]
  ds_read_b64_tr_b16 v[42:43], v21 offset:8704
  s_waitcnt lgkmcnt(8)
  v_mfma_f32_16x16x32_bf16 v[48:51], v[28:31], v[216:219], v[48:51]
  ds_read_b64_tr_b16 v[44:45], v21 offset:12288
  s_waitcnt lgkmcnt(8)
  v_mfma_f32_16x16x32_bf16 v[52:55], v[24:27], v[212:215], v[52:55]
  ds_read_b64_tr_b16 v[46:47], v21 offset:12800
  s_waitcnt lgkmcnt(8)
  v_mfma_f32_16x16x32_bf16 v[52:55], v[28:31], v[220:223], v[52:55]
  v_xor_b32 v20, 32, v22
  ds_read_b64_tr_b16 v[24:25], v20 offset:8192
  s_waitcnt lgkmcnt(7)
  v_mfma_f32_16x16x32_bf16 v[56:59], v[32:35], v[208:211], v[56:59]
  ds_read_b64_tr_b16 v[26:27], v20 offset:8704
  s_waitcnt lgkmcnt(6)
  v_mfma_f32_16x16x32_bf16 v[56:59], v[36:39], v[216:219], v[56:59]
  ds_read_b64_tr_b16 v[28:29], v20 offset:12288
  v_mfma_f32_16x16x32_bf16 v[60:63], v[32:35], v[212:215], v[60:63]
  ds_read_b64_tr_b16 v[30:31], v20 offset:12800
  v_mfma_f32_16x16x32_bf16 v[60:63], v[36:39], v[220:223], v[60:63]
  v_xor_b32 v21, 64, v22
  ds_read_b64_tr_b16 v[32:33], v21 offset:8192
  s_waitcnt lgkmcnt(7)
  v_mfma_f32_16x16x32_bf16 v[64:67], v[208:211], v[40:43], v[64:67]
  ds_read_b64_tr_b16 v[34:35], v21 offset:8704
  s_waitcnt lgkmcnt(6)
  v_mfma_f32_16x16x32_bf16 v[64:67], v[216:219], v[44:47], v[64:67]
  ds_read_b64_tr_b16 v[36:37], v21 offset:12288
  v_mfma_f32_16x16x32_bf16 v[68:71], v[212:215], v[40:43], v[68:71]
  ds_read_b64_tr_b16 v[38:39], v21 offset:12800
  v_mfma_f32_16x16x32_bf16 v[68:71], v[220:223], v[44:47], v[68:71]
  v_xor_b32 v20, 96, v22
  ds_read_b64_tr_b16 v[40:41], v20 offset:8192
  s_waitcnt lgkmcnt(7)
  v_mfma_f32_16x16x32_bf16 v[72:75], v[208:211], v[24:27], v[72:75]
  ds_read_b64_tr_b16 v[42:43], v20 offset:8704
  s_waitcnt lgkmcnt(6)
  v_mfma_f32_16x16x32_bf16 v[72:75], v[216:219], v[28:31], v[72:75]
  ds_read_b64_tr_b16 v[44:45], v20 offset:12288
  v_mfma_f32_16x16x32_bf16 v[76:79], v[212:215], v[24:27], v[76:79]
  ds_read_b64_tr_b16 v[46:47], v20 offset:12800
  s_cmp_lt_u32 s56, 4
  s_cbranch_scc1 gated_mix__softmax_full_mha__geglu_ffn__prompt_kernel_l14
  v_mfma_f32_16x16x32_bf16 v[76:79], v[220:223], v[28:31], v[76:79]
  s_waitcnt lgkmcnt(6)
  v_mfma_f32_16x16x32_bf16 v[80:83], v[208:211], v[32:35], v[80:83]
  s_waitcnt lgkmcnt(4)
  v_mfma_f32_16x16x32_bf16 v[80:83], v[216:219], v[36:39], v[80:83]
  v_mfma_f32_16x16x32_bf16 v[84:87], v[212:215], v[32:35], v[84:87]
  v_mfma_f32_16x16x32_bf16 v[84:87], v[220:223], v[36:39], v[84:87]
  s_waitcnt lgkmcnt(2)
  v_mfma_f32_16x16x32_bf16 v[88:91], v[208:211], v[40:43], v[88:91]
  s_waitcnt vmcnt(6)
  s_waitcnt lgkmcnt(0)
  s_barrier
  v_mfma_f32_16x16x32_bf16 v[88:91], v[216:219], v[44:47], v[88:91]
  v_mfma_f32_16x16x32_bf16 v[92:95], v[212:215], v[40:43], v[92:95]
  v_mfma_f32_16x16x32_bf16 v[92:95], v[220:223], v[44:47], v[92:95]
  s_cmp_ge_u32 s84, 9
  s_cselect_b32 s63, s96, s67
  s_add_u32 m0, s85, 0
  s_add_u32 s63, s63, 0
  buffer_load_dwordx4 v2, s[32:35], s63 offen lds
  s_cmp_ge_u32 s84, 9
  s_cselect_b32 s63, s96, s67
  s_add_u32 m0, s85, 24576
  s_add_u32 s63, s63, 0
  buffer_load_dwordx4 v2, s[36:39], s63 offen lds
  s_cmp_ge_u32 s84, 8
  s_cselect_b32 s63, s96, s67
  s_add_u32 m0, s85, 8192
  s_add_u32 s63, s63, 589824
  buffer_load_dwordx4 v2, s[32:35], s63 offen lds
  s_cmp_ge_u32 s84, 8
  s_cselect_b32 s63, s96, s67
  s_add_u32 m0, s85, 32768
  s_add_u32 s63, s63, 589824
  buffer_load_dwordx4 v2, s[36:39], s63 offen lds
  s_cmp_ge_u32 s84, 7
  s_cselect_b32 s63, s96, s67
  s_add_u32 m0, s85, 16384
  s_add_u32 s63, s63, 1179648
  buffer_load_dwordx4 v2, s[32:35], s63 offen lds
  s_cmp_ge_u32 s84, 7
  s_cselect_b32 s63, s96, s67
  s_add_u32 m0, s85, 40960
  s_add_u32 s63, s63, 1179648
  buffer_load_dwordx4 v2, s[36:39], s63 offen lds
  v_add_u32 v22, 49152, v1
  v_add_u32 v99, 49152, v7
  v_xor_b32 v100, 64, v99
  v_add_u32 v98, 49152, v97
  ds_read_b64_tr_b16 v[24:25], v98 offset:0
  ds_read_b64_tr_b16 v[26:27], v98 offset:256
  ds_read_b128 v[224:227], v99 offset:0
  ds_read_b64_tr_b16 v[28:29], v98 offset:1024
  ds_read_b64_tr_b16 v[30:31], v98 offset:1280
  ds_read_b128 v[232:235], v100 offset:0
  ds_read_b128 v[228:231], v99 offset:2048
  ds_read_b128 v[236:239], v100 offset:2048
  ds_read_b64_tr_b16 v[32:33], v98 offset:2048
  ds_read_b64_tr_b16 v[34:35], v98 offset:2304
  ds_read_b64_tr_b16 v[36:37], v98 offset:3072
  ds_read_b64_tr_b16 v[38:39], v98 offset:3328
  v_xor_b32 v21, 0, v22
  ds_read_b64_tr_b16 v[40:41], v21 offset:8192
  s_branch gated_mix__softmax_full_mha__geglu_ffn__prompt_kernel_l15
gated_mix__softmax_full_mha__geglu_ffn__prompt_kernel_l14:
  s_cmp_ge_u32 s84, 1
  s_cselect_b32 s63, s3, s69
  s_add_u32 m0, s71, 98304
  s_add_u32 s63, s63, 4718592
  buffer_load_dwordx4 v96, s[12:15], s63 offen lds
  s_cmp_ge_u32 s84, 1
  s_cselect_b32 s63, s98, s70
  s_add_u32 m0, s85, 106496
  s_add_u32 s63, s63, 1769472
  buffer_load_dwordx4 v3, s[40:43], s63 offen lds
  s_cmp_ge_u32 s84, 1
  s_cselect_b32 s63, s97, s62
  s_add_u32 m0, s78, 98304
  s_add_u32 s63, s63, 1024
  buffer_load_dwordx4 v5, s[28:31], s63 offen lds
  s_cmp_ge_u32 s84, 1
  s_cselect_b32 s63, s97, s62
  s_add_u32 m0, s78, 99328
  s_add_u32 s63, s63, 1024
  buffer_load_dwordx4 v6, s[28:31], s63 offen lds
  s_cmp_ge_u32 s84, 1
  s_cselect_b32 s63, s97, s62
  s_add_u32 m0, s78, 100352
  s_add_u32 s63, s63, 19456
  buffer_load_dwordx4 v5, s[28:31], s63 offen lds
  s_cmp_ge_u32 s84, 1
  s_cselect_b32 s63, s97, s62
  s_add_u32 m0, s78, 101376
  s_add_u32 s63, s63, 19456
  buffer_load_dwordx4 v6, s[28:31], s63 offen lds
  v_add_u32 v22, 49152, v1
  v_add_u32 v99, 49152, v7
  v_xor_b32 v100, 64, v99
  v_add_u32 v98, 49152, v97
  s_waitcnt vmcnt(6)
  s_waitcnt lgkmcnt(0)
  s_barrier
  ds_read_b64_tr_b16 v[24:25], v98 offset:0
  ds_read_b64_tr_b16 v[26:27], v98 offset:256
  ds_read_b128 v[224:227], v99 offset:0
  v_mfma_f32_16x16x32_bf16 v[76:79], v[220:223], v[28:31], v[76:79]
  ds_read_b64_tr_b16 v[28:29], v98 offset:1024
  ds_read_b64_tr_b16 v[30:31], v98 offset:1280
  v_mfma_f32_16x16x32_bf16 v[80:83], v[208:211], v[32:35], v[80:83]
  ds_read_b128 v[232:235], v100 offset:0
  ds_read_b128 v[228:231], v99 offset:2048
  v_mfma_f32_16x16x32_bf16 v[80:83], v[216:219], v[36:39], v[80:83]
  ds_read_b128 v[236:239], v100 offset:2048
  v_mfma_f32_16x16x32_bf16 v[84:87], v[212:215], v[32:35], v[84:87]
  ds_read_b64_tr_b16 v[32:33], v98 offset:2048
  ds_read_b64_tr_b16 v[34:35], v98 offset:2304
  v_mfma_f32_16x16x32_bf16 v[84:87], v[220:223], v[36:39], v[84:87]
  ds_read_b64_tr_b16 v[36:37], v98 offset:3072
  ds_read_b64_tr_b16 v[38:39], v98 offset:3328
  v_mfma_f32_16x16x32_bf16 v[88:91], v[208:211], v[40:43], v[88:91]
  v_mfma_f32_16x16x32_bf16 v[88:91], v[216:219], v[44:47], v[88:91]
  v_mfma_f32_16x16x32_bf16 v[92:95], v[212:215], v[40:43], v[92:95]
  v_xor_b32 v21, 0, v22
  ds_read_b64_tr_b16 v[40:41], v21 offset:8192
  v_mfma_f32_16x16x32_bf16 v[92:95], v[220:223], v[44:47], v[92:95]
gated_mix__softmax_full_mha__geglu_ffn__prompt_kernel_l15:
  s_waitcnt lgkmcnt(10)
  v_mfma_f32_16x16x32_bf16 v[48:51], v[24:27], v[224:227], v[48:51]
  ds_read_b64_tr_b16 v[42:43], v21 offset:8704
  s_waitcnt lgkmcnt(8)
  v_mfma_f32_16x16x32_bf16 v[48:51], v[28:31], v[232:235], v[48:51]
  ds_read_b64_tr_b16 v[44:45], v21 offset:12288
  s_waitcnt lgkmcnt(8)
  v_mfma_f32_16x16x32_bf16 v[52:55], v[24:27], v[228:231], v[52:55]
  ds_read_b64_tr_b16 v[46:47], v21 offset:12800
  s_waitcnt lgkmcnt(8)
  v_mfma_f32_16x16x32_bf16 v[52:55], v[28:31], v[236:239], v[52:55]
  v_xor_b32 v20, 32, v22
  ds_read_b64_tr_b16 v[24:25], v20 offset:8192
  s_waitcnt lgkmcnt(7)
  v_mfma_f32_16x16x32_bf16 v[56:59], v[32:35], v[224:227], v[56:59]
  ds_read_b64_tr_b16 v[26:27], v20 offset:8704
  s_waitcnt lgkmcnt(6)
  v_mfma_f32_16x16x32_bf16 v[56:59], v[36:39], v[232:235], v[56:59]
  ds_read_b64_tr_b16 v[28:29], v20 offset:12288
  v_mfma_f32_16x16x32_bf16 v[60:63], v[32:35], v[228:231], v[60:63]
  ds_read_b64_tr_b16 v[30:31], v20 offset:12800
  v_mfma_f32_16x16x32_bf16 v[60:63], v[36:39], v[236:239], v[60:63]
  v_xor_b32 v21, 64, v22
  ds_read_b64_tr_b16 v[32:33], v21 offset:8192
  s_waitcnt lgkmcnt(7)
  v_mfma_f32_16x16x32_bf16 v[64:67], v[224:227], v[40:43], v[64:67]
  ds_read_b64_tr_b16 v[34:35], v21 offset:8704
  s_waitcnt lgkmcnt(6)
  v_mfma_f32_16x16x32_bf16 v[64:67], v[232:235], v[44:47], v[64:67]
  ds_read_b64_tr_b16 v[36:37], v21 offset:12288
  v_mfma_f32_16x16x32_bf16 v[68:71], v[228:231], v[40:43], v[68:71]
  ds_read_b64_tr_b16 v[38:39], v21 offset:12800
  v_mfma_f32_16x16x32_bf16 v[68:71], v[236:239], v[44:47], v[68:71]
  v_xor_b32 v20, 96, v22
  ds_read_b64_tr_b16 v[40:41], v20 offset:8192
  s_waitcnt lgkmcnt(7)
  v_mfma_f32_16x16x32_bf16 v[72:75], v[224:227], v[24:27], v[72:75]
  ds_read_b64_tr_b16 v[42:43], v20 offset:8704
  s_waitcnt lgkmcnt(6)
  v_mfma_f32_16x16x32_bf16 v[72:75], v[232:235], v[28:31], v[72:75]
  ds_read_b64_tr_b16 v[44:45], v20 offset:12288
  v_mfma_f32_16x16x32_bf16 v[76:79], v[228:231], v[24:27], v[76:79]
  ds_read_b64_tr_b16 v[46:47], v20 offset:12800
  s_cmp_lt_u32 s56, 4
  s_cbranch_scc1 gated_mix__softmax_full_mha__geglu_ffn__prompt_kernel_l16
  v_mfma_f32_16x16x32_bf16 v[76:79], v[236:239], v[28:31], v[76:79]
  s_waitcnt lgkmcnt(6)
  v_mfma_f32_16x16x32_bf16 v[80:83], v[224:227], v[32:35], v[80:83]
  s_waitcnt lgkmcnt(4)
  v_mfma_f32_16x16x32_bf16 v[80:83], v[232:235], v[36:39], v[80:83]
  v_mfma_f32_16x16x32_bf16 v[84:87], v[228:231], v[32:35], v[84:87]
  v_mfma_f32_16x16x32_bf16 v[84:87], v[236:239], v[36:39], v[84:87]
  s_waitcnt lgkmcnt(2)
  v_mfma_f32_16x16x32_bf16 v[88:91], v[224:227], v[40:43], v[88:91]
  s_waitcnt vmcnt(6)
  s_waitcnt lgkmcnt(0)
  s_barrier
  v_mfma_f32_16x16x32_bf16 v[88:91], v[232:235], v[44:47], v[88:91]
  v_mfma_f32_16x16x32_bf16 v[92:95], v[228:231], v[40:43], v[92:95]
  v_mfma_f32_16x16x32_bf16 v[92:95], v[236:239], v[44:47], v[92:95]
  s_cmp_ge_u32 s84, 6
  s_cselect_b32 s63, s96, s67
  s_add_u32 m0, s85, 49152
  s_add_u32 s63, s63, 1769472
  buffer_load_dwordx4 v2, s[32:35], s63 offen lds
  s_cmp_ge_u32 s84, 6
  s_cselect_b32 s63, s96, s67
  s_add_u32 m0, s85, 73728
  s_add_u32 s63, s63, 1769472
  buffer_load_dwordx4 v2, s[36:39], s63 offen lds
  s_cmp_ge_u32 s84, 5
  s_cselect_b32 s63, s96, s67
  s_add_u32 m0, s85, 57344
  s_add_u32 s63, s63, 2359296
  buffer_load_dwordx4 v2, s[32:35], s63 offen lds
  s_cmp_ge_u32 s84, 5
  s_cselect_b32 s63, s96, s67
  s_add_u32 m0, s85, 81920
  s_add_u32 s63, s63, 2359296
  buffer_load_dwordx4 v2, s[36:39], s63 offen lds
  s_cmp_ge_u32 s84, 4
  s_cselect_b32 s63, s96, s67
  s_add_u32 m0, s85, 65536
  s_add_u32 s63, s63, 2949120
  buffer_load_dwordx4 v2, s[32:35], s63 offen lds
  s_cmp_ge_u32 s84, 4
  s_cselect_b32 s63, s96, s67
  s_add_u32 m0, s85, 90112
  s_add_u32 s63, s63, 2949120
  buffer_load_dwordx4 v2, s[36:39], s63 offen lds
  s_and_b32 s66, s56, 3
  s_add_u32 s66, s66, 0
  s_mul_i32 s64, s57, 36
  s_lshl_b32 s63, s59, 2
  s_add_u32 s63, s63, s66
  s_add_u32 s63, s63, s64
  s_movk_i32 s92, 0x77
  s_bitcmp1_b32 s92, s56
  s_cselect_b32 s92, 1, 0
  s_mov_b32 s64, s58
  s_mov_b32 s75, 0x00020000
  s_lshr_b32 s65, s63, 2
  s_mul_i32 s66, s65, 57
  s_lshr_b32 s66, s66, 9
  s_mul_i32 s66, s66, 9
  s_sub_u32 s66, s65, s66
  s_lshr_b32 s86, s63, 1
  s_lshl_b32 s86, s86, 5
  s_and_b32 s65, s63, 1
  s_lshl_b32 s65, s65, 3
  s_add_u32 s86, s86, s65
  s_lshl_b32 s65, s63, 4
  s_cmp_eq_u32 s66, 8
  s_cselect_b32 s86, s65, s86
  s_cselect_b32 s87, 4, 16
  s_cselect_b32 s88, 8, 4
  s_mov_b32 s89, 2
  s_mul_i32 s90, s64, 576
  s_add_u32 s90, s90, s63
  s_mul_i32 s90, s90, 2304
  s_add_u32 s90, s90, 18874368
  s_mov_b32 s91, 663552
  s_mov_b32 s72, s16
  s_and_b32 s73, s17, 0xffff
  s_mov_b32 s74, 5308416
  s_cmp_lt_u32 s63, 288
  s_cbranch_scc1 gated_mix__softmax_full_mha__geglu_ffn__prompt_kernel_l18
  s_sub_u32 s63, s63, 288
  s_mul_i32 s90, s64, 72
  s_add_u32 s90, s90, s63
  s_mul_i32 s90, s90, 2304
  s_add_u32 s90, s90, 24182784
  s_mov_b32 s91, 82944
  s_mov_b32 s72, s8
  s_and_b32 s73, s9, 0xffff
  s_mov_b32 s74, 663552
  s_mul_i32 s86, s63, 18
  s_sub_u32 s65, s63, 32
  s_mul_i32 s65, s65, 144
  s_add_u32 s65, s65, 16
  s_cmp_lt_u32 s63, 32
  s_cselect_b32 s86, s86, s65
  s_cselect_b32 s87, 4, 36
  s_cselect_b32 s88, 8, 72
  s_cselect_b32 s89, 2, 18
gated_mix__softmax_full_mha__geglu_ffn__prompt_kernel_l18:
  s_mul_i32 s86, s86, 1152
  s_mul_i32 s64, s64, 288
  s_add_u32 s86, s86, s64
  s_mul_i32 s87, s87, 1152
  s_mul_i32 s88, s88, 1152
  s_mul_i32 s89, s89, 1152
  s_cmp_eq_u32 s92, 0
  s_cselect_b32 s74, 0, s74
  s_cselect_b32 s90, 0, s90
  v_add_u32 v22, 98304, v1
  v_add_u32 v99, 98304, v7
  v_xor_b32 v100, 64, v99
  v_add_u32 v98, 98304, v97
  ds_read_b64_tr_b16 v[24:25], v98 offset:0
  ds_read_b64_tr_b16 v[26:27], v98 offset:256
  ds_read_b128 v[240:243], v99 offset:0
  ds_read_b64_tr_b16 v[28:29], v98 offset:1024
  ds_read_b64_tr_b16 v[30:31], v98 offset:1280
  ds_read_b128 v[248:251], v100 offset:0
  ds_read_b128 v[244:247], v99 offset:2048
  ds_read_b128 v[252:255], v100 offset:2048
  ds_read_b64_tr_b16 v[32:33], v98 offset:2048
  ds_read_b64_tr_b16 v[34:35], v98 offset:2304
  ds_read_b64_tr_b16 v[36:37], v98 offset:3072
  ds_read_b64_tr_b16 v[38:39], v98 offset:3328
  v_xor_b32 v21, 0, v22
  ds_read_b64_tr_b16 v[40:41], v21 offset:8192
  s_branch gated_mix__softmax_full_mha__geglu_ffn__prompt_kernel_l17
gated_mix__softmax_full_mha__geglu_ffn__prompt_kernel_l16:
  s_cmp_ge_u32 s84, 9
  s_cselect_b32 s63, s96, s67
  s_add_u32 m0, s85, 0
  s_add_u32 s63, s63, 0
  buffer_load_dwordx4 v2, s[32:35], s63 offen lds
  s_cmp_ge_u32 s84, 9
  s_cselect_b32 s63, s96, s67
  s_add_u32 m0, s85, 24576
  s_add_u32 s63, s63, 0
  buffer_load_dwordx4 v2, s[36:39], s63 offen lds
  s_cmp_ge_u32 s84, 8
  s_cselect_b32 s63, s96, s67
  s_add_u32 m0, s85, 8192
  s_add_u32 s63, s63, 589824
  buffer_load_dwordx4 v2, s[32:35], s63 offen lds
  s_cmp_ge_u32 s84, 8
  s_cselect_b32 s63, s96, s67
  s_add_u32 m0, s85, 32768
  s_add_u32 s63, s63, 589824
  buffer_load_dwordx4 v2, s[36:39], s63 offen lds
  s_cmp_ge_u32 s84, 7
  s_cselect_b32 s63, s96, s67
  s_add_u32 m0, s85, 16384
  s_add_u32 s63, s63, 1179648
  buffer_load_dwordx4 v2, s[32:35], s63 offen lds
  s_cmp_ge_u32 s84, 7
  s_cselect_b32 s63, s96, s67
  s_add_u32 m0, s85, 40960
  s_add_u32 s63, s63, 1179648
  buffer_load_dwordx4 v2, s[36:39], s63 offen lds
  v_add_u32 v22, 98304, v1
  v_add_u32 v99, 98304, v7
  v_xor_b32 v100, 64, v99
  v_add_u32 v98, 98304, v97
  s_waitcnt vmcnt(6)
  s_waitcnt lgkmcnt(0)
  s_barrier
  ds_read_b64_tr_b16 v[24:25], v98 offset:0
  ds_read_b64_tr_b16 v[26:27], v98 offset:256
  ds_read_b128 v[240:243], v99 offset:0
  v_mfma_f32_16x16x32_bf16 v[76:79], v[236:239], v[28:31], v[76:79]
  ds_read_b64_tr_b16 v[28:29], v98 offset:1024
  ds_read_b64_tr_b16 v[30:31], v98 offset:1280
  v_mfma_f32_16x16x32_bf16 v[80:83], v[224:227], v[32:35], v[80:83]
  ds_read_b128 v[248:251], v100 offset:0
  ds_read_b128 v[244:247], v99 offset:2048
  v_mfma_f32_16x16x32_bf16 v[80:83], v[232:235], v[36:39], v[80:83]
  ds_read_b128 v[252:255], v100 offset:2048
  v_mfma_f32_16x16x32_bf16 v[84:87], v[228:231], v[32:35], v[84:87]
  ds_read_b64_tr_b16 v[32:33], v98 offset:2048
  ds_read_b64_tr_b16 v[34:35], v98 offset:2304
  v_mfma_f32_16x16x32_bf16 v[84:87], v[236:239], v[36:39], v[84:87]
  ds_read_b64_tr_b16 v[36:37], v98 offset:3072
  ds_read_b64_tr_b16 v[38:39], v98 offset:3328
  v_mfma_f32_16x16x32_bf16 v[88:91], v[224:227], v[40:43], v[88:91]
  v_mfma_f32_16x16x32_bf16 v[88:91], v[232:235], v[44:47], v[88:91]
  v_mfma_f32_16x16x32_bf16 v[92:95], v[228:231], v[40:43], v[92:95]
  v_xor_b32 v21, 0, v22
  ds_read_b64_tr_b16 v[40:41], v21 offset:8192
  v_mfma_f32_16x16x32_bf16 v[92:95], v[236:239], v[44:47], v[92:95]
gated_mix__softmax_full_mha__geglu_ffn__prompt_kernel_l17:
  s_waitcnt lgkmcnt(10)
  v_mfma_f32_16x16x32_bf16 v[48:51], v[24:27], v[240:243], v[48:51]
  ds_read_b64_tr_b16 v[42:43], v21 offset:8704
  s_waitcnt lgkmcnt(8)
  v_mfma_f32_16x16x32_bf16 v[48:51], v[28:31], v[248:251], v[48:51]
  ds_read_b64_tr_b16 v[44:45], v21 offset:12288
  s_waitcnt lgkmcnt(8)
  v_mfma_f32_16x16x32_bf16 v[52:55], v[24:27], v[244:247], v[52:55]
  ds_read_b64_tr_b16 v[46:47], v21 offset:12800
  s_waitcnt lgkmcnt(8)
  v_mfma_f32_16x16x32_bf16 v[52:55], v[28:31], v[252:255], v[52:55]
  v_xor_b32 v20, 32, v22
  ds_read_b64_tr_b16 v[24:25], v20 offset:8192
  s_waitcnt lgkmcnt(7)
  v_mfma_f32_16x16x32_bf16 v[56:59], v[32:35], v[240:243], v[56:59]
  ds_read_b64_tr_b16 v[26:27], v20 offset:8704
  s_waitcnt lgkmcnt(6)
  v_mfma_f32_16x16x32_bf16 v[56:59], v[36:39], v[248:251], v[56:59]
  ds_read_b64_tr_b16 v[28:29], v20 offset:12288
  v_mfma_f32_16x16x32_bf16 v[60:63], v[32:35], v[244:247], v[60:63]
  ds_read_b64_tr_b16 v[30:31], v20 offset:12800
  v_mfma_f32_16x16x32_bf16 v[60:63], v[36:39], v[252:255], v[60:63]
  v_xor_b32 v21, 64, v22
  ds_read_b64_tr_b16 v[32:33], v21 offset:8192
  s_waitcnt lgkmcnt(7)
  v_mfma_f32_16x16x32_bf16 v[64:67], v[240:243], v[40:43], v[64:67]
  ds_read_b64_tr_b16 v[34:35], v21 offset:8704
  s_waitcnt lgkmcnt(6)
  v_mfma_f32_16x16x32_bf16 v[64:67], v[248:251], v[44:47], v[64:67]
  ds_read_b64_tr_b16 v[36:37], v21 offset:12288
  v_mfma_f32_16x16x32_bf16 v[68:71], v[244:247], v[40:43], v[68:71]
  ds_read_b64_tr_b16 v[38:39], v21 offset:12800
  v_mfma_f32_16x16x32_bf16 v[68:71], v[252:255], v[44:47], v[68:71]
  v_xor_b32 v20, 96, v22
  ds_read_b64_tr_b16 v[40:41], v20 offset:8192
  s_waitcnt lgkmcnt(7)
  v_mfma_f32_16x16x32_bf16 v[72:75], v[240:243], v[24:27], v[72:75]
  ds_read_b64_tr_b16 v[42:43], v20 offset:8704
  s_waitcnt lgkmcnt(6)
  v_mfma_f32_16x16x32_bf16 v[72:75], v[248:251], v[28:31], v[72:75]
  ds_read_b64_tr_b16 v[44:45], v20 offset:12288
  v_mfma_f32_16x16x32_bf16 v[76:79], v[244:247], v[24:27], v[76:79]
  ds_read_b64_tr_b16 v[46:47], v20 offset:12800
  s_cmp_lt_u32 s56, 4
  s_cbranch_scc1 gated_mix__softmax_full_mha__geglu_ffn__prompt_kernel_l19
  v_mfma_f32_16x16x32_bf16 v[76:79], v[252:255], v[28:31], v[76:79]
  s_waitcnt lgkmcnt(6)
  v_mfma_f32_16x16x32_bf16 v[80:83], v[240:243], v[32:35], v[80:83]
  s_waitcnt lgkmcnt(4)
  v_mfma_f32_16x16x32_bf16 v[80:83], v[248:251], v[36:39], v[80:83]
  v_mfma_f32_16x16x32_bf16 v[84:87], v[244:247], v[32:35], v[84:87]
  v_mfma_f32_16x16x32_bf16 v[84:87], v[252:255], v[36:39], v[84:87]
  s_waitcnt lgkmcnt(2)
  v_mfma_f32_16x16x32_bf16 v[88:91], v[240:243], v[40:43], v[88:91]
  s_waitcnt vmcnt(6)
  s_waitcnt lgkmcnt(0)
  s_barrier
  v_mfma_f32_16x16x32_bf16 v[88:91], v[248:251], v[44:47], v[88:91]
  v_mfma_f32_16x16x32_bf16 v[92:95], v[244:247], v[40:43], v[92:95]
  v_mfma_f32_16x16x32_bf16 v[92:95], v[252:255], v[44:47], v[92:95]
  s_cmp_ge_u32 s84, 3
  s_cselect_b32 s63, s96, s67
  s_add_u32 m0, s85, 98304
  s_add_u32 s63, s63, 3538944
  buffer_load_dwordx4 v2, s[32:35], s63 offen lds
  s_cmp_ge_u32 s84, 3
  s_cselect_b32 s63, s96, s67
  s_add_u32 m0, s85, 122880
  s_add_u32 s63, s63, 3538944
  buffer_load_dwordx4 v2, s[36:39], s63 offen lds
  s_cmp_ge_u32 s84, 2
  s_cselect_b32 s63, s96, s67
  s_add_u32 m0, s85, 106496
  s_add_u32 s63, s63, 4128768
  buffer_load_dwordx4 v2, s[32:35], s63 offen lds
  s_cmp_ge_u32 s84, 2
  s_cselect_b32 s63, s96, s67
  s_add_u32 m0, s85, 131072
  s_add_u32 s63, s63, 4128768
  buffer_load_dwordx4 v2, s[36:39], s63 offen lds
  s_cmp_ge_u32 s84, 1
  s_cselect_b32 s63, s96, s67
  s_add_u32 m0, s85, 114688
  s_add_u32 s63, s63, 4718592
  buffer_load_dwordx4 v2, s[32:35], s63 offen lds
  s_cmp_ge_u32 s84, 1
  s_cselect_b32 s63, s96, s67
  s_add_u32 m0, s85, 139264
  s_add_u32 s63, s63, 4718592
  buffer_load_dwordx4 v2, s[36:39], s63 offen lds
  s_and_b32 s81, s56, 3
  s_mul_i32 s81, s81, 4608
  s_add_u32 s81, s81, 147456
  v_lshlrev_b32 v8, 4, v0
  v_add_u32 v9, 864, v8
  v_cmp_gt_u32 vcc, 18, v0
  s_nop 1
  v_cndmask_b32 v8, v9, v8, vcc
  s_mov_b32 exec_hi, 15
  s_mov_b32 s63, s86
  s_add_u32 m0, s81, 0
  s_nop 0
  buffer_load_dwordx4 v8, s[72:75], s63 offen lds
  s_mov_b32 s63, s86
  s_add_u32 s63, s63, s89
  s_add_u32 m0, s81, 576
  s_nop 0
  buffer_load_dwordx4 v8, s[72:75], s63 offen lds
  s_mov_b32 s63, s86
  s_add_u32 s63, s63, s88
  s_add_u32 m0, s81, 1152
  s_nop 0
  buffer_load_dwordx4 v8, s[72:75], s63 offen lds
  s_mov_b32 s63, s86
  s_add_u32 s63, s63, s89
  s_add_u32 s63, s63, s88
  s_add_u32 m0, s81, 1728
  s_nop 0
  buffer_load_dwordx4 v8, s[72:75], s63 offen lds
  s_mov_b32 s63, s86
  s_add_u32 s63, s63, s87
  s_add_u32 m0, s81, 2304
  s_nop 0
  buffer_load_dwordx4 v8, s[72:75], s63 offen lds
  s_mov_b32 s63, s86
  s_add_u32 s63, s63, s89
  s_add_u32 s63, s63, s87
  s_add_u32 m0, s81, 2880
  s_nop 0
  buffer_load_dwordx4 v8, s[72:75], s63 offen lds
  s_mov_b32 s63, s86
  s_add_u32 s63, s63, s88
  s_add_u32 s63, s63, s87
  s_add_u32 m0, s81, 3456
  s_nop 0
  buffer_load_dwordx4 v8, s[72:75], s63 offen lds
  s_mov_b32 s63, s86
  s_add_u32 s63, s63, s89
  s_add_u32 s63, s63, s88
  s_add_u32 s63, s63, s87
  s_add_u32 m0, s81, 4032
  s_nop 0
  buffer_load_dwordx4 v8, s[72:75], s63 offen lds
  s_mov_b32 exec_hi, -1
  v_and_b32 v8, 15, v0
  v_lshrrev_b32 v9, 4, v0
  v_lshlrev_b32 v9, 10, v9
  v_lshl_add_u32 v5, v8, 4, v9
  v_cmp_gt_u32 vcc, 8, v8
  v_mov_b32 v10, 2147483648
  s_nop 0
  v_cndmask_b32 v6, v10, v5, vcc
  v_mov_b32 v9, s93
  v_mov_b32 v10, s94
  v_mov_b32 v11, s95
  v_cmp_le_u32 vcc, 2, v8
  s_nop 1
  v_cndmask_b32 v7, v9, v10, vcc
  v_cmp_le_u32 vcc, 4, v8
  s_nop 1
  v_cndmask_b32 v3, v10, v11, vcc
  v_add_u32 v22, 0, v1
  v_xor_b32 v21, 96, v22
  ds_read_b64_tr_b16 v[24:25], v21 offset:0
  ds_read_b64_tr_b16 v[26:27], v21 offset:512
  ds_read_b64_tr_b16 v[28:29], v21 offset:4096
  ds_read_b64_tr_b16 v[30:31], v21 offset:4608
  ds_read_b64_tr_b16 v[32:33], v21 offset:8192
  ds_read_b64_tr_b16 v[34:35], v21 offset:8704
  ds_read_b64_tr_b16 v[36:37], v21 offset:12288
  ds_read_b64_tr_b16 v[38:39], v21 offset:12800
  ds_read_b64_tr_b16 v[40:41], v21 offset:16384
  s_branch gated_mix__softmax_full_mha__geglu_ffn__prompt_kernel_l20
gated_mix__softmax_full_mha__geglu_ffn__prompt_kernel_l19:
  s_cmp_ge_u32 s84, 6
  s_cselect_b32 s63, s96, s67
  s_add_u32 m0, s85, 49152
  s_add_u32 s63, s63, 1769472
  buffer_load_dwordx4 v2, s[32:35], s63 offen lds
  s_cmp_ge_u32 s84, 6
  s_cselect_b32 s63, s96, s67
  s_add_u32 m0, s85, 73728
  s_add_u32 s63, s63, 1769472
  buffer_load_dwordx4 v2, s[36:39], s63 offen lds
  s_cmp_ge_u32 s84, 5
  s_cselect_b32 s63, s96, s67
  s_add_u32 m0, s85, 57344
  s_add_u32 s63, s63, 2359296
  buffer_load_dwordx4 v2, s[32:35], s63 offen lds
  s_cmp_ge_u32 s84, 5
  s_cselect_b32 s63, s96, s67
  s_add_u32 m0, s85, 81920
  s_add_u32 s63, s63, 2359296
  buffer_load_dwordx4 v2, s[36:39], s63 offen lds
  s_cmp_ge_u32 s84, 4
  s_cselect_b32 s63, s96, s67
  s_add_u32 m0, s85, 65536
  s_add_u32 s63, s63, 2949120
  buffer_load_dwordx4 v2, s[32:35], s63 offen lds
  s_cmp_ge_u32 s84, 4
  s_cselect_b32 s63, s96, s67
  s_add_u32 m0, s85, 90112
  s_add_u32 s63, s63, 2949120
  buffer_load_dwordx4 v2, s[36:39], s63 offen lds
  v_and_b32 v8, 15, v0
  v_lshrrev_b32 v9, 4, v0
  v_lshlrev_b32 v9, 10, v9
  v_lshl_add_u32 v5, v8, 4, v9
  v_cmp_gt_u32 vcc, 8, v8
  v_mov_b32 v10, 2147483648
  s_nop 0
  v_cndmask_b32 v6, v10, v5, vcc
  v_mov_b32 v9, s93
  v_mov_b32 v10, s94
  v_mov_b32 v11, s95
  v_cmp_le_u32 vcc, 2, v8
  s_nop 1
  v_cndmask_b32 v7, v9, v10, vcc
  v_cmp_le_u32 vcc, 4, v8
  s_nop 1
  v_cndmask_b32 v3, v10, v11, vcc
  v_add_u32 v22, 0, v1
  s_waitcnt vmcnt(6)
  s_waitcnt lgkmcnt(0)
  s_barrier
  v_xor_b32 v21, 96, v22
  ds_read_b64_tr_b16 v[24:25], v21 offset:0
  ds_read_b64_tr_b16 v[26:27], v21 offset:512
  v_mfma_f32_16x16x32_bf16 v[76:79], v[252:255], v[28:31], v[76:79]
  ds_read_b64_tr_b16 v[28:29], v21 offset:4096
  ds_read_b64_tr_b16 v[30:31], v21 offset:4608
  v_mfma_f32_16x16x32_bf16 v[80:83], v[240:243], v[32:35], v[80:83]
  v_mfma_f32_16x16x32_bf16 v[80:83], v[248:251], v[36:39], v[80:83]
  v_mfma_f32_16x16x32_bf16 v[84:87], v[244:247], v[32:35], v[84:87]
  ds_read_b64_tr_b16 v[32:33], v21 offset:8192
  ds_read_b64_tr_b16 v[34:35], v21 offset:8704
  v_mfma_f32_16x16x32_bf16 v[84:87], v[252:255], v[36:39], v[84:87]
  ds_read_b64_tr_b16 v[36:37], v21 offset:12288
  ds_read_b64_tr_b16 v[38:39], v21 offset:12800
  v_mfma_f32_16x16x32_bf16 v[88:91], v[240:243], v[40:43], v[88:91]
  v_mfma_f32_16x16x32_bf16 v[88:91], v[248:251], v[44:47], v[88:91]
  v_mfma_f32_16x16x32_bf16 v[92:95], v[244:247], v[40:43], v[92:95]
  ds_read_b64_tr_b16 v[40:41], v21 offset:16384
  v_mfma_f32_16x16x32_bf16 v[92:95], v[252:255], v[44:47], v[92:95]
gated_mix__softmax_full_mha__geglu_ffn__prompt_kernel_l20:
  s_waitcnt lgkmcnt(7)
  v_mfma_f32_16x16x32_bf16 v[96:99], v[24:27], v[112:115], 0
  ds_read_b64_tr_b16 v[42:43], v21 offset:16896
  s_waitcnt lgkmcnt(6)
  v_mfma_f32_16x16x32_bf16 v[96:99], v[28:31], v[120:123], v[96:99]
  ds_read_b64_tr_b16 v[44:45], v21 offset:20480
  s_waitcnt lgkmcnt(5)
  v_mfma_f32_16x16x32_bf16 v[96:99], v[32:35], v[128:131], v[96:99]
  ds_read_b64_tr_b16 v[46:47], v21 offset:20992
  v_mfma_f32_16x16x32_bf16 v[100:103], v[24:27], v[116:119], 0
  ds_read_b64_tr_b16 v[24:25], v21 offset:24576
  v_mfma_f32_16x16x32_bf16 v[100:103], v[28:31], v[124:127], v[100:103]
  ds_read_b64_tr_b16 v[26:27], v21 offset:25088
  v_mfma_f32_16x16x32_bf16 v[100:103], v[32:35], v[132:135], v[100:103]
  ds_read_b64_tr_b16 v[28:29], v21 offset:28672
  s_waitcnt lgkmcnt(7)
  v_mfma_f32_16x16x32_bf16 v[100:103], v[36:39], v[140:143], v[100:103]
  ds_read_b64_tr_b16 v[30:31], v21 offset:29184
  s_waitcnt lgkmcnt(6)
  v_mfma_f32_16x16x32_bf16 v[100:103], v[40:43], v[148:151], v[100:103]
  ds_read_b64_tr_b16 v[32:33], v21 offset:32768
  s_waitcnt lgkmcnt(5)
  v_mfma_f32_16x16x32_bf16 v[100:103], v[44:47], v[156:159], v[100:103]
  ds_read_b64_tr_b16 v[34:35], v21 offset:33280
  v_mfma_f32_16x16x32_bf16 v[96:99], v[36:39], v[136:139], v[96:99]
  ds_read_b64_tr_b16 v[36:37], v21 offset:36864
  v_mfma_f32_16x16x32_bf16 v[96:99], v[40:43], v[144:147], v[96:99]
  ds_read_b64_tr_b16 v[38:39], v21 offset:37376
  v_mfma_f32_16x16x32_bf16 v[96:99], v[44:47], v[152:155], v[96:99]
  ds_read_b64_tr_b16 v[40:41], v21 offset:40960
  s_waitcnt lgkmcnt(7)
  v_mfma_f32_16x16x32_bf16 v[104:107], v[24:27], v[112:115], 0
  ds_read_b64_tr_b16 v[42:43], v21 offset:41472
  s_waitcnt lgkmcnt(6)
  v_mfma_f32_16x16x32_bf16 v[104:107], v[28:31], v[120:123], v[104:107]
  ds_read_b64_tr_b16 v[44:45], v21 offset:45056
  s_waitcnt lgkmcnt(5)
  v_mfma_f32_16x16x32_bf16 v[104:107], v[32:35], v[128:131], v[104:107]
  ds_read_b64_tr_b16 v[46:47], v21 offset:45568
  v_mfma_f32_16x16x32_bf16 v[108:111], v[24:27], v[116:119], 0
  v_xor_b32 v20, 64, v22
  ds_read_b64_tr_b16 v[24:25], v20 offset:0
  v_mfma_f32_16x16x32_bf16 v[108:111], v[28:31], v[124:127], v[108:111]
  ds_read_b64_tr_b16 v[26:27], v20 offset:512
  v_mfma_f32_16x16x32_bf16 v[108:111], v[32:35], v[132:135], v[108:111]
  ds_read_b64_tr_b16 v[28:29], v20 offset:4096
  s_waitcnt lgkmcnt(7)
  v_mfma_f32_16x16x32_bf16 v[108:111], v[36:39], v[140:143], v[108:111]
  ds_read_b64_tr_b16 v[30:31], v20 offset:4608
  s_waitcnt lgkmcnt(6)
  v_mfma_f32_16x16x32_bf16 v[108:111], v[40:43], v[148:151], v[108:111]
  ds_read_b64_tr_b16 v[32:33], v20 offset:8192
  s_waitcnt lgkmcnt(5)
  v_mfma_f32_16x16x32_bf16 v[108:111], v[44:47], v[156:159], v[108:111]
  ds_read_b64_tr_b16 v[34:35], v20 offset:8704
  v_mfma_f32_16x16x32_bf16 v[104:107], v[36:39], v[136:139], v[104:107]
  ds_read_b64_tr_b16 v[36:37], v20 offset:12288
  v_mfma_f32_16x16x32_bf16 v[104:107], v[40:43], v[144:147], v[104:107]
  ds_read_b64_tr_b16 v[38:39], v20 offset:12800
  v_mfma_f32_16x16x32_bf16 v[104:107], v[44:47], v[152:155], v[104:107]
  ds_read_b64_tr_b16 v[40:41], v20 offset:16384
  v_mul_f32 v80, v3, v80
  v_mul_f32 v81, v3, v81
  v_mul_f32 v82, v3, v82
  v_mul_f32 v83, v3, v83
  v_cvt_pk_bf16_f32 v12, v80, v81
  v_cvt_pk_bf16_f32 v13, v82, v83
  v_mul_f32 v84, v3, v84
  v_mul_f32 v85, v3, v85
  v_mul_f32 v86, v3, v86
  v_mul_f32 v87, v3, v87
  v_cvt_pk_bf16_f32 v14, v84, v85
  v_cvt_pk_bf16_f32 v15, v86, v87
  buffer_store_dwordx4 v[12:15], v5, s[44:47], s82 offen offset:512 sc1
  v_mul_f32 v88, s95, v88
  v_mul_f32 v89, s95, v89
  v_mul_f32 v90, s95, v90
  v_mul_f32 v91, s95, v91
  v_cvt_pk_bf16_f32 v16, v88, v89
  v_cvt_pk_bf16_f32 v17, v90, v91
  v_mul_f32 v92, s95, v92
  v_mul_f32 v93, s95, v93
  v_mul_f32 v94, s95, v94
  v_mul_f32 v95, s95, v95
  v_cvt_pk_bf16_f32 v18, v92, v93
  v_cvt_pk_bf16_f32 v19, v94, v95
  buffer_store_dwordx4 v[16:19], v6, s[44:47], s82 offen offset:768 sc1
  s_waitcnt lgkmcnt(7)
  v_mfma_f32_16x16x32_bf16 v[80:83], v[24:27], v[112:115], 0
  ds_read_b64_tr_b16 v[42:43], v20 offset:16896
  s_waitcnt lgkmcnt(6)
  v_mfma_f32_16x16x32_bf16 v[80:83], v[28:31], v[120:123], v[80:83]
  ds_read_b64_tr_b16 v[44:45], v20 offset:20480
  s_waitcnt lgkmcnt(5)
  v_mfma_f32_16x16x32_bf16 v[80:83], v[32:35], v[128:131], v[80:83]
  ds_read_b64_tr_b16 v[46:47], v20 offset:20992
  v_mfma_f32_16x16x32_bf16 v[84:87], v[24:27], v[116:119], 0
  ds_read_b64_tr_b16 v[24:25], v20 offset:24576
  v_mfma_f32_16x16x32_bf16 v[84:87], v[28:31], v[124:127], v[84:87]
  ds_read_b64_tr_b16 v[26:27], v20 offset:25088
  v_mfma_f32_16x16x32_bf16 v[84:87], v[32:35], v[132:135], v[84:87]
  ds_read_b64_tr_b16 v[28:29], v20 offset:28672
  s_waitcnt lgkmcnt(7)
  v_mfma_f32_16x16x32_bf16 v[84:87], v[36:39], v[140:143], v[84:87]
  ds_read_b64_tr_b16 v[30:31], v20 offset:29184
  s_waitcnt lgkmcnt(6)
  v_mfma_f32_16x16x32_bf16 v[84:87], v[40:43], v[148:151], v[84:87]
  ds_read_b64_tr_b16 v[32:33], v20 offset:32768
  s_waitcnt lgkmcnt(5)
  v_mfma_f32_16x16x32_bf16 v[84:87], v[44:47], v[156:159], v[84:87]
  ds_read_b64_tr_b16 v[34:35], v20 offset:33280
  v_mfma_f32_16x16x32_bf16 v[80:83], v[36:39], v[136:139], v[80:83]
  ds_read_b64_tr_b16 v[36:37], v20 offset:36864
  v_mfma_f32_16x16x32_bf16 v[80:83], v[40:43], v[144:147], v[80:83]
  ds_read_b64_tr_b16 v[38:39], v20 offset:37376
  v_mfma_f32_16x16x32_bf16 v[80:83], v[44:47], v[152:155], v[80:83]
  ds_read_b64_tr_b16 v[40:41], v20 offset:40960
  s_waitcnt lgkmcnt(7)
  v_mfma_f32_16x16x32_bf16 v[88:91], v[24:27], v[112:115], 0
  ds_read_b64_tr_b16 v[42:43], v20 offset:41472
  s_waitcnt lgkmcnt(6)
  v_mfma_f32_16x16x32_bf16 v[88:91], v[28:31], v[120:123], v[88:91]
  ds_read_b64_tr_b16 v[44:45], v20 offset:45056
  s_waitcnt lgkmcnt(5)
  v_mfma_f32_16x16x32_bf16 v[88:91], v[32:35], v[128:131], v[88:91]
  ds_read_b64_tr_b16 v[46:47], v20 offset:45568
  v_mfma_f32_16x16x32_bf16 v[92:95], v[24:27], v[116:119], 0
  v_xor_b32 v21, 0, v22
  ds_read_b64_tr_b16 v[24:25], v21 offset:0
  v_mfma_f32_16x16x32_bf16 v[92:95], v[28:31], v[124:127], v[92:95]
  ds_read_b64_tr_b16 v[26:27], v21 offset:512
  v_mfma_f32_16x16x32_bf16 v[92:95], v[32:35], v[132:135], v[92:95]
  ds_read_b64_tr_b16 v[28:29], v21 offset:4096
  s_waitcnt lgkmcnt(7)
  v_mfma_f32_16x16x32_bf16 v[92:95], v[36:39], v[140:143], v[92:95]
  ds_read_b64_tr_b16 v[30:31], v21 offset:4608
  s_waitcnt lgkmcnt(6)
  v_mfma_f32_16x16x32_bf16 v[92:95], v[40:43], v[148:151], v[92:95]
  ds_read_b64_tr_b16 v[32:33], v21 offset:8192
  s_waitcnt lgkmcnt(5)
  v_mfma_f32_16x16x32_bf16 v[92:95], v[44:47], v[156:159], v[92:95]
  ds_read_b64_tr_b16 v[34:35], v21 offset:8704
  v_mfma_f32_16x16x32_bf16 v[88:91], v[36:39], v[136:139], v[88:91]
  ds_read_b64_tr_b16 v[36:37], v21 offset:12288
  v_mfma_f32_16x16x32_bf16 v[88:91], v[40:43], v[144:147], v[88:91]
  ds_read_b64_tr_b16 v[38:39], v21 offset:12800
  v_mfma_f32_16x16x32_bf16 v[88:91], v[44:47], v[152:155], v[88:91]
  ds_read_b64_tr_b16 v[40:41], v21 offset:16384
  v_mul_f32 v56, v48, v56
  v_mul_f32 v57, v49, v57
  v_mul_f32 v58, v50, v58
  v_mul_f32 v59, v51, v59
  v_fma_f32 v8, v48, v48, s76
  v_fma_f32 v9, v49, v49, s76
  v_fma_f32 v10, v50, v50, s76
  v_fma_f32 v11, v51, v51, s76
  v_mul_f32 v48, s77, v48
  v_mul_f32 v49, s77, v49
  v_mul_f32 v50, s77, v50
  v_mul_f32 v51, s77, v51
  v_mul_f32 v8, v8, v48
  v_mul_f32 v9, v9, v49
  v_mul_f32 v10, v10, v50
  v_mul_f32 v11, v11, v51
  v_exp_f32 v8, v8
  v_exp_f32 v9, v9
  v_exp_f32 v10, v10
  v_exp_f32 v11, v11
  v_add_f32 v8, 1.0, v8
  v_add_f32 v9, 1.0, v9
  v_add_f32 v10, 1.0, v10
  v_add_f32 v11, 1.0, v11
  v_rcp_f32 v8, v8
  v_rcp_f32 v9, v9
  v_rcp_f32 v10, v10
  v_rcp_f32 v11, v11
  v_mul_f32 v8, v8, v56
  v_mul_f32 v9, v9, v57
  v_mul_f32 v10, v10, v58
  v_mul_f32 v11, v11, v59
  v_cvt_pk_bf16_f32 v12, v8, v9
  v_cvt_pk_bf16_f32 v13, v10, v11
  v_mul_f32 v60, v52, v60
  v_mul_f32 v61, v53, v61
  v_mul_f32 v62, v54, v62
  v_mul_f32 v63, v55, v63
  v_fma_f32 v8, v52, v52, s76
  v_fma_f32 v9, v53, v53, s76
  v_fma_f32 v10, v54, v54, s76
  v_fma_f32 v11, v55, v55, s76
  v_mul_f32 v52, s77, v52
  v_mul_f32 v53, s77, v53
  v_mul_f32 v54, s77, v54
  v_mul_f32 v55, s77, v55
  v_mul_f32 v8, v8, v52
  v_mul_f32 v9, v9, v53
  v_mul_f32 v10, v10, v54
  v_mul_f32 v11, v11, v55
  v_exp_f32 v8, v8
  v_exp_f32 v9, v9
  v_exp_f32 v10, v10
  v_exp_f32 v11, v11
  v_add_f32 v8, 1.0, v8
  v_add_f32 v9, 1.0, v9
  v_add_f32 v10, 1.0, v10
  v_add_f32 v11, 1.0, v11
  v_rcp_f32 v8, v8
  v_rcp_f32 v9, v9
  v_rcp_f32 v10, v10
  v_rcp_f32 v11, v11
  v_mul_f32 v8, v8, v60
  v_mul_f32 v9, v9, v61
  v_mul_f32 v10, v10, v62
  v_mul_f32 v11, v11, v63
  v_cvt_pk_bf16_f32 v14, v8, v9
  v_cvt_pk_bf16_f32 v15, v10, v11
  v_lshlrev_b32 v8, 4, v0
  v_permlane16_swap_b32 v12, v14
  v_permlane16_swap_b32 v13, v15
  buffer_store_dwordx4 v[12:15], v8, s[44:47], s83 offen sc1
  s_waitcnt lgkmcnt(7)
  v_mfma_f32_16x16x32_bf16 v[48:51], v[24:27], v[112:115], 0
  ds_read_b64_tr_b16 v[42:43], v21 offset:16896
  s_waitcnt lgkmcnt(6)
  v_mfma_f32_16x16x32_bf16 v[48:51], v[28:31], v[120:123], v[48:51]
  ds_read_b64_tr_b16 v[44:45], v21 offset:20480
  s_waitcnt lgkmcnt(5)
  v_mfma_f32_16x16x32_bf16 v[48:51], v[32:35], v[128:131], v[48:51]
  ds_read_b64_tr_b16 v[46:47], v21 offset:20992
  v_mfma_f32_16x16x32_bf16 v[52:55], v[24:27], v[116:119], 0
  ds_read_b64_tr_b16 v[24:25], v21 offset:24576
  v_mfma_f32_16x16x32_bf16 v[52:55], v[28:31], v[124:127], v[52:55]
  ds_read_b64_tr_b16 v[26:27], v21 offset:25088
  v_mfma_f32_16x16x32_bf16 v[52:55], v[32:35], v[132:135], v[52:55]
  ds_read_b64_tr_b16 v[28:29], v21 offset:28672
  s_waitcnt lgkmcnt(7)
  v_mfma_f32_16x16x32_bf16 v[52:55], v[36:39], v[140:143], v[52:55]
  ds_read_b64_tr_b16 v[30:31], v21 offset:29184
  s_waitcnt lgkmcnt(6)
  v_mfma_f32_16x16x32_bf16 v[52:55], v[40:43], v[148:151], v[52:55]
  ds_read_b64_tr_b16 v[32:33], v21 offset:32768
  s_waitcnt lgkmcnt(5)
  v_mfma_f32_16x16x32_bf16 v[52:55], v[44:47], v[156:159], v[52:55]
  ds_read_b64_tr_b16 v[34:35], v21 offset:33280
  v_mfma_f32_16x16x32_bf16 v[48:51], v[36:39], v[136:139], v[48:51]
  ds_read_b64_tr_b16 v[36:37], v21 offset:36864
  v_mfma_f32_16x16x32_bf16 v[48:51], v[40:43], v[144:147], v[48:51]
  ds_read_b64_tr_b16 v[38:39], v21 offset:37376
  v_mfma_f32_16x16x32_bf16 v[48:51], v[44:47], v[152:155], v[48:51]
  ds_read_b64_tr_b16 v[40:41], v21 offset:40960
  s_waitcnt lgkmcnt(7)
  v_mfma_f32_16x16x32_bf16 v[56:59], v[24:27], v[112:115], 0
  ds_read_b64_tr_b16 v[42:43], v21 offset:41472
  s_waitcnt lgkmcnt(6)
  v_mfma_f32_16x16x32_bf16 v[56:59], v[28:31], v[120:123], v[56:59]
  ds_read_b64_tr_b16 v[44:45], v21 offset:45056
  s_waitcnt lgkmcnt(5)
  v_mfma_f32_16x16x32_bf16 v[56:59], v[32:35], v[128:131], v[56:59]
  ds_read_b64_tr_b16 v[46:47], v21 offset:45568
  v_mfma_f32_16x16x32_bf16 v[60:63], v[24:27], v[116:119], 0
  v_xor_b32 v20, 32, v22
  ds_read_b64_tr_b16 v[24:25], v20 offset:0
  v_mfma_f32_16x16x32_bf16 v[60:63], v[28:31], v[124:127], v[60:63]
  ds_read_b64_tr_b16 v[26:27], v20 offset:512
  v_mfma_f32_16x16x32_bf16 v[60:63], v[32:35], v[132:135], v[60:63]
  ds_read_b64_tr_b16 v[28:29], v20 offset:4096
  s_waitcnt lgkmcnt(7)
  v_mfma_f32_16x16x32_bf16 v[60:63], v[36:39], v[140:143], v[60:63]
  ds_read_b64_tr_b16 v[30:31], v20 offset:4608
  s_waitcnt lgkmcnt(6)
  v_mfma_f32_16x16x32_bf16 v[60:63], v[40:43], v[148:151], v[60:63]
  ds_read_b64_tr_b16 v[32:33], v20 offset:8192
  s_waitcnt lgkmcnt(5)
  v_mfma_f32_16x16x32_bf16 v[60:63], v[44:47], v[156:159], v[60:63]
  ds_read_b64_tr_b16 v[34:35], v20 offset:8704
  v_mfma_f32_16x16x32_bf16 v[56:59], v[36:39], v[136:139], v[56:59]
  ds_read_b64_tr_b16 v[36:37], v20 offset:12288
  v_mfma_f32_16x16x32_bf16 v[56:59], v[40:43], v[144:147], v[56:59]
  ds_read_b64_tr_b16 v[38:39], v20 offset:12800
  v_mfma_f32_16x16x32_bf16 v[56:59], v[44:47], v[152:155], v[56:59]
  ds_read_b64_tr_b16 v[40:41], v20 offset:16384
  v_mul_f32 v64, s93, v64
  v_mul_f32 v65, s93, v65
  v_mul_f32 v66, s93, v66
  v_mul_f32 v67, s93, v67
  v_cvt_pk_bf16_f32 v12, v64, v65
  v_cvt_pk_bf16_f32 v13, v66, v67
  v_mul_f32 v68, s93, v68
  v_mul_f32 v69, s93, v69
  v_mul_f32 v70, s93, v70
  v_mul_f32 v71, s93, v71
  v_cvt_pk_bf16_f32 v14, v68, v69
  v_cvt_pk_bf16_f32 v15, v70, v71
  buffer_store_dwordx4 v[12:15], v5, s[44:47], s82 offen offset:0 sc1
  v_mul_f32 v72, v7, v72
  v_mul_f32 v73, v7, v73
  v_mul_f32 v74, v7, v74
  v_mul_f32 v75, v7, v75
  v_cvt_pk_bf16_f32 v16, v72, v73
  v_cvt_pk_bf16_f32 v17, v74, v75
  v_mul_f32 v76, v7, v76
  v_mul_f32 v77, v7, v77
  v_mul_f32 v78, v7, v78
  v_mul_f32 v79, v7, v79
  v_cvt_pk_bf16_f32 v18, v76, v77
  v_cvt_pk_bf16_f32 v19, v78, v79
  buffer_store_dwordx4 v[16:19], v5, s[44:47], s82 offen offset:256 sc1
  s_waitcnt lgkmcnt(7)
  v_mfma_f32_16x16x32_bf16 v[64:67], v[24:27], v[112:115], 0
  ds_read_b64_tr_b16 v[42:43], v20 offset:16896
  s_waitcnt lgkmcnt(6)
  v_mfma_f32_16x16x32_bf16 v[64:67], v[28:31], v[120:123], v[64:67]
  ds_read_b64_tr_b16 v[44:45], v20 offset:20480
  s_waitcnt lgkmcnt(5)
  v_mfma_f32_16x16x32_bf16 v[64:67], v[32:35], v[128:131], v[64:67]
  ds_read_b64_tr_b16 v[46:47], v20 offset:20992
  v_mfma_f32_16x16x32_bf16 v[68:71], v[24:27], v[116:119], 0
  ds_read_b64_tr_b16 v[24:25], v20 offset:24576
  v_mfma_f32_16x16x32_bf16 v[68:71], v[28:31], v[124:127], v[68:71]
  ds_read_b64_tr_b16 v[26:27], v20 offset:25088
  v_mfma_f32_16x16x32_bf16 v[68:71], v[32:35], v[132:135], v[68:71]
  ds_read_b64_tr_b16 v[28:29], v20 offset:28672
  s_waitcnt lgkmcnt(7)
  v_mfma_f32_16x16x32_bf16 v[68:71], v[36:39], v[140:143], v[68:71]
  ds_read_b64_tr_b16 v[30:31], v20 offset:29184
  s_waitcnt lgkmcnt(6)
  v_mfma_f32_16x16x32_bf16 v[68:71], v[40:43], v[148:151], v[68:71]
  ds_read_b64_tr_b16 v[32:33], v20 offset:32768
  s_waitcnt lgkmcnt(5)
  v_mfma_f32_16x16x32_bf16 v[68:71], v[44:47], v[156:159], v[68:71]
  ds_read_b64_tr_b16 v[34:35], v20 offset:33280
  v_mfma_f32_16x16x32_bf16 v[64:67], v[36:39], v[136:139], v[64:67]
  ds_read_b64_tr_b16 v[36:37], v20 offset:36864
  v_mfma_f32_16x16x32_bf16 v[64:67], v[40:43], v[144:147], v[64:67]
  ds_read_b64_tr_b16 v[38:39], v20 offset:37376
  v_mfma_f32_16x16x32_bf16 v[64:67], v[44:47], v[152:155], v[64:67]
  ds_read_b64_tr_b16 v[40:41], v20 offset:40960
  s_waitcnt lgkmcnt(7)
  v_mfma_f32_16x16x32_bf16 v[72:75], v[24:27], v[112:115], 0
  ds_read_b64_tr_b16 v[42:43], v20 offset:41472
  s_waitcnt lgkmcnt(6)
  v_mfma_f32_16x16x32_bf16 v[72:75], v[28:31], v[120:123], v[72:75]
  ds_read_b64_tr_b16 v[44:45], v20 offset:45056
  s_waitcnt lgkmcnt(5)
  v_mfma_f32_16x16x32_bf16 v[72:75], v[32:35], v[128:131], v[72:75]
  ds_read_b64_tr_b16 v[46:47], v20 offset:45568
  s_cmp_lt_u32 s56, 4
  s_cbranch_scc1 gated_mix__softmax_full_mha__geglu_ffn__prompt_kernel_l21
  v_mfma_f32_16x16x32_bf16 v[76:79], v[24:27], v[116:119], 0
  v_mfma_f32_16x16x32_bf16 v[76:79], v[28:31], v[124:127], v[76:79]
  v_mfma_f32_16x16x32_bf16 v[76:79], v[32:35], v[132:135], v[76:79]
  s_waitcnt lgkmcnt(4)
  v_mfma_f32_16x16x32_bf16 v[76:79], v[36:39], v[140:143], v[76:79]
  s_waitcnt lgkmcnt(2)
  v_mfma_f32_16x16x32_bf16 v[76:79], v[40:43], v[148:151], v[76:79]
  s_waitcnt lgkmcnt(0)
  v_mfma_f32_16x16x32_bf16 v[76:79], v[44:47], v[156:159], v[76:79]
  s_waitcnt vmcnt(19)
  s_waitcnt lgkmcnt(0)
  s_barrier
  v_mfma_f32_16x16x32_bf16 v[72:75], v[36:39], v[136:139], v[72:75]
  v_mfma_f32_16x16x32_bf16 v[72:75], v[40:43], v[144:147], v[72:75]
  v_mfma_f32_16x16x32_bf16 v[72:75], v[44:47], v[152:155], v[72:75]
  s_cmp_ge_u32 s84, 9
  s_cselect_b32 s63, s96, s67
  s_add_u32 m0, s85, 0
  s_add_u32 s63, s63, 128
  buffer_load_dwordx4 v2, s[32:35], s63 offen lds
  s_cmp_ge_u32 s84, 9
  s_cselect_b32 s63, s96, s67
  s_add_u32 m0, s85, 24576
  s_add_u32 s63, s63, 128
  buffer_load_dwordx4 v2, s[36:39], s63 offen lds
  s_cmp_ge_u32 s84, 8
  s_cselect_b32 s63, s96, s67
  s_add_u32 m0, s85, 8192
  s_add_u32 s63, s63, 589952
  buffer_load_dwordx4 v2, s[32:35], s63 offen lds
  s_cmp_ge_u32 s84, 8
  s_cselect_b32 s63, s96, s67
  s_add_u32 m0, s85, 32768
  s_add_u32 s63, s63, 589952
  buffer_load_dwordx4 v2, s[36:39], s63 offen lds
  s_cmp_ge_u32 s84, 7
  s_cselect_b32 s63, s96, s67
  s_add_u32 m0, s85, 16384
  s_add_u32 s63, s63, 1179776
  buffer_load_dwordx4 v2, s[32:35], s63 offen lds
  s_cmp_ge_u32 s84, 7
  s_cselect_b32 s63, s96, s67
  s_add_u32 m0, s85, 40960
  s_add_u32 s63, s63, 1179776
  buffer_load_dwordx4 v2, s[36:39], s63 offen lds
  v_lshrrev_b32 v8, 5, v0
  v_bfe_u32 v9, v0, 2, 2
  v_lshl_add_u32 v8, v8, 2, v9
  v_mul_u32_u24 v8, 288, v8
  v_add_u32 v8, s81, v8
  v_and_b32 v9, 1, v0
  v_lshl_add_u32 v10, v9, 5, v8
  v_bfe_u32 v9, v0, 1, 1
  v_lshl_add_u32 v10, v9, 3, v10
  v_and_b32 v9, 3, v0
  v_lshl_add_u32 v8, v9, 3, v8
  v_bfe_u32 v9, v0, 4, 1
  v_lshl_add_u32 v10, v9, 4, v10
  v_mul_u32_u24 v11, 144, v9
  v_add_u32 v11, v11, v8
  s_waitcnt vmcnt(11)
  ds_read_b64_tr_b16 v[24:25], v10 offset:0
  ds_read_b64_tr_b16 v[26:27], v10 offset:2304
  ds_read_b64_tr_b16 v[28:29], v10 offset:64
  ds_read_b64_tr_b16 v[30:31], v10 offset:2368
  ds_read_b64_tr_b16 v[32:33], v10 offset:144
  ds_read_b64_tr_b16 v[34:35], v10 offset:2448
  ds_read_b64_tr_b16 v[36:37], v10 offset:208
  ds_read_b64_tr_b16 v[38:39], v10 offset:2512
  ds_read_b64_tr_b16 v[40:41], v11 offset:128
  ds_read_b64_tr_b16 v[42:43], v11 offset:2432
  v_mul_lo_u32 v9, v9, s91
  v_lshrrev_b32 v8, 5, v0
  v_lshl_add_u32 v9, v8, 7, v9
  v_and_b32 v8, 15, v0
  v_lshl_add_u32 v9, v8, 4, v9
  v_cmp_gt_u32 vcc, 8, v8
  v_mov_b32 v8, 2147483648
  s_nop 0
  v_cndmask_b32 v9, v8, v9, vcc
  v_lshlrev_b32 v8, 4, v0
  s_cmp_eq_u32 s92, 0
  s_cselect_b32 s63, 2147483648, 0
  v_or_b32 v8, s63, v8
  v_or_b32 v9, s63, v9
  s_add_u32 s63, s90, s91
  s_waitcnt lgkmcnt(0)
  buffer_store_dwordx4 v[24:27], v8, s[44:47], s90 offen offset:0 sc1
  buffer_store_dwordx4 v[28:31], v8, s[44:47], s90 offen offset:1024 sc1
  buffer_store_dwordx4 v[32:35], v8, s[44:47], s63 offen offset:0 sc1
  buffer_store_dwordx4 v[36:39], v8, s[44:47], s63 offen offset:1024 sc1
  buffer_store_dwordx4 v[40:43], v9, s[44:47], s90 offen offset:2048 sc1
  s_and_b32 s66, s56, 3
  s_add_u32 s66, s66, 3
  s_mul_i32 s64, s57, 36
  s_lshl_b32 s63, s59, 2
  s_add_u32 s63, s63, s66
  s_add_u32 s63, s63, s64
  s_movk_i32 s92, 0x77
  s_add_u32 s64, s64, s59
  s_add_u32 s64, s64, 32
  s_lshl_b32 s65, s57, 2
  s_add_u32 s65, s65, s59
  s_add_u32 s65, s65, 284
  s_cmp_lt_u32 s59, 4
  s_cselect_b32 s64, s64, s65
  s_cmp_eq_u32 s66, 4
  s_cselect_b32 s63, s64, s63
  s_add_u32 s64, s57, 320
  s_cmp_eq_u32 s66, 5
  s_cselect_b32 s63, s64, s63
  s_lshl_b32 s64, s59, 3
  s_add_u32 s64, s64, s57
  s_cmp_lt_u32 s64, 4
  s_cselect_b32 s92, s92, 0x30
  s_bitcmp1_b32 s92, s56
  s_cselect_b32 s92, 1, 0
  s_mov_b32 s64, s58
  s_mov_b32 s75, 0x00020000
  s_lshr_b32 s65, s63, 2
  s_mul_i32 s66, s65, 57
  s_lshr_b32 s66, s66, 9
  s_mul_i32 s66, s66, 9
  s_sub_u32 s66, s65, s66
  s_lshr_b32 s86, s63, 1
  s_lshl_b32 s86, s86, 5
  s_and_b32 s65, s63, 1
  s_lshl_b32 s65, s65, 3
  s_add_u32 s86, s86, s65
  s_lshl_b32 s65, s63, 4
  s_cmp_eq_u32 s66, 8
  s_cselect_b32 s86, s65, s86
  s_cselect_b32 s87, 4, 16
  s_cselect_b32 s88, 8, 4
  s_mov_b32 s89, 2
  s_mul_i32 s90, s64, 576
  s_add_u32 s90, s90, s63
  s_mul_i32 s90, s90, 2304
  s_add_u32 s90, s90, 18874368
  s_mov_b32 s91, 663552
  s_mov_b32 s72, s16
  s_and_b32 s73, s17, 0xffff
  s_mov_b32 s74, 5308416
  s_cmp_lt_u32 s63, 288
  s_cbranch_scc1 gated_mix__softmax_full_mha__geglu_ffn__prompt_kernel_l23
  s_sub_u32 s63, s63, 288
  s_mul_i32 s90, s64, 72
  s_add_u32 s90, s90, s63
  s_mul_i32 s90, s90, 2304
  s_add_u32 s90, s90, 24182784
  s_mov_b32 s91, 82944
  s_mov_b32 s72, s8
  s_and_b32 s73, s9, 0xffff
  s_mov_b32 s74, 663552
  s_mul_i32 s86, s63, 18
  s_sub_u32 s65, s63, 32
  s_mul_i32 s65, s65, 144
  s_add_u32 s65, s65, 16
  s_cmp_lt_u32 s63, 32
  s_cselect_b32 s86, s86, s65
  s_cselect_b32 s87, 4, 36
  s_cselect_b32 s88, 8, 72
  s_cselect_b32 s89, 2, 18
gated_mix__softmax_full_mha__geglu_ffn__prompt_kernel_l23:
  s_mul_i32 s86, s86, 1152
  s_mul_i32 s64, s64, 288
  s_add_u32 s86, s86, s64
  s_mul_i32 s87, s87, 1152
  s_mul_i32 s88, s88, 1152
  s_mul_i32 s89, s89, 1152
  s_cmp_eq_u32 s92, 0
  s_cselect_b32 s74, 0, s74
  s_cselect_b32 s90, 0, s90
  s_and_b32 s81, s56, 3
  s_mul_i32 s81, s81, 4608
  s_add_u32 s81, s81, 147456
  v_lshlrev_b32 v8, 4, v0
  v_add_u32 v9, 864, v8
  v_cmp_gt_u32 vcc, 18, v0
  s_nop 1
  v_cndmask_b32 v8, v9, v8, vcc
  s_mov_b32 exec_hi, 15
  s_mov_b32 s63, s86
  s_add_u32 m0, s81, 0
  s_nop 0
  buffer_load_dwordx4 v8, s[72:75], s63 offen lds
  s_mov_b32 s63, s86
  s_add_u32 s63, s63, s89
  s_add_u32 m0, s81, 576
  s_nop 0
  buffer_load_dwordx4 v8, s[72:75], s63 offen lds
  s_mov_b32 s63, s86
  s_add_u32 s63, s63, s88
  s_add_u32 m0, s81, 1152
  s_nop 0
  buffer_load_dwordx4 v8, s[72:75], s63 offen lds
  s_mov_b32 s63, s86
  s_add_u32 s63, s63, s89
  s_add_u32 s63, s63, s88
  s_add_u32 m0, s81, 1728
  s_nop 0
  buffer_load_dwordx4 v8, s[72:75], s63 offen lds
  s_mov_b32 s63, s86
  s_add_u32 s63, s63, s87
  s_add_u32 m0, s81, 2304
  s_nop 0
  buffer_load_dwordx4 v8, s[72:75], s63 offen lds
  s_mov_b32 s63, s86
  s_add_u32 s63, s63, s89
  s_add_u32 s63, s63, s87
  s_add_u32 m0, s81, 2880
  s_nop 0
  buffer_load_dwordx4 v8, s[72:75], s63 offen lds
  s_mov_b32 s63, s86
  s_add_u32 s63, s63, s88
  s_add_u32 s63, s63, s87
  s_add_u32 m0, s81, 3456
  s_nop 0
  buffer_load_dwordx4 v8, s[72:75], s63 offen lds
  s_mov_b32 s63, s86
  s_add_u32 s63, s63, s89
  s_add_u32 s63, s63, s88
  s_add_u32 s63, s63, s87
  s_add_u32 m0, s81, 4032
  s_nop 0
  buffer_load_dwordx4 v8, s[72:75], s63 offen lds
  s_mov_b32 exec_hi, -1
  v_lshlrev_b32 v8, 4, v0
  v_lshlrev_b32 v9, 2, v0
  v_cmp_gt_u32 vcc, 32, v0
  v_mov_b32 v10, 2147483648
  s_nop 0
  v_cndmask_b32 v9, v10, v9, vcc
  s_mul_i32 s64, s80, 1152
  buffer_load_dwordx4 v[12:15], v8, s[28:31], s64 offen
  buffer_load_dword v3, v9, s[28:31], s64 offen offset:1024
  buffer_load_dwordx4 v[16:19], v8, s[52:55], 0 offen
  buffer_load_dword v5, v9, s[52:55], 0 offen offset:1024
  v_add_u32 v22, 49152, v1
  v_xor_b32 v21, 96, v22
  ds_read_b64_tr_b16 v[24:25], v21 offset:0
  ds_read_b64_tr_b16 v[26:27], v21 offset:512
  ds_read_b64_tr_b16 v[28:29], v21 offset:4096
  ds_read_b64_tr_b16 v[30:31], v21 offset:4608
  ds_read_b64_tr_b16 v[32:33], v21 offset:8192
  ds_read_b64_tr_b16 v[34:35], v21 offset:8704
  ds_read_b64_tr_b16 v[36:37], v21 offset:12288
  ds_read_b64_tr_b16 v[38:39], v21 offset:12800
  ds_read_b64_tr_b16 v[40:41], v21 offset:16384
  s_branch gated_mix__softmax_full_mha__geglu_ffn__prompt_kernel_l22
gated_mix__softmax_full_mha__geglu_ffn__prompt_kernel_l21:
  s_cmp_ge_u32 s84, 3
  s_cselect_b32 s63, s96, s67
  s_add_u32 m0, s85, 98304
  s_add_u32 s63, s63, 3538944
  buffer_load_dwordx4 v2, s[32:35], s63 offen lds
  s_cmp_ge_u32 s84, 3
  s_cselect_b32 s63, s96, s67
  s_add_u32 m0, s85, 122880
  s_add_u32 s63, s63, 3538944
  buffer_load_dwordx4 v2, s[36:39], s63 offen lds
  s_cmp_ge_u32 s84, 2
  s_cselect_b32 s63, s96, s67
  s_add_u32 m0, s85, 106496
  s_add_u32 s63, s63, 4128768
  buffer_load_dwordx4 v2, s[32:35], s63 offen lds
  s_cmp_ge_u32 s84, 2
  s_cselect_b32 s63, s96, s67
  s_add_u32 m0, s85, 131072
  s_add_u32 s63, s63, 4128768
  buffer_load_dwordx4 v2, s[36:39], s63 offen lds
  s_cmp_ge_u32 s84, 1
  s_cselect_b32 s63, s96, s67
  s_add_u32 m0, s85, 114688
  s_add_u32 s63, s63, 4718592
  buffer_load_dwordx4 v2, s[32:35], s63 offen lds
  s_cmp_ge_u32 s84, 1
  s_cselect_b32 s63, s96, s67
  s_add_u32 m0, s85, 139264
  s_add_u32 s63, s63, 4718592
  buffer_load_dwordx4 v2, s[36:39], s63 offen lds
  v_lshlrev_b32 v8, 4, v0
  v_lshlrev_b32 v9, 2, v0
  v_cmp_gt_u32 vcc, 32, v0
  v_mov_b32 v10, 2147483648
  s_nop 0
  v_cndmask_b32 v9, v10, v9, vcc
  s_mul_i32 s64, s80, 1152
  buffer_load_dwordx4 v[12:15], v8, s[28:31], s64 offen
  buffer_load_dword v3, v9, s[28:31], s64 offen offset:1024
  buffer_load_dwordx4 v[16:19], v8, s[52:55], 0 offen
  buffer_load_dword v5, v9, s[52:55], 0 offen offset:1024
  v_add_u32 v22, 49152, v1
  s_waitcnt vmcnt(15)
  s_waitcnt lgkmcnt(0)
  s_barrier
  v_mfma_f32_16x16x32_bf16 v[76:79], v[24:27], v[116:119], 0
  v_xor_b32 v21, 96, v22
  ds_read_b64_tr_b16 v[24:25], v21 offset:0
  ds_read_b64_tr_b16 v[26:27], v21 offset:512
  v_mfma_f32_16x16x32_bf16 v[76:79], v[28:31], v[124:127], v[76:79]
  ds_read_b64_tr_b16 v[28:29], v21 offset:4096
  ds_read_b64_tr_b16 v[30:31], v21 offset:4608
  v_mfma_f32_16x16x32_bf16 v[76:79], v[32:35], v[132:135], v[76:79]
  ds_read_b64_tr_b16 v[32:33], v21 offset:8192
  ds_read_b64_tr_b16 v[34:35], v21 offset:8704
  v_mfma_f32_16x16x32_bf16 v[76:79], v[36:39], v[140:143], v[76:79]
  v_mfma_f32_16x16x32_bf16 v[76:79], v[40:43], v[148:151], v[76:79]
  v_mfma_f32_16x16x32_bf16 v[76:79], v[44:47], v[156:159], v[76:79]
  v_mfma_f32_16x16x32_bf16 v[72:75], v[36:39], v[136:139], v[72:75]
  ds_read_b64_tr_b16 v[36:37], v21 offset:12288
  ds_read_b64_tr_b16 v[38:39], v21 offset:12800
  v_mfma_f32_16x16x32_bf16 v[72:75], v[40:43], v[144:147], v[72:75]
  ds_read_b64_tr_b16 v[40:41], v21 offset:16384
  v_mfma_f32_16x16x32_bf16 v[72:75], v[44:47], v[152:155], v[72:75]
gated_mix__softmax_full_mha__geglu_ffn__prompt_kernel_l22:
  s_waitcnt lgkmcnt(7)
  v_mfma_f32_16x16x32_bf16 v[96:99], v[24:27], v[160:163], v[96:99]
  ds_read_b64_tr_b16 v[42:43], v21 offset:16896
  s_waitcnt lgkmcnt(6)
  v_mfma_f32_16x16x32_bf16 v[96:99], v[28:31], v[168:171], v[96:99]
  ds_read_b64_tr_b16 v[44:45], v21 offset:20480
  s_waitcnt lgkmcnt(5)
  v_mfma_f32_16x16x32_bf16 v[96:99], v[32:35], v[176:179], v[96:99]
  ds_read_b64_tr_b16 v[46:47], v21 offset:20992
  v_mfma_f32_16x16x32_bf16 v[100:103], v[24:27], v[164:167], v[100:103]
  ds_read_b64_tr_b16 v[24:25], v21 offset:24576
  v_mfma_f32_16x16x32_bf16 v[100:103], v[28:31], v[172:175], v[100:103]
  ds_read_b64_tr_b16 v[26:27], v21 offset:25088
  v_mfma_f32_16x16x32_bf16 v[100:103], v[32:35], v[180:183], v[100:103]
  ds_read_b64_tr_b16 v[28:29], v21 offset:28672
  s_waitcnt lgkmcnt(7)
  v_mfma_f32_16x16x32_bf16 v[100:103], v[36:39], v[188:191], v[100:103]
  ds_read_b64_tr_b16 v[30:31], v21 offset:29184
  s_waitcnt lgkmcnt(6)
  v_mfma_f32_16x16x32_bf16 v[100:103], v[40:43], v[196:199], v[100:103]
  ds_read_b64_tr_b16 v[32:33], v21 offset:32768
  s_waitcnt lgkmcnt(5)
  v_mfma_f32_16x16x32_bf16 v[100:103], v[44:47], v[204:207], v[100:103]
  ds_read_b64_tr_b16 v[34:35], v21 offset:33280
  v_mfma_f32_16x16x32_bf16 v[96:99], v[36:39], v[184:187], v[96:99]
  ds_read_b64_tr_b16 v[36:37], v21 offset:36864
  v_mfma_f32_16x16x32_bf16 v[96:99], v[40:43], v[192:195], v[96:99]
  ds_read_b64_tr_b16 v[38:39], v21 offset:37376
  v_mfma_f32_16x16x32_bf16 v[96:99], v[44:47], v[200:203], v[96:99]
  ds_read_b64_tr_b16 v[40:41], v21 offset:40960
  s_waitcnt lgkmcnt(7)
  v_mfma_f32_16x16x32_bf16 v[104:107], v[24:27], v[160:163], v[104:107]
  ds_read_b64_tr_b16 v[42:43], v21 offset:41472
  s_waitcnt lgkmcnt(6)
  v_mfma_f32_16x16x32_bf16 v[104:107], v[28:31], v[168:171], v[104:107]
  ds_read_b64_tr_b16 v[44:45], v21 offset:45056
  s_waitcnt lgkmcnt(5)
  v_mfma_f32_16x16x32_bf16 v[104:107], v[32:35], v[176:179], v[104:107]
  ds_read_b64_tr_b16 v[46:47], v21 offset:45568
  v_mfma_f32_16x16x32_bf16 v[108:111], v[24:27], v[164:167], v[108:111]
  v_xor_b32 v20, 64, v22
  ds_read_b64_tr_b16 v[24:25], v20 offset:0
  v_mfma_f32_16x16x32_bf16 v[108:111], v[28:31], v[172:175], v[108:111]
  ds_read_b64_tr_b16 v[26:27], v20 offset:512
  v_mfma_f32_16x16x32_bf16 v[108:111], v[32:35], v[180:183], v[108:111]
  ds_read_b64_tr_b16 v[28:29], v20 offset:4096
  s_waitcnt lgkmcnt(7)
  v_mfma_f32_16x16x32_bf16 v[108:111], v[36:39], v[188:191], v[108:111]
  ds_read_b64_tr_b16 v[30:31], v20 offset:4608
  s_waitcnt lgkmcnt(6)
  v_mfma_f32_16x16x32_bf16 v[108:111], v[40:43], v[196:199], v[108:111]
  ds_read_b64_tr_b16 v[32:33], v20 offset:8192
  s_waitcnt lgkmcnt(5)
  v_mfma_f32_16x16x32_bf16 v[108:111], v[44:47], v[204:207], v[108:111]
  ds_read_b64_tr_b16 v[34:35], v20 offset:8704
  v_mfma_f32_16x16x32_bf16 v[104:107], v[36:39], v[184:187], v[104:107]
  ds_read_b64_tr_b16 v[36:37], v20 offset:12288
  v_mfma_f32_16x16x32_bf16 v[104:107], v[40:43], v[192:195], v[104:107]
  ds_read_b64_tr_b16 v[38:39], v20 offset:12800
  v_mfma_f32_16x16x32_bf16 v[104:107], v[44:47], v[200:203], v[104:107]
  ds_read_b64_tr_b16 v[40:41], v20 offset:16384
  s_waitcnt lgkmcnt(7)
  v_mfma_f32_16x16x32_bf16 v[80:83], v[24:27], v[160:163], v[80:83]
  ds_read_b64_tr_b16 v[42:43], v20 offset:16896
  s_waitcnt lgkmcnt(6)
  v_mfma_f32_16x16x32_bf16 v[80:83], v[28:31], v[168:171], v[80:83]
  ds_read_b64_tr_b16 v[44:45], v20 offset:20480
  s_waitcnt lgkmcnt(5)
  v_mfma_f32_16x16x32_bf16 v[80:83], v[32:35], v[176:179], v[80:83]
  ds_read_b64_tr_b16 v[46:47], v20 offset:20992
  v_mfma_f32_16x16x32_bf16 v[84:87], v[24:27], v[164:167], v[84:87]
  ds_read_b64_tr_b16 v[24:25], v20 offset:24576
  v_mfma_f32_16x16x32_bf16 v[84:87], v[28:31], v[172:175], v[84:87]
  ds_read_b64_tr_b16 v[26:27], v20 offset:25088
  v_mfma_f32_16x16x32_bf16 v[84:87], v[32:35], v[180:183], v[84:87]
  ds_read_b64_tr_b16 v[28:29], v20 offset:28672
  s_waitcnt lgkmcnt(7)
  v_mfma_f32_16x16x32_bf16 v[84:87], v[36:39], v[188:191], v[84:87]
  ds_read_b64_tr_b16 v[30:31], v20 offset:29184
  s_waitcnt lgkmcnt(6)
  v_mfma_f32_16x16x32_bf16 v[84:87], v[40:43], v[196:199], v[84:87]
  ds_read_b64_tr_b16 v[32:33], v20 offset:32768
  s_waitcnt lgkmcnt(5)
  v_mfma_f32_16x16x32_bf16 v[84:87], v[44:47], v[204:207], v[84:87]
  ds_read_b64_tr_b16 v[34:35], v20 offset:33280
  v_mfma_f32_16x16x32_bf16 v[80:83], v[36:39], v[184:187], v[80:83]
  ds_read_b64_tr_b16 v[36:37], v20 offset:36864
  v_mfma_f32_16x16x32_bf16 v[80:83], v[40:43], v[192:195], v[80:83]
  ds_read_b64_tr_b16 v[38:39], v20 offset:37376
  v_mfma_f32_16x16x32_bf16 v[80:83], v[44:47], v[200:203], v[80:83]
  ds_read_b64_tr_b16 v[40:41], v20 offset:40960
  s_waitcnt lgkmcnt(7)
  v_mfma_f32_16x16x32_bf16 v[88:91], v[24:27], v[160:163], v[88:91]
  ds_read_b64_tr_b16 v[42:43], v20 offset:41472
  s_waitcnt lgkmcnt(6)
  v_mfma_f32_16x16x32_bf16 v[88:91], v[28:31], v[168:171], v[88:91]
  ds_read_b64_tr_b16 v[44:45], v20 offset:45056
  s_waitcnt lgkmcnt(5)
  v_mfma_f32_16x16x32_bf16 v[88:91], v[32:35], v[176:179], v[88:91]
  ds_read_b64_tr_b16 v[46:47], v20 offset:45568
  v_mfma_f32_16x16x32_bf16 v[92:95], v[24:27], v[164:167], v[92:95]
  v_xor_b32 v21, 0, v22
  ds_read_b64_tr_b16 v[24:25], v21 offset:0
  v_mfma_f32_16x16x32_bf16 v[92:95], v[28:31], v[172:175], v[92:95]
  ds_read_b64_tr_b16 v[26:27], v21 offset:512
  v_mfma_f32_16x16x32_bf16 v[92:95], v[32:35], v[180:183], v[92:95]
  ds_read_b64_tr_b16 v[28:29], v21 offset:4096
  s_waitcnt lgkmcnt(7)
  v_mfma_f32_16x16x32_bf16 v[92:95], v[36:39], v[188:191], v[92:95]
  ds_read_b64_tr_b16 v[30:31], v21 offset:4608
  s_waitcnt lgkmcnt(6)
  v_mfma_f32_16x16x32_bf16 v[92:95], v[40:43], v[196:199], v[92:95]
  ds_read_b64_tr_b16 v[32:33], v21 offset:8192
  s_waitcnt lgkmcnt(5)
  v_mfma_f32_16x16x32_bf16 v[92:95], v[44:47], v[204:207], v[92:95]
  ds_read_b64_tr_b16 v[34:35], v21 offset:8704
  v_mfma_f32_16x16x32_bf16 v[88:91], v[36:39], v[184:187], v[88:91]
  ds_read_b64_tr_b16 v[36:37], v21 offset:12288
  v_mfma_f32_16x16x32_bf16 v[88:91], v[40:43], v[192:195], v[88:91]
  ds_read_b64_tr_b16 v[38:39], v21 offset:12800
  v_mfma_f32_16x16x32_bf16 v[88:91], v[44:47], v[200:203], v[88:91]
  ds_read_b64_tr_b16 v[40:41], v21 offset:16384
  s_waitcnt lgkmcnt(7)
  v_mfma_f32_16x16x32_bf16 v[48:51], v[24:27], v[160:163], v[48:51]
  ds_read_b64_tr_b16 v[42:43], v21 offset:16896
  s_waitcnt lgkmcnt(6)
  v_mfma_f32_16x16x32_bf16 v[48:51], v[28:31], v[168:171], v[48:51]
  ds_read_b64_tr_b16 v[44:45], v21 offset:20480
  s_waitcnt lgkmcnt(5)
  v_mfma_f32_16x16x32_bf16 v[48:51], v[32:35], v[176:179], v[48:51]
  ds_read_b64_tr_b16 v[46:47], v21 offset:20992
  v_mfma_f32_16x16x32_bf16 v[52:55], v[24:27], v[164:167], v[52:55]
  ds_read_b64_tr_b16 v[24:25], v21 offset:24576
  v_mfma_f32_16x16x32_bf16 v[52:55], v[28:31], v[172:175], v[52:55]
  ds_read_b64_tr_b16 v[26:27], v21 offset:25088
  v_mfma_f32_16x16x32_bf16 v[52:55], v[32:35], v[180:183], v[52:55]
  ds_read_b64_tr_b16 v[28:29], v21 offset:28672
  s_waitcnt lgkmcnt(7)
  v_mfma_f32_16x16x32_bf16 v[52:55], v[36:39], v[188:191], v[52:55]
  ds_read_b64_tr_b16 v[30:31], v21 offset:29184
  s_waitcnt lgkmcnt(6)
  v_mfma_f32_16x16x32_bf16 v[52:55], v[40:43], v[196:199], v[52:55]
  ds_read_b64_tr_b16 v[32:33], v21 offset:32768
  s_waitcnt lgkmcnt(5)
  v_mfma_f32_16x16x32_bf16 v[52:55], v[44:47], v[204:207], v[52:55]
  ds_read_b64_tr_b16 v[34:35], v21 offset:33280
  v_mfma_f32_16x16x32_bf16 v[48:51], v[36:39], v[184:187], v[48:51]
  ds_read_b64_tr_b16 v[36:37], v21 offset:36864
  v_mfma_f32_16x16x32_bf16 v[48:51], v[40:43], v[192:195], v[48:51]
  ds_read_b64_tr_b16 v[38:39], v21 offset:37376
  v_mfma_f32_16x16x32_bf16 v[48:51], v[44:47], v[200:203], v[48:51]
  ds_read_b64_tr_b16 v[40:41], v21 offset:40960
  s_waitcnt lgkmcnt(7)
  v_mfma_f32_16x16x32_bf16 v[56:59], v[24:27], v[160:163], v[56:59]
  ds_read_b64_tr_b16 v[42:43], v21 offset:41472
  s_waitcnt lgkmcnt(6)
  v_mfma_f32_16x16x32_bf16 v[56:59], v[28:31], v[168:171], v[56:59]
  ds_read_b64_tr_b16 v[44:45], v21 offset:45056
  s_waitcnt lgkmcnt(5)
  v_mfma_f32_16x16x32_bf16 v[56:59], v[32:35], v[176:179], v[56:59]
  ds_read_b64_tr_b16 v[46:47], v21 offset:45568
  v_mfma_f32_16x16x32_bf16 v[60:63], v[24:27], v[164:167], v[60:63]
  v_xor_b32 v20, 32, v22
  ds_read_b64_tr_b16 v[24:25], v20 offset:0
  v_mfma_f32_16x16x32_bf16 v[60:63], v[28:31], v[172:175], v[60:63]
  ds_read_b64_tr_b16 v[26:27], v20 offset:512
  v_mfma_f32_16x16x32_bf16 v[60:63], v[32:35], v[180:183], v[60:63]
  ds_read_b64_tr_b16 v[28:29], v20 offset:4096
  s_waitcnt lgkmcnt(7)
  v_mfma_f32_16x16x32_bf16 v[60:63], v[36:39], v[188:191], v[60:63]
  ds_read_b64_tr_b16 v[30:31], v20 offset:4608
  s_waitcnt lgkmcnt(6)
  v_mfma_f32_16x16x32_bf16 v[60:63], v[40:43], v[196:199], v[60:63]
  ds_read_b64_tr_b16 v[32:33], v20 offset:8192
  s_waitcnt lgkmcnt(5)
  v_mfma_f32_16x16x32_bf16 v[60:63], v[44:47], v[204:207], v[60:63]
  ds_read_b64_tr_b16 v[34:35], v20 offset:8704
  v_mfma_f32_16x16x32_bf16 v[56:59], v[36:39], v[184:187], v[56:59]
  ds_read_b64_tr_b16 v[36:37], v20 offset:12288
  v_mfma_f32_16x16x32_bf16 v[56:59], v[40:43], v[192:195], v[56:59]
  ds_read_b64_tr_b16 v[38:39], v20 offset:12800
  v_mfma_f32_16x16x32_bf16 v[56:59], v[44:47], v[200:203], v[56:59]
  ds_read_b64_tr_b16 v[40:41], v20 offset:16384
  s_waitcnt lgkmcnt(7)
  v_mfma_f32_16x16x32_bf16 v[64:67], v[24:27], v[160:163], v[64:67]
  ds_read_b64_tr_b16 v[42:43], v20 offset:16896
  s_waitcnt lgkmcnt(6)
  v_mfma_f32_16x16x32_bf16 v[64:67], v[28:31], v[168:171], v[64:67]
  ds_read_b64_tr_b16 v[44:45], v20 offset:20480
  s_waitcnt lgkmcnt(5)
  v_mfma_f32_16x16x32_bf16 v[64:67], v[32:35], v[176:179], v[64:67]
  ds_read_b64_tr_b16 v[46:47], v20 offset:20992
  v_mfma_f32_16x16x32_bf16 v[68:71], v[24:27], v[164:167], v[68:71]
  ds_read_b64_tr_b16 v[24:25], v20 offset:24576
  v_mfma_f32_16x16x32_bf16 v[68:71], v[28:31], v[172:175], v[68:71]
  ds_read_b64_tr_b16 v[26:27], v20 offset:25088
  v_mfma_f32_16x16x32_bf16 v[68:71], v[32:35], v[180:183], v[68:71]
  ds_read_b64_tr_b16 v[28:29], v20 offset:28672
  s_waitcnt lgkmcnt(7)
  v_mfma_f32_16x16x32_bf16 v[68:71], v[36:39], v[188:191], v[68:71]
  ds_read_b64_tr_b16 v[30:31], v20 offset:29184
  s_waitcnt lgkmcnt(6)
  v_mfma_f32_16x16x32_bf16 v[68:71], v[40:43], v[196:199], v[68:71]
  ds_read_b64_tr_b16 v[32:33], v20 offset:32768
  s_waitcnt lgkmcnt(5)
  v_mfma_f32_16x16x32_bf16 v[68:71], v[44:47], v[204:207], v[68:71]
  ds_read_b64_tr_b16 v[34:35], v20 offset:33280
  v_mfma_f32_16x16x32_bf16 v[64:67], v[36:39], v[184:187], v[64:67]
  ds_read_b64_tr_b16 v[36:37], v20 offset:36864
  v_mfma_f32_16x16x32_bf16 v[64:67], v[40:43], v[192:195], v[64:67]
  ds_read_b64_tr_b16 v[38:39], v20 offset:37376
  v_mfma_f32_16x16x32_bf16 v[64:67], v[44:47], v[200:203], v[64:67]
  ds_read_b64_tr_b16 v[40:41], v20 offset:40960
  s_waitcnt lgkmcnt(7)
  v_mfma_f32_16x16x32_bf16 v[72:75], v[24:27], v[160:163], v[72:75]
  ds_read_b64_tr_b16 v[42:43], v20 offset:41472
  s_waitcnt lgkmcnt(6)
  v_mfma_f32_16x16x32_bf16 v[72:75], v[28:31], v[168:171], v[72:75]
  ds_read_b64_tr_b16 v[44:45], v20 offset:45056
  s_waitcnt lgkmcnt(5)
  v_mfma_f32_16x16x32_bf16 v[72:75], v[32:35], v[176:179], v[72:75]
  ds_read_b64_tr_b16 v[46:47], v20 offset:45568
  s_cmp_lt_u32 s56, 4
  s_cbranch_scc1 gated_mix__softmax_full_mha__geglu_ffn__prompt_kernel_l24
  v_mfma_f32_16x16x32_bf16 v[76:79], v[24:27], v[164:167], v[76:79]
  v_mfma_f32_16x16x32_bf16 v[76:79], v[28:31], v[172:175], v[76:79]
  v_mfma_f32_16x16x32_bf16 v[76:79], v[32:35], v[180:183], v[76:79]
  s_waitcnt lgkmcnt(4)
  v_mfma_f32_16x16x32_bf16 v[76:79], v[36:39], v[188:191], v[76:79]
  s_waitcnt lgkmcnt(2)
  v_mfma_f32_16x16x32_bf16 v[76:79], v[40:43], v[196:199], v[76:79]
  s_waitcnt lgkmcnt(0)
  v_mfma_f32_16x16x32_bf16 v[76:79], v[44:47], v[204:207], v[76:79]
  s_waitcnt vmcnt(23)
  s_waitcnt lgkmcnt(0)
  s_barrier
  v_mfma_f32_16x16x32_bf16 v[72:75], v[36:39], v[184:187], v[72:75]
  v_mfma_f32_16x16x32_bf16 v[72:75], v[40:43], v[192:195], v[72:75]
  v_mfma_f32_16x16x32_bf16 v[72:75], v[44:47], v[200:203], v[72:75]
  s_cmp_lg_u32 s56, 7
  s_cbranch_scc1 gated_mix__softmax_full_mha__geglu_ffn__prompt_kernel_l26
  v_lshrrev_b32 v8, 3, v0
  s_mul_i32 s63, s60, 3
  v_add_u32 v8, s63, v8
  v_and_b32 v9, 7, v0
  v_and_b32 v10, 3, v8
  v_lshl_add_u32 v10, v9, 2, v10
  v_bfe_u32 v11, v8, 2, 3
  v_lshl_add_u32 v10, v10, 3, v11
  v_lshlrev_b32 v10, 9, v10
  v_lshrrev_b32 v8, 5, v8
  v_lshlrev_b32 v11, 5, v8
  s_lshl_b32 s63, s59, 2
  v_add_u32 v11, s63, v11
  v_cmp_eq_u32 vcc, 0, v8
  v_mov_b32 v8, 96
  s_nop 0
  v_cndmask_b32 v11, v11, v8, vcc
  v_add_u32 v10, v10, v11
  v_cmp_ne_u32 s[86:87], s59, v9
  s_nop 0
  s_and_b64 vcc, vcc, s[86:87]
  s_or_b32 vcc_lo, vcc_lo, 0xff000000
  s_mov_b32 vcc_hi, -1
  v_mov_b32 v8, 2147483648
  v_cndmask_b32 v10, v10, v8, vcc
  v_mov_b32 v11, s0
  s_mov_b32 s63, 45088768
  buffer_store_dword v11, v10, s[44:47], s63 offen sc1
gated_mix__softmax_full_mha__geglu_ffn__prompt_kernel_l26:
  s_cmp_ge_u32 s84, 6
  s_cselect_b32 s63, s96, s67
  s_add_u32 m0, s85, 49152
  s_add_u32 s63, s63, 1769600
  buffer_load_dwordx4 v2, s[32:35], s63 offen lds
  s_cmp_ge_u32 s84, 6
  s_cselect_b32 s63, s96, s67
  s_add_u32 m0, s85, 73728
  s_add_u32 s63, s63, 1769600
  buffer_load_dwordx4 v2, s[36:39], s63 offen lds
  s_cmp_ge_u32 s84, 5
  s_cselect_b32 s63, s96, s67
  s_add_u32 m0, s85, 57344
  s_add_u32 s63, s63, 2359424
  buffer_load_dwordx4 v2, s[32:35], s63 offen lds
  s_cmp_ge_u32 s84, 5
  s_cselect_b32 s63, s96, s67
  s_add_u32 m0, s85, 81920
  s_add_u32 s63, s63, 2359424
  buffer_load_dwordx4 v2, s[36:39], s63 offen lds
  s_cmp_ge_u32 s84, 4
  s_cselect_b32 s63, s96, s67
  s_add_u32 m0, s85, 65536
  s_add_u32 s63, s63, 2949248
  buffer_load_dwordx4 v2, s[32:35], s63 offen lds
  s_cmp_ge_u32 s84, 4
  s_cselect_b32 s63, s96, s67
  s_add_u32 m0, s85, 90112
  s_add_u32 s63, s63, 2949248
  buffer_load_dwordx4 v2, s[36:39], s63 offen lds
  v_lshrrev_b32 v8, 5, v0
  v_bfe_u32 v9, v0, 2, 2
  v_lshl_add_u32 v8, v8, 2, v9
  v_mul_u32_u24 v8, 288, v8
  v_add_u32 v8, s81, v8
  v_and_b32 v9, 1, v0
  v_lshl_add_u32 v10, v9, 5, v8
  v_bfe_u32 v9, v0, 1, 1
  v_lshl_add_u32 v10, v9, 3, v10
  v_and_b32 v9, 3, v0
  v_lshl_add_u32 v8, v9, 3, v8
  v_bfe_u32 v9, v0, 4, 1
  v_lshl_add_u32 v10, v9, 4, v10
  v_mul_u32_u24 v11, 144, v9
  v_add_u32 v11, v11, v8
  s_waitcnt vmcnt(10)
  ds_read_b64_tr_b16 v[24:25], v10 offset:0
  ds_read_b64_tr_b16 v[26:27], v10 offset:2304
  ds_read_b64_tr_b16 v[28:29], v10 offset:64
  ds_read_b64_tr_b16 v[30:31], v10 offset:2368
  ds_read_b64_tr_b16 v[32:33], v10 offset:144
  ds_read_b64_tr_b16 v[34:35], v10 offset:2448
  ds_read_b64_tr_b16 v[36:37], v10 offset:208
  ds_read_b64_tr_b16 v[38:39], v10 offset:2512
  ds_read_b64_tr_b16 v[40:41], v11 offset:128
  ds_read_b64_tr_b16 v[42:43], v11 offset:2432
  v_mul_lo_u32 v9, v9, s91
  v_lshrrev_b32 v8, 5, v0
  v_lshl_add_u32 v9, v8, 7, v9
  v_and_b32 v8, 15, v0
  v_lshl_add_u32 v9, v8, 4, v9
  v_cmp_gt_u32 vcc, 8, v8
  v_mov_b32 v8, 2147483648
  s_nop 0
  v_cndmask_b32 v9, v8, v9, vcc
  v_lshlrev_b32 v8, 4, v0
  s_cmp_eq_u32 s92, 0
  s_cselect_b32 s63, 2147483648, 0
  v_or_b32 v8, s63, v8
  v_or_b32 v9, s63, v9
  s_add_u32 s63, s90, s91
  s_waitcnt lgkmcnt(0)
  buffer_store_dwordx4 v[24:27], v8, s[44:47], s90 offen offset:0 sc1
  buffer_store_dwordx4 v[28:31], v8, s[44:47], s90 offen offset:1024 sc1
  buffer_store_dwordx4 v[32:35], v8, s[44:47], s63 offen offset:0 sc1
  buffer_store_dwordx4 v[36:39], v8, s[44:47], s63 offen offset:1024 sc1
  buffer_store_dwordx4 v[40:43], v9, s[44:47], s90 offen offset:2048 sc1
  s_waitcnt vmcnt(11)
  v_mov_b32 v8, 0
  v_dot2_f32_bf16 v8, v3, v5, v8
  v_dot2_f32_bf16 v8, v12, v16, v8
  v_dot2_f32_bf16 v8, v13, v17, v8
  v_dot2_f32_bf16 v8, v14, v18, v8
  v_dot2_f32_bf16 v8, v15, v19, v8
  s_nop 3
  v_add_f32_dpp v8, v8, v8 quad_perm:[1,0,3,2] row_mask:0xf bank_mask:0xf
  s_nop 1
  v_add_f32_dpp v8, v8, v8 quad_perm:[2,3,0,1] row_mask:0xf bank_mask:0xf
  s_nop 1
  v_add_f32_dpp v8, v8, v8 row_half_mirror row_mask:0xf bank_mask:0xf
  s_nop 1
  v_add_f32_dpp v8, v8, v8 row_mirror row_mask:0xf bank_mask:0xf
  s_nop 0
  v_readlane_b32 s63, v8, 16
  v_readlane_b32 s65, v8, 32
  v_readlane_b32 s64, v8, 48
  v_add_f32 v8, s63, v8
  v_add_f32 v8, s65, v8
  v_add_f32 v8, s64, v8
  v_max_f32 v8, 3256877056, v8
  v_min_f32 v8, 1106247680, v8
  v_mul_f32 v8, 1069066811, v8
  v_exp_f32 v8, v8
  v_cmp_eq_u32 vcc, 0, v0
  v_mov_b32 v9, 2147483648
  s_nop 0
  v_cndmask_b32 v9, v9, v0, vcc
  s_lshl_b32 s63, s80, 2
  s_add_u32 s63, s63, 35594240
  buffer_store_dword v8, v9, s[44:47], s63 offen sc1
  v_add_u32 v22, 98304, v1
  v_xor_b32 v21, 96, v22
  ds_read_b64_tr_b16 v[24:25], v21 offset:0
  ds_read_b64_tr_b16 v[26:27], v21 offset:512
  ds_read_b64_tr_b16 v[28:29], v21 offset:4096
  ds_read_b64_tr_b16 v[30:31], v21 offset:4608
  ds_read_b64_tr_b16 v[32:33], v21 offset:8192
  ds_read_b64_tr_b16 v[34:35], v21 offset:8704
  ds_read_b64_tr_b16 v[36:37], v21 offset:12288
  ds_read_b64_tr_b16 v[38:39], v21 offset:12800
  ds_read_b64_tr_b16 v[40:41], v21 offset:16384
  s_branch gated_mix__softmax_full_mha__geglu_ffn__prompt_kernel_l25
gated_mix__softmax_full_mha__geglu_ffn__prompt_kernel_l24:
  s_cmp_ge_u32 s84, 9
  s_cselect_b32 s63, s96, s67
  s_add_u32 m0, s85, 0
  s_add_u32 s63, s63, 128
  buffer_load_dwordx4 v2, s[32:35], s63 offen lds
  s_cmp_ge_u32 s84, 9
  s_cselect_b32 s63, s96, s67
  s_add_u32 m0, s85, 24576
  s_add_u32 s63, s63, 128
  buffer_load_dwordx4 v2, s[36:39], s63 offen lds
  s_cmp_ge_u32 s84, 8
  s_cselect_b32 s63, s96, s67
  s_add_u32 m0, s85, 8192
  s_add_u32 s63, s63, 589952
  buffer_load_dwordx4 v2, s[32:35], s63 offen lds
  s_cmp_ge_u32 s84, 8
  s_cselect_b32 s63, s96, s67
  s_add_u32 m0, s85, 32768
  s_add_u32 s63, s63, 589952
  buffer_load_dwordx4 v2, s[36:39], s63 offen lds
  s_cmp_ge_u32 s84, 7
  s_cselect_b32 s63, s96, s67
  s_add_u32 m0, s85, 16384
  s_add_u32 s63, s63, 1179776
  buffer_load_dwordx4 v2, s[32:35], s63 offen lds
  s_cmp_ge_u32 s84, 7
  s_cselect_b32 s63, s96, s67
  s_add_u32 m0, s85, 40960
  s_add_u32 s63, s63, 1179776
  buffer_load_dwordx4 v2, s[36:39], s63 offen lds
  s_waitcnt vmcnt(6)
  v_mov_b32 v8, 0
  v_dot2_f32_bf16 v8, v3, v5, v8
  v_dot2_f32_bf16 v8, v12, v16, v8
  v_dot2_f32_bf16 v8, v13, v17, v8
  v_dot2_f32_bf16 v8, v14, v18, v8
  v_dot2_f32_bf16 v8, v15, v19, v8
  s_nop 3
  v_add_f32_dpp v8, v8, v8 quad_perm:[1,0,3,2] row_mask:0xf bank_mask:0xf
  s_nop 1
  v_add_f32_dpp v8, v8, v8 quad_perm:[2,3,0,1] row_mask:0xf bank_mask:0xf
  s_nop 1
  v_add_f32_dpp v8, v8, v8 row_half_mirror row_mask:0xf bank_mask:0xf
  s_nop 1
  v_add_f32_dpp v8, v8, v8 row_mirror row_mask:0xf bank_mask:0xf
  s_nop 0
  v_readlane_b32 s63, v8, 16
  v_readlane_b32 s65, v8, 32
  v_readlane_b32 s64, v8, 48
  v_add_f32 v8, s63, v8
  v_add_f32 v8, s65, v8
  v_add_f32 v8, s64, v8
  v_max_f32 v8, 3256877056, v8
  v_min_f32 v8, 1106247680, v8
  v_mul_f32 v8, 1069066811, v8
  v_exp_f32 v8, v8
  v_cmp_eq_u32 vcc, 0, v0
  v_mov_b32 v9, 2147483648
  s_nop 0
  v_cndmask_b32 v9, v9, v0, vcc
  s_lshl_b32 s63, s80, 2
  s_add_u32 s63, s63, 35594240
  buffer_store_dword v8, v9, s[44:47], s63 offen sc1
  v_add_u32 v22, 98304, v1
  s_waitcnt vmcnt(11)
  s_waitcnt lgkmcnt(0)
  s_barrier
  v_mfma_f32_16x16x32_bf16 v[76:79], v[24:27], v[164:167], v[76:79]
  v_xor_b32 v21, 96, v22
  ds_read_b64_tr_b16 v[24:25], v21 offset:0
  ds_read_b64_tr_b16 v[26:27], v21 offset:512
  v_mfma_f32_16x16x32_bf16 v[76:79], v[28:31], v[172:175], v[76:79]
  ds_read_b64_tr_b16 v[28:29], v21 offset:4096
  ds_read_b64_tr_b16 v[30:31], v21 offset:4608
  v_mfma_f32_16x16x32_bf16 v[76:79], v[32:35], v[180:183], v[76:79]
  ds_read_b64_tr_b16 v[32:33], v21 offset:8192
  ds_read_b64_tr_b16 v[34:35], v21 offset:8704
  v_mfma_f32_16x16x32_bf16 v[76:79], v[36:39], v[188:191], v[76:79]
  v_mfma_f32_16x16x32_bf16 v[76:79], v[40:43], v[196:199], v[76:79]
  v_mfma_f32_16x16x32_bf16 v[76:79], v[44:47], v[204:207], v[76:79]
  v_mfma_f32_16x16x32_bf16 v[72:75], v[36:39], v[184:187], v[72:75]
  ds_read_b64_tr_b16 v[36:37], v21 offset:12288
  ds_read_b64_tr_b16 v[38:39], v21 offset:12800
  v_mfma_f32_16x16x32_bf16 v[72:75], v[40:43], v[192:195], v[72:75]
  ds_read_b64_tr_b16 v[40:41], v21 offset:16384
  v_mfma_f32_16x16x32_bf16 v[72:75], v[44:47], v[200:203], v[72:75]
gated_mix__softmax_full_mha__geglu_ffn__prompt_kernel_l25:
  s_waitcnt lgkmcnt(7)
  v_mfma_f32_16x16x32_bf16 v[96:99], v[24:27], v[208:211], v[96:99]
  ds_read_b64_tr_b16 v[42:43], v21 offset:16896
  s_waitcnt lgkmcnt(6)
  v_mfma_f32_16x16x32_bf16 v[96:99], v[28:31], v[216:219], v[96:99]
  ds_read_b64_tr_b16 v[44:45], v21 offset:20480
  s_waitcnt lgkmcnt(5)
  v_mfma_f32_16x16x32_bf16 v[96:99], v[32:35], v[224:227], v[96:99]
  ds_read_b64_tr_b16 v[46:47], v21 offset:20992
  v_mfma_f32_16x16x32_bf16 v[100:103], v[24:27], v[212:215], v[100:103]
  ds_read_b64_tr_b16 v[24:25], v21 offset:24576
  v_mfma_f32_16x16x32_bf16 v[100:103], v[28:31], v[220:223], v[100:103]
  ds_read_b64_tr_b16 v[26:27], v21 offset:25088
  v_mfma_f32_16x16x32_bf16 v[100:103], v[32:35], v[228:231], v[100:103]
  ds_read_b64_tr_b16 v[28:29], v21 offset:28672
  s_waitcnt lgkmcnt(7)
  v_mfma_f32_16x16x32_bf16 v[100:103], v[36:39], v[236:239], v[100:103]
  ds_read_b64_tr_b16 v[30:31], v21 offset:29184
  s_waitcnt lgkmcnt(6)
  v_mfma_f32_16x16x32_bf16 v[100:103], v[40:43], v[244:247], v[100:103]
  ds_read_b64_tr_b16 v[32:33], v21 offset:32768
  s_waitcnt lgkmcnt(5)
  v_mfma_f32_16x16x32_bf16 v[100:103], v[44:47], v[252:255], v[100:103]
  ds_read_b64_tr_b16 v[34:35], v21 offset:33280
  v_mfma_f32_16x16x32_bf16 v[96:99], v[36:39], v[232:235], v[96:99]
  ds_read_b64_tr_b16 v[36:37], v21 offset:36864
  v_mfma_f32_16x16x32_bf16 v[96:99], v[40:43], v[240:243], v[96:99]
  ds_read_b64_tr_b16 v[38:39], v21 offset:37376
  v_mfma_f32_16x16x32_bf16 v[96:99], v[44:47], v[248:251], v[96:99]
  ds_read_b64_tr_b16 v[40:41], v21 offset:40960
  s_waitcnt lgkmcnt(7)
  v_mfma_f32_16x16x32_bf16 v[104:107], v[24:27], v[208:211], v[104:107]
  ds_read_b64_tr_b16 v[42:43], v21 offset:41472
  s_waitcnt lgkmcnt(6)
  v_mfma_f32_16x16x32_bf16 v[104:107], v[28:31], v[216:219], v[104:107]
  ds_read_b64_tr_b16 v[44:45], v21 offset:45056
  s_waitcnt lgkmcnt(5)
  v_mfma_f32_16x16x32_bf16 v[104:107], v[32:35], v[224:227], v[104:107]
  ds_read_b64_tr_b16 v[46:47], v21 offset:45568
  v_mfma_f32_16x16x32_bf16 v[108:111], v[24:27], v[212:215], v[108:111]
  v_xor_b32 v20, 64, v22
  ds_read_b64_tr_b16 v[24:25], v20 offset:0
  v_mfma_f32_16x16x32_bf16 v[108:111], v[28:31], v[220:223], v[108:111]
  ds_read_b64_tr_b16 v[26:27], v20 offset:512
  v_mfma_f32_16x16x32_bf16 v[108:111], v[32:35], v[228:231], v[108:111]
  ds_read_b64_tr_b16 v[28:29], v20 offset:4096
  s_waitcnt lgkmcnt(7)
  v_mfma_f32_16x16x32_bf16 v[108:111], v[36:39], v[236:239], v[108:111]
  ds_read_b64_tr_b16 v[30:31], v20 offset:4608
  s_waitcnt lgkmcnt(6)
  v_mfma_f32_16x16x32_bf16 v[108:111], v[40:43], v[244:247], v[108:111]
  ds_read_b64_tr_b16 v[32:33], v20 offset:8192
  s_waitcnt lgkmcnt(5)
  v_mfma_f32_16x16x32_bf16 v[108:111], v[44:47], v[252:255], v[108:111]
  ds_read_b64_tr_b16 v[34:35], v20 offset:8704
  v_mfma_f32_16x16x32_bf16 v[104:107], v[36:39], v[232:235], v[104:107]
  ds_read_b64_tr_b16 v[36:37], v20 offset:12288
  v_mfma_f32_16x16x32_bf16 v[104:107], v[40:43], v[240:243], v[104:107]
  ds_read_b64_tr_b16 v[38:39], v20 offset:12800
  v_mfma_f32_16x16x32_bf16 v[104:107], v[44:47], v[248:251], v[104:107]
  ds_read_b64_tr_b16 v[40:41], v20 offset:16384
  s_waitcnt lgkmcnt(7)
  v_mfma_f32_16x16x32_bf16 v[80:83], v[24:27], v[208:211], v[80:83]
  ds_read_b64_tr_b16 v[42:43], v20 offset:16896
  s_waitcnt lgkmcnt(6)
  v_mfma_f32_16x16x32_bf16 v[80:83], v[28:31], v[216:219], v[80:83]
  ds_read_b64_tr_b16 v[44:45], v20 offset:20480
  s_waitcnt lgkmcnt(5)
  v_mfma_f32_16x16x32_bf16 v[80:83], v[32:35], v[224:227], v[80:83]
  ds_read_b64_tr_b16 v[46:47], v20 offset:20992
  v_mul_f32 v104, v96, v104
  v_mfma_f32_16x16x32_bf16 v[84:87], v[24:27], v[212:215], v[84:87]
  ds_read_b64_tr_b16 v[24:25], v20 offset:24576
  v_mul_f32 v105, v97, v105
  v_mul_f32 v106, v98, v106
  v_mfma_f32_16x16x32_bf16 v[84:87], v[28:31], v[220:223], v[84:87]
  ds_read_b64_tr_b16 v[26:27], v20 offset:25088
  v_mul_f32 v107, v99, v107
  v_fma_f32 v8, v96, v96, s76
  v_mfma_f32_16x16x32_bf16 v[84:87], v[32:35], v[228:231], v[84:87]
  ds_read_b64_tr_b16 v[28:29], v20 offset:28672
  v_fma_f32 v9, v97, v97, s76
  v_fma_f32 v10, v98, v98, s76
  s_waitcnt lgkmcnt(7)
  v_mfma_f32_16x16x32_bf16 v[84:87], v[36:39], v[236:239], v[84:87]
  ds_read_b64_tr_b16 v[30:31], v20 offset:29184
  v_fma_f32 v11, v99, v99, s76
  v_mul_f32 v96, s77, v96
  s_waitcnt lgkmcnt(6)
  v_mfma_f32_16x16x32_bf16 v[84:87], v[40:43], v[244:247], v[84:87]
  ds_read_b64_tr_b16 v[32:33], v20 offset:32768
  v_mul_f32 v97, s77, v97
  s_waitcnt lgkmcnt(5)
  v_mfma_f32_16x16x32_bf16 v[84:87], v[44:47], v[252:255], v[84:87]
  ds_read_b64_tr_b16 v[34:35], v20 offset:33280
  v_mul_f32 v98, s77, v98
  v_mul_f32 v99, s77, v99
  v_mfma_f32_16x16x32_bf16 v[80:83], v[36:39], v[232:235], v[80:83]
  ds_read_b64_tr_b16 v[36:37], v20 offset:36864
  v_mul_f32 v8, v8, v96
  v_mul_f32 v9, v9, v97
  v_mfma_f32_16x16x32_bf16 v[80:83], v[40:43], v[240:243], v[80:83]
  ds_read_b64_tr_b16 v[38:39], v20 offset:37376
  v_mul_f32 v10, v10, v98
  v_mul_f32 v11, v11, v99
  v_mfma_f32_16x16x32_bf16 v[80:83], v[44:47], v[248:251], v[80:83]
  ds_read_b64_tr_b16 v[40:41], v20 offset:40960
  v_exp_f32 v8, v8
  v_exp_f32 v9, v9
  s_waitcnt lgkmcnt(7)
  v_mfma_f32_16x16x32_bf16 v[88:91], v[24:27], v[208:211], v[88:91]
  ds_read_b64_tr_b16 v[42:43], v20 offset:41472
  v_exp_f32 v10, v10
  s_waitcnt lgkmcnt(6)
  v_mfma_f32_16x16x32_bf16 v[88:91], v[28:31], v[216:219], v[88:91]
  ds_read_b64_tr_b16 v[44:45], v20 offset:45056
  v_exp_f32 v11, v11
  v_add_f32 v8, 1.0, v8
  s_waitcnt lgkmcnt(5)
  v_mfma_f32_16x16x32_bf16 v[88:91], v[32:35], v[224:227], v[88:91]
  ds_read_b64_tr_b16 v[46:47], v20 offset:45568
  v_add_f32 v9, 1.0, v9
  v_add_f32 v10, 1.0, v10
  v_mfma_f32_16x16x32_bf16 v[92:95], v[24:27], v[212:215], v[92:95]
  v_xor_b32 v21, 0, v22
  ds_read_b64_tr_b16 v[24:25], v21 offset:0
  v_add_f32 v11, 1.0, v11
  v_rcp_f32 v8, v8
  v_mfma_f32_16x16x32_bf16 v[92:95], v[28:31], v[220:223], v[92:95]
  ds_read_b64_tr_b16 v[26:27], v21 offset:512
  v_rcp_f32 v9, v9
  v_rcp_f32 v10, v10
  v_mfma_f32_16x16x32_bf16 v[92:95], v[32:35], v[228:231], v[92:95]
  ds_read_b64_tr_b16 v[28:29], v21 offset:4096
  v_rcp_f32 v11, v11
  s_waitcnt lgkmcnt(7)
  v_mfma_f32_16x16x32_bf16 v[92:95], v[36:39], v[236:239], v[92:95]
  ds_read_b64_tr_b16 v[30:31], v21 offset:4608
  v_mul_f32 v8, v8, v104
  v_mul_f32 v9, v9, v105
  s_waitcnt lgkmcnt(6)
  v_mfma_f32_16x16x32_bf16 v[92:95], v[40:43], v[244:247], v[92:95]
  ds_read_b64_tr_b16 v[32:33], v21 offset:8192
  v_mul_f32 v10, v10, v106
  v_mul_f32 v11, v11, v107
  s_waitcnt lgkmcnt(5)
  v_mfma_f32_16x16x32_bf16 v[92:95], v[44:47], v[252:255], v[92:95]
  ds_read_b64_tr_b16 v[34:35], v21 offset:8704
  v_cvt_pk_bf16_f32 v14, v8, v9
  v_cvt_pk_bf16_f32 v15, v10, v11
  v_mfma_f32_16x16x32_bf16 v[88:91], v[36:39], v[232:235], v[88:91]
  ds_read_b64_tr_b16 v[36:37], v21 offset:12288
  v_mul_f32 v108, v100, v108
  v_mul_f32 v109, v101, v109
  v_mfma_f32_16x16x32_bf16 v[88:91], v[40:43], v[240:243], v[88:91]
  ds_read_b64_tr_b16 v[38:39], v21 offset:12800
  v_mul_f32 v110, v102, v110
  v_mfma_f32_16x16x32_bf16 v[88:91], v[44:47], v[248:251], v[88:91]
  ds_read_b64_tr_b16 v[40:41], v21 offset:16384
  v_mul_f32 v111, v103, v111
  v_fma_f32 v8, v100, v100, s76
  s_waitcnt lgkmcnt(7)
  v_mfma_f32_16x16x32_bf16 v[48:51], v[24:27], v[208:211], v[48:51]
  ds_read_b64_tr_b16 v[42:43], v21 offset:16896
  v_fma_f32 v9, v101, v101, s76
  v_fma_f32 v10, v102, v102, s76
  s_waitcnt lgkmcnt(6)
  v_mfma_f32_16x16x32_bf16 v[48:51], v[28:31], v[216:219], v[48:51]
  ds_read_b64_tr_b16 v[44:45], v21 offset:20480
  v_fma_f32 v11, v103, v103, s76
  v_mul_f32 v100, s77, v100
  s_waitcnt lgkmcnt(5)
  v_mfma_f32_16x16x32_bf16 v[48:51], v[32:35], v[224:227], v[48:51]
  ds_read_b64_tr_b16 v[46:47], v21 offset:20992
  v_mul_f32 v101, s77, v101
  v_mul_f32 v102, s77, v102
  v_mfma_f32_16x16x32_bf16 v[52:55], v[24:27], v[212:215], v[52:55]
  ds_read_b64_tr_b16 v[24:25], v21 offset:24576
  v_mul_f32 v103, s77, v103
  v_mfma_f32_16x16x32_bf16 v[52:55], v[28:31], v[220:223], v[52:55]
  ds_read_b64_tr_b16 v[26:27], v21 offset:25088
  v_mul_f32 v8, v8, v100
  v_mul_f32 v9, v9, v101
  v_mfma_f32_16x16x32_bf16 v[52:55], v[32:35], v[228:231], v[52:55]
  ds_read_b64_tr_b16 v[28:29], v21 offset:28672
  v_mul_f32 v10, v10, v102
  v_mul_f32 v11, v11, v103
  s_waitcnt lgkmcnt(7)
  v_mfma_f32_16x16x32_bf16 v[52:55], v[36:39], v[236:239], v[52:55]
  ds_read_b64_tr_b16 v[30:31], v21 offset:29184
  v_exp_f32 v8, v8
  v_exp_f32 v9, v9
  s_waitcnt lgkmcnt(6)
  v_mfma_f32_16x16x32_bf16 v[52:55], v[40:43], v[244:247], v[52:55]
  ds_read_b64_tr_b16 v[32:33], v21 offset:32768
  v_exp_f32 v10, v10
  v_exp_f32 v11, v11
  s_waitcnt lgkmcnt(5)
  v_mfma_f32_16x16x32_bf16 v[52:55], v[44:47], v[252:255], v[52:55]
  ds_read_b64_tr_b16 v[34:35], v21 offset:33280
  v_add_f32 v8, 1.0, v8
  v_mfma_f32_16x16x32_bf16 v[48:51], v[36:39], v[232:235], v[48:51]
  ds_read_b64_tr_b16 v[36:37], v21 offset:36864
  v_add_f32 v9, 1.0, v9
  v_add_f32 v10, 1.0, v10
  v_mfma_f32_16x16x32_bf16 v[48:51], v[40:43], v[240:243], v[48:51]
  ds_read_b64_tr_b16 v[38:39], v21 offset:37376
  v_add_f32 v11, 1.0, v11
  v_rcp_f32 v8, v8
  v_mfma_f32_16x16x32_bf16 v[48:51], v[44:47], v[248:251], v[48:51]
  ds_read_b64_tr_b16 v[40:41], v21 offset:40960
  v_rcp_f32 v9, v9
  v_rcp_f32 v10, v10
  s_waitcnt lgkmcnt(7)
  v_mfma_f32_16x16x32_bf16 v[56:59], v[24:27], v[208:211], v[56:59]
  ds_read_b64_tr_b16 v[42:43], v21 offset:41472
  v_rcp_f32 v11, v11
  v_mul_f32 v8, v8, v108
  s_waitcnt lgkmcnt(6)
  v_mfma_f32_16x16x32_bf16 v[56:59], v[28:31], v[216:219], v[56:59]
  ds_read_b64_tr_b16 v[44:45], v21 offset:45056
  v_mul_f32 v9, v9, v109
  s_waitcnt lgkmcnt(5)
  v_mfma_f32_16x16x32_bf16 v[56:59], v[32:35], v[224:227], v[56:59]
  ds_read_b64_tr_b16 v[46:47], v21 offset:45568
  v_mul_f32 v10, v10, v110
  v_mul_f32 v11, v11, v111
  v_mfma_f32_16x16x32_bf16 v[60:63], v[24:27], v[212:215], v[60:63]
  v_xor_b32 v20, 32, v22
  ds_read_b64_tr_b16 v[24:25], v20 offset:0
  v_cvt_pk_bf16_f32 v18, v8, v9
  v_cvt_pk_bf16_f32 v19, v10, v11
  v_mfma_f32_16x16x32_bf16 v[60:63], v[28:31], v[220:223], v[60:63]
  ds_read_b64_tr_b16 v[26:27], v20 offset:512
  v_mul_f32 v88, v80, v88
  v_mul_f32 v89, v81, v89
  v_mfma_f32_16x16x32_bf16 v[60:63], v[32:35], v[228:231], v[60:63]
  ds_read_b64_tr_b16 v[28:29], v20 offset:4096
  v_mul_f32 v90, v82, v90
  v_mul_f32 v91, v83, v91
  s_waitcnt lgkmcnt(7)
  v_mfma_f32_16x16x32_bf16 v[60:63], v[36:39], v[236:239], v[60:63]
  ds_read_b64_tr_b16 v[30:31], v20 offset:4608
  v_fma_f32 v8, v80, v80, s76
  s_waitcnt lgkmcnt(6)
  v_mfma_f32_16x16x32_bf16 v[60:63], v[40:43], v[244:247], v[60:63]
  ds_read_b64_tr_b16 v[32:33], v20 offset:8192
  v_fma_f32 v9, v81, v81, s76
  v_fma_f32 v10, v82, v82, s76
  s_waitcnt lgkmcnt(5)
  v_mfma_f32_16x16x32_bf16 v[60:63], v[44:47], v[252:255], v[60:63]
  ds_read_b64_tr_b16 v[34:35], v20 offset:8704
  v_fma_f32 v11, v83, v83, s76
  v_mul_f32 v80, s77, v80
  v_mfma_f32_16x16x32_bf16 v[56:59], v[36:39], v[232:235], v[56:59]
  ds_read_b64_tr_b16 v[36:37], v20 offset:12288
  v_mul_f32 v81, s77, v81
  v_mul_f32 v82, s77, v82
  v_mfma_f32_16x16x32_bf16 v[56:59], v[40:43], v[240:243], v[56:59]
  ds_read_b64_tr_b16 v[38:39], v20 offset:12800
  v_mul_f32 v83, s77, v83
  v_mul_f32 v8, v8, v80
  v_mfma_f32_16x16x32_bf16 v[56:59], v[44:47], v[248:251], v[56:59]
  ds_read_b64_tr_b16 v[40:41], v20 offset:16384
  v_mul_f32 v9, v9, v81
  s_waitcnt lgkmcnt(7)
  v_mfma_f32_16x16x32_bf16 v[64:67], v[24:27], v[208:211], v[64:67]
  ds_read_b64_tr_b16 v[42:43], v20 offset:16896
  v_mul_f32 v10, v10, v82
  v_mul_f32 v11, v11, v83
  s_waitcnt lgkmcnt(6)
  v_mfma_f32_16x16x32_bf16 v[64:67], v[28:31], v[216:219], v[64:67]
  ds_read_b64_tr_b16 v[44:45], v20 offset:20480
  v_exp_f32 v8, v8
  v_exp_f32 v9, v9
  s_waitcnt lgkmcnt(5)
  v_mfma_f32_16x16x32_bf16 v[64:67], v[32:35], v[224:227], v[64:67]
  ds_read_b64_tr_b16 v[46:47], v20 offset:20992
  v_exp_f32 v10, v10
  v_exp_f32 v11, v11
  v_mfma_f32_16x16x32_bf16 v[68:71], v[24:27], v[212:215], v[68:71]
  ds_read_b64_tr_b16 v[24:25], v20 offset:24576
  v_add_f32 v8, 1.0, v8
  v_add_f32 v9, 1.0, v9
  v_mfma_f32_16x16x32_bf16 v[68:71], v[28:31], v[220:223], v[68:71]
  ds_read_b64_tr_b16 v[26:27], v20 offset:25088
  v_add_f32 v10, 1.0, v10
  v_mfma_f32_16x16x32_bf16 v[68:71], v[32:35], v[228:231], v[68:71]
  ds_read_b64_tr_b16 v[28:29], v20 offset:28672
  v_add_f32 v11, 1.0, v11
  v_rcp_f32 v8, v8
  s_waitcnt lgkmcnt(7)
  v_mfma_f32_16x16x32_bf16 v[68:71], v[36:39], v[236:239], v[68:71]
  ds_read_b64_tr_b16 v[30:31], v20 offset:29184
  v_rcp_f32 v9, v9
  v_rcp_f32 v10, v10
  s_waitcnt lgkmcnt(6)
  v_mfma_f32_16x16x32_bf16 v[68:71], v[40:43], v[244:247], v[68:71]
  ds_read_b64_tr_b16 v[32:33], v20 offset:32768
  v_rcp_f32 v11, v11
  v_mul_f32 v8, v8, v88
  s_waitcnt lgkmcnt(5)
  v_mfma_f32_16x16x32_bf16 v[68:71], v[44:47], v[252:255], v[68:71]
  ds_read_b64_tr_b16 v[34:35], v20 offset:33280
  v_mul_f32 v9, v9, v89
  v_mul_f32 v10, v10, v90
  v_mfma_f32_16x16x32_bf16 v[64:67], v[36:39], v[232:235], v[64:67]
  ds_read_b64_tr_b16 v[36:37], v20 offset:36864
  v_mul_f32 v11, v11, v91
  v_mfma_f32_16x16x32_bf16 v[64:67], v[40:43], v[240:243], v[64:67]
  ds_read_b64_tr_b16 v[38:39], v20 offset:37376
  v_cvt_pk_bf16_f32 v12, v8, v9
  v_cvt_pk_bf16_f32 v13, v10, v11
  v_mfma_f32_16x16x32_bf16 v[64:67], v[44:47], v[248:251], v[64:67]
  ds_read_b64_tr_b16 v[40:41], v20 offset:40960
  s_add_u32 s66, s68, 8192
  buffer_store_dwordx4 v[12:15], v4, s[44:47], s66 offen offset:0 sc1
  s_waitcnt lgkmcnt(7)
  v_mfma_f32_16x16x32_bf16 v[72:75], v[24:27], v[208:211], v[72:75]
  ds_read_b64_tr_b16 v[42:43], v20 offset:41472
  v_mul_f32 v92, v84, v92
  v_mul_f32 v93, v85, v93
  s_waitcnt lgkmcnt(6)
  v_mfma_f32_16x16x32_bf16 v[72:75], v[28:31], v[216:219], v[72:75]
  ds_read_b64_tr_b16 v[44:45], v20 offset:45056
  v_mul_f32 v94, v86, v94
  v_mul_f32 v95, v87, v95
  s_waitcnt lgkmcnt(5)
  v_mfma_f32_16x16x32_bf16 v[72:75], v[32:35], v[224:227], v[72:75]
  ds_read_b64_tr_b16 v[46:47], v20 offset:45568
  v_fma_f32 v8, v84, v84, s76
  v_fma_f32 v9, v85, v85, s76
  v_fma_f32 v10, v86, v86, s76
  v_fma_f32 v11, v87, v87, s76
  v_mul_f32 v84, s77, v84
  v_mul_f32 v85, s77, v85
  v_mul_f32 v86, s77, v86
  v_mul_f32 v87, s77, v87
  v_mul_f32 v8, v8, v84
  v_mul_f32 v9, v9, v85
  v_mul_f32 v10, v10, v86
  v_mul_f32 v11, v11, v87
  v_exp_f32 v8, v8
  v_exp_f32 v9, v9
  v_exp_f32 v10, v10
  v_exp_f32 v11, v11
  v_add_f32 v8, 1.0, v8
  v_add_f32 v9, 1.0, v9
  v_add_f32 v10, 1.0, v10
  v_add_f32 v11, 1.0, v11
  v_rcp_f32 v8, v8
  v_rcp_f32 v9, v9
  v_rcp_f32 v10, v10
  v_rcp_f32 v11, v11
  v_mul_f32 v8, v8, v92
  v_mul_f32 v9, v9, v93
  v_mul_f32 v10, v10, v94
  v_mul_f32 v11, v11, v95
  v_cvt_pk_bf16_f32 v16, v8, v9
  v_cvt_pk_bf16_f32 v17, v10, v11
  buffer_store_dwordx4 v[16:19], v4, s[44:47], s66 offen offset:256 sc1
  s_cmp_lt_u32 s56, 4
  s_cbranch_scc1 gated_mix__softmax_full_mha__geglu_ffn__prompt_kernel_l27
  v_mfma_f32_16x16x32_bf16 v[76:79], v[24:27], v[212:215], v[76:79]
  v_mfma_f32_16x16x32_bf16 v[76:79], v[28:31], v[220:223], v[76:79]
  v_mfma_f32_16x16x32_bf16 v[76:79], v[32:35], v[228:231], v[76:79]
  s_waitcnt lgkmcnt(4)
  v_mfma_f32_16x16x32_bf16 v[76:79], v[36:39], v[236:239], v[76:79]
  s_waitcnt lgkmcnt(2)
  v_mfma_f32_16x16x32_bf16 v[76:79], v[40:43], v[244:247], v[76:79]
  s_waitcnt lgkmcnt(0)
  v_mfma_f32_16x16x32_bf16 v[76:79], v[44:47], v[252:255], v[76:79]
  s_waitcnt vmcnt(31)
  s_waitcnt lgkmcnt(0)
  s_barrier
  v_mfma_f32_16x16x32_bf16 v[72:75], v[36:39], v[232:235], v[72:75]
  v_mfma_f32_16x16x32_bf16 v[72:75], v[40:43], v[240:243], v[72:75]
  v_mfma_f32_16x16x32_bf16 v[72:75], v[44:47], v[248:251], v[72:75]
  s_cmp_ge_u32 s84, 3
  s_cselect_b32 s63, s96, s67
  s_add_u32 m0, s85, 98304
  s_add_u32 s63, s63, 3539072
  buffer_load_dwordx4 v2, s[32:35], s63 offen lds
  s_cmp_ge_u32 s84, 3
  s_cselect_b32 s63, s96, s67
  s_add_u32 m0, s85, 122880
  s_add_u32 s63, s63, 3539072
  buffer_load_dwordx4 v2, s[36:39], s63 offen lds
  s_cmp_ge_u32 s84, 2
  s_cselect_b32 s63, s96, s67
  s_add_u32 m0, s85, 106496
  s_add_u32 s63, s63, 4128896
  buffer_load_dwordx4 v2, s[32:35], s63 offen lds
  s_cmp_ge_u32 s84, 2
  s_cselect_b32 s63, s96, s67
  s_add_u32 m0, s85, 131072
  s_add_u32 s63, s63, 4128896
  buffer_load_dwordx4 v2, s[36:39], s63 offen lds
  s_cmp_ge_u32 s84, 1
  s_cselect_b32 s63, s96, s67
  s_add_u32 m0, s85, 114688
  s_add_u32 s63, s63, 4718720
  buffer_load_dwordx4 v2, s[32:35], s63 offen lds
  s_cmp_ge_u32 s84, 1
  s_cselect_b32 s63, s96, s67
  s_add_u32 m0, s85, 139264
  s_add_u32 s63, s63, 4718720
  buffer_load_dwordx4 v2, s[36:39], s63 offen lds
  v_mul_f32 v56, v48, v56
  v_mul_f32 v57, v49, v57
  v_mul_f32 v58, v50, v58
  v_mul_f32 v59, v51, v59
  v_fma_f32 v8, v48, v48, s76
  v_fma_f32 v9, v49, v49, s76
  v_fma_f32 v10, v50, v50, s76
  v_fma_f32 v11, v51, v51, s76
  v_mul_f32 v48, s77, v48
  v_mul_f32 v49, s77, v49
  v_mul_f32 v50, s77, v50
  v_mul_f32 v51, s77, v51
  v_mul_f32 v8, v8, v48
  v_mul_f32 v9, v9, v49
  v_mul_f32 v10, v10, v50
  v_mul_f32 v11, v11, v51
  v_exp_f32 v8, v8
  v_exp_f32 v9, v9
  v_exp_f32 v10, v10
  v_exp_f32 v11, v11
  v_add_f32 v8, 1.0, v8
  v_add_f32 v9, 1.0, v9
  v_add_f32 v10, 1.0, v10
  v_add_f32 v11, 1.0, v11
  v_rcp_f32 v8, v8
  v_rcp_f32 v9, v9
  v_rcp_f32 v10, v10
  v_rcp_f32 v11, v11
  v_mul_f32 v8, v8, v56
  v_mul_f32 v9, v9, v57
  v_mul_f32 v10, v10, v58
  v_mul_f32 v11, v11, v59
  v_cvt_pk_bf16_f32 v12, v8, v9
  v_cvt_pk_bf16_f32 v13, v10, v11
  v_mul_f32 v60, v52, v60
  v_mul_f32 v61, v53, v61
  v_mul_f32 v62, v54, v62
  v_mul_f32 v63, v55, v63
  v_fma_f32 v8, v52, v52, s76
  v_fma_f32 v9, v53, v53, s76
  v_fma_f32 v10, v54, v54, s76
  v_fma_f32 v11, v55, v55, s76
  v_mul_f32 v52, s77, v52
  v_mul_f32 v53, s77, v53
  v_mul_f32 v54, s77, v54
  v_mul_f32 v55, s77, v55
  v_mul_f32 v8, v8, v52
  v_mul_f32 v9, v9, v53
  v_mul_f32 v10, v10, v54
  v_mul_f32 v11, v11, v55
  v_exp_f32 v8, v8
  v_exp_f32 v9, v9
  v_exp_f32 v10, v10
  v_exp_f32 v11, v11
  v_add_f32 v8, 1.0, v8
  v_add_f32 v9, 1.0, v9
  v_add_f32 v10, 1.0, v10
  v_add_f32 v11, 1.0, v11
  v_rcp_f32 v8, v8
  v_rcp_f32 v9, v9
  v_rcp_f32 v10, v10
  v_rcp_f32 v11, v11
  v_mul_f32 v8, v8, v60
  v_mul_f32 v9, v9, v61
  v_mul_f32 v10, v10, v62
  v_mul_f32 v11, v11, v63
  v_cvt_pk_bf16_f32 v16, v8, v9
  v_cvt_pk_bf16_f32 v17, v10, v11
  v_add_u32 v22, 0, v1
  v_xor_b32 v21, 96, v22
  ds_read_b64_tr_b16 v[24:25], v21 offset:0
  ds_read_b64_tr_b16 v[26:27], v21 offset:512
  ds_read_b64_tr_b16 v[28:29], v21 offset:4096
  ds_read_b64_tr_b16 v[30:31], v21 offset:4608
  ds_read_b64_tr_b16 v[32:33], v21 offset:8192
  ds_read_b64_tr_b16 v[34:35], v21 offset:8704
  ds_read_b64_tr_b16 v[36:37], v21 offset:12288
  ds_read_b64_tr_b16 v[38:39], v21 offset:12800
  ds_read_b64_tr_b16 v[40:41], v21 offset:16384
  s_branch gated_mix__softmax_full_mha__geglu_ffn__prompt_kernel_l28
gated_mix__softmax_full_mha__geglu_ffn__prompt_kernel_l27:
  s_cmp_ge_u32 s84, 6
  s_cselect_b32 s63, s96, s67
  s_add_u32 m0, s85, 49152
  s_add_u32 s63, s63, 1769600
  buffer_load_dwordx4 v2, s[32:35], s63 offen lds
  s_cmp_ge_u32 s84, 6
  s_cselect_b32 s63, s96, s67
  s_add_u32 m0, s85, 73728
  s_add_u32 s63, s63, 1769600
  buffer_load_dwordx4 v2, s[36:39], s63 offen lds
  s_cmp_ge_u32 s84, 5
  s_cselect_b32 s63, s96, s67
  s_add_u32 m0, s85, 57344
  s_add_u32 s63, s63, 2359424
  buffer_load_dwordx4 v2, s[32:35], s63 offen lds
  s_cmp_ge_u32 s84, 5
  s_cselect_b32 s63, s96, s67
  s_add_u32 m0, s85, 81920
  s_add_u32 s63, s63, 2359424
  buffer_load_dwordx4 v2, s[36:39], s63 offen lds
  s_cmp_ge_u32 s84, 4
  s_cselect_b32 s63, s96, s67
  s_add_u32 m0, s85, 65536
  s_add_u32 s63, s63, 2949248
  buffer_load_dwordx4 v2, s[32:35], s63 offen lds
  s_cmp_ge_u32 s84, 4
  s_cselect_b32 s63, s96, s67
  s_add_u32 m0, s85, 90112
  s_add_u32 s63, s63, 2949248
  buffer_load_dwordx4 v2, s[36:39], s63 offen lds
  v_mul_f32 v56, v48, v56
  v_mul_f32 v57, v49, v57
  v_mul_f32 v58, v50, v58
  v_mul_f32 v59, v51, v59
  v_fma_f32 v8, v48, v48, s76
  v_fma_f32 v9, v49, v49, s76
  v_fma_f32 v10, v50, v50, s76
  v_fma_f32 v11, v51, v51, s76
  v_mul_f32 v48, s77, v48
  v_mul_f32 v49, s77, v49
  v_mul_f32 v50, s77, v50
  v_mul_f32 v51, s77, v51
  v_mul_f32 v8, v8, v48
  v_mul_f32 v9, v9, v49
  v_mul_f32 v10, v10, v50
  v_mul_f32 v11, v11, v51
  v_exp_f32 v8, v8
  v_exp_f32 v9, v9
  v_exp_f32 v10, v10
  v_exp_f32 v11, v11
  v_add_f32 v8, 1.0, v8
  v_add_f32 v9, 1.0, v9
  v_add_f32 v10, 1.0, v10
  v_add_f32 v11, 1.0, v11
  v_rcp_f32 v8, v8
  v_rcp_f32 v9, v9
  v_rcp_f32 v10, v10
  v_rcp_f32 v11, v11
  v_mul_f32 v8, v8, v56
  v_mul_f32 v9, v9, v57
  v_mul_f32 v10, v10, v58
  v_mul_f32 v11, v11, v59
  v_cvt_pk_bf16_f32 v12, v8, v9
  v_cvt_pk_bf16_f32 v13, v10, v11
  v_mul_f32 v60, v52, v60
  v_mul_f32 v61, v53, v61
  v_mul_f32 v62, v54, v62
  v_mul_f32 v63, v55, v63
  v_fma_f32 v8, v52, v52, s76
  v_fma_f32 v9, v53, v53, s76
  v_fma_f32 v10, v54, v54, s76
  v_fma_f32 v11, v55, v55, s76
  v_mul_f32 v52, s77, v52
  v_mul_f32 v53, s77, v53
  v_mul_f32 v54, s77, v54
  v_mul_f32 v55, s77, v55
  v_mul_f32 v8, v8, v52
  v_mul_f32 v9, v9, v53
  v_mul_f32 v10, v10, v54
  v_mul_f32 v11, v11, v55
  v_exp_f32 v8, v8
  v_exp_f32 v9, v9
  v_exp_f32 v10, v10
  v_exp_f32 v11, v11
  v_add_f32 v8, 1.0, v8
  v_add_f32 v9, 1.0, v9
  v_add_f32 v10, 1.0, v10
  v_add_f32 v11, 1.0, v11
  v_rcp_f32 v8, v8
  v_rcp_f32 v9, v9
  v_rcp_f32 v10, v10
  v_rcp_f32 v11, v11
  v_mul_f32 v8, v8, v60
  v_mul_f32 v9, v9, v61
  v_mul_f32 v10, v10, v62
  v_mul_f32 v11, v11, v63
  v_cvt_pk_bf16_f32 v16, v8, v9
  v_cvt_pk_bf16_f32 v17, v10, v11
  v_add_u32 v22, 0, v1
  s_waitcnt vmcnt(9)
  s_waitcnt lgkmcnt(0)
  s_barrier
  v_mfma_f32_16x16x32_bf16 v[76:79], v[24:27], v[212:215], v[76:79]
  v_xor_b32 v21, 96, v22
  ds_read_b64_tr_b16 v[24:25], v21 offset:0
  ds_read_b64_tr_b16 v[26:27], v21 offset:512
  v_mfma_f32_16x16x32_bf16 v[76:79], v[28:31], v[220:223], v[76:79]
  ds_read_b64_tr_b16 v[28:29], v21 offset:4096
  ds_read_b64_tr_b16 v[30:31], v21 offset:4608
  v_mfma_f32_16x16x32_bf16 v[76:79], v[32:35], v[228:231], v[76:79]
  ds_read_b64_tr_b16 v[32:33], v21 offset:8192
  ds_read_b64_tr_b16 v[34:35], v21 offset:8704
  v_mfma_f32_16x16x32_bf16 v[76:79], v[36:39], v[236:239], v[76:79]
  v_mfma_f32_16x16x32_bf16 v[76:79], v[40:43], v[244:247], v[76:79]
  v_mfma_f32_16x16x32_bf16 v[76:79], v[44:47], v[252:255], v[76:79]
  v_mfma_f32_16x16x32_bf16 v[72:75], v[36:39], v[232:235], v[72:75]
  ds_read_b64_tr_b16 v[36:37], v21 offset:12288
  ds_read_b64_tr_b16 v[38:39], v21 offset:12800
  v_mfma_f32_16x16x32_bf16 v[72:75], v[40:43], v[240:243], v[72:75]
  ds_read_b64_tr_b16 v[40:41], v21 offset:16384
  v_mfma_f32_16x16x32_bf16 v[72:75], v[44:47], v[248:251], v[72:75]
gated_mix__softmax_full_mha__geglu_ffn__prompt_kernel_l28:
  s_waitcnt lgkmcnt(7)
  v_mfma_f32_16x16x32_bf16 v[96:99], v[24:27], v[112:115], 0
  ds_read_b64_tr_b16 v[42:43], v21 offset:16896
  s_waitcnt lgkmcnt(6)
  v_mfma_f32_16x16x32_bf16 v[96:99], v[28:31], v[120:123], v[96:99]
  ds_read_b64_tr_b16 v[44:45], v21 offset:20480
  s_waitcnt lgkmcnt(5)
  v_mfma_f32_16x16x32_bf16 v[96:99], v[32:35], v[128:131], v[96:99]
  ds_read_b64_tr_b16 v[46:47], v21 offset:20992
  v_mfma_f32_16x16x32_bf16 v[100:103], v[24:27], v[116:119], 0
  ds_read_b64_tr_b16 v[24:25], v21 offset:24576
  v_mul_f32 v72, v64, v72
  v_mfma_f32_16x16x32_bf16 v[100:103], v[28:31], v[124:127], v[100:103]
  ds_read_b64_tr_b16 v[26:27], v21 offset:25088
  v_mul_f32 v73, v65, v73
  v_mfma_f32_16x16x32_bf16 v[100:103], v[32:35], v[132:135], v[100:103]
  ds_read_b64_tr_b16 v[28:29], v21 offset:28672
  v_mul_f32 v74, v66, v74
  s_waitcnt lgkmcnt(7)
  v_mfma_f32_16x16x32_bf16 v[100:103], v[36:39], v[140:143], v[100:103]
  ds_read_b64_tr_b16 v[30:31], v21 offset:29184
  v_mul_f32 v75, v67, v75
  s_waitcnt lgkmcnt(6)
  v_mfma_f32_16x16x32_bf16 v[100:103], v[40:43], v[148:151], v[100:103]
  ds_read_b64_tr_b16 v[32:33], v21 offset:32768
  v_fma_f32 v8, v64, v64, s76
  s_waitcnt lgkmcnt(5)
  v_mfma_f32_16x16x32_bf16 v[100:103], v[44:47], v[156:159], v[100:103]
  ds_read_b64_tr_b16 v[34:35], v21 offset:33280
  v_fma_f32 v9, v65, v65, s76
  v_fma_f32 v10, v66, v66, s76
  v_mfma_f32_16x16x32_bf16 v[96:99], v[36:39], v[136:139], v[96:99]
  ds_read_b64_tr_b16 v[36:37], v21 offset:36864
  v_fma_f32 v11, v67, v67, s76
  v_mfma_f32_16x16x32_bf16 v[96:99], v[40:43], v[144:147], v[96:99]
  ds_read_b64_tr_b16 v[38:39], v21 offset:37376
  v_mul_f32 v64, s77, v64
  v_mfma_f32_16x16x32_bf16 v[96:99], v[44:47], v[152:155], v[96:99]
  ds_read_b64_tr_b16 v[40:41], v21 offset:40960
  v_mul_f32 v65, s77, v65
  s_waitcnt lgkmcnt(7)
  v_mfma_f32_16x16x32_bf16 v[104:107], v[24:27], v[112:115], 0
  ds_read_b64_tr_b16 v[42:43], v21 offset:41472
  v_mul_f32 v66, s77, v66
  s_waitcnt lgkmcnt(6)
  v_mfma_f32_16x16x32_bf16 v[104:107], v[28:31], v[120:123], v[104:107]
  ds_read_b64_tr_b16 v[44:45], v21 offset:45056
  v_mul_f32 v67, s77, v67
  v_mul_f32 v8, v8, v64
  s_waitcnt lgkmcnt(5)
  v_mfma_f32_16x16x32_bf16 v[104:107], v[32:35], v[128:131], v[104:107]
  ds_read_b64_tr_b16 v[46:47], v21 offset:45568
  v_mul_f32 v9, v9, v65
  v_mfma_f32_16x16x32_bf16 v[108:111], v[24:27], v[116:119], 0
  v_xor_b32 v20, 64, v22
  ds_read_b64_tr_b16 v[24:25], v20 offset:0
  v_mul_f32 v10, v10, v66
  v_mfma_f32_16x16x32_bf16 v[108:111], v[28:31], v[124:127], v[108:111]
  ds_read_b64_tr_b16 v[26:27], v20 offset:512
  v_mul_f32 v11, v11, v67
  v_mfma_f32_16x16x32_bf16 v[108:111], v[32:35], v[132:135], v[108:111]
  ds_read_b64_tr_b16 v[28:29], v20 offset:4096
  v_exp_f32 v8, v8
  s_waitcnt lgkmcnt(7)
  v_mfma_f32_16x16x32_bf16 v[108:111], v[36:39], v[140:143], v[108:111]
  ds_read_b64_tr_b16 v[30:31], v20 offset:4608
  v_exp_f32 v9, v9
  v_exp_f32 v10, v10
  s_waitcnt lgkmcnt(6)
  v_mfma_f32_16x16x32_bf16 v[108:111], v[40:43], v[148:151], v[108:111]
  ds_read_b64_tr_b16 v[32:33], v20 offset:8192
  v_exp_f32 v11, v11
  s_waitcnt lgkmcnt(5)
  v_mfma_f32_16x16x32_bf16 v[108:111], v[44:47], v[156:159], v[108:111]
  ds_read_b64_tr_b16 v[34:35], v20 offset:8704
  v_add_f32 v8, 1.0, v8
  v_mfma_f32_16x16x32_bf16 v[104:107], v[36:39], v[136:139], v[104:107]
  ds_read_b64_tr_b16 v[36:37], v20 offset:12288
  v_add_f32 v9, 1.0, v9
  v_mfma_f32_16x16x32_bf16 v[104:107], v[40:43], v[144:147], v[104:107]
  ds_read_b64_tr_b16 v[38:39], v20 offset:12800
  v_add_f32 v10, 1.0, v10
  v_mfma_f32_16x16x32_bf16 v[104:107], v[44:47], v[152:155], v[104:107]
  ds_read_b64_tr_b16 v[40:41], v20 offset:16384
  v_add_f32 v11, 1.0, v11
  v_rcp_f32 v8, v8
  s_waitcnt lgkmcnt(7)
  v_mfma_f32_16x16x32_bf16 v[80:83], v[24:27], v[112:115], 0
  ds_read_b64_tr_b16 v[42:43], v20 offset:16896
  v_rcp_f32 v9, v9
  s_waitcnt lgkmcnt(6)
  v_mfma_f32_16x16x32_bf16 v[80:83], v[28:31], v[120:123], v[80:83]
  ds_read_b64_tr_b16 v[44:45], v20 offset:20480
  v_rcp_f32 v10, v10
  s_waitcnt lgkmcnt(5)
  v_mfma_f32_16x16x32_bf16 v[80:83], v[32:35], v[128:131], v[80:83]
  ds_read_b64_tr_b16 v[46:47], v20 offset:20992
  v_rcp_f32 v11, v11
  v_mfma_f32_16x16x32_bf16 v[84:87], v[24:27], v[116:119], 0
  ds_read_b64_tr_b16 v[24:25], v20 offset:24576
  v_mul_f32 v8, v8, v72
  v_mfma_f32_16x16x32_bf16 v[84:87], v[28:31], v[124:127], v[84:87]
  ds_read_b64_tr_b16 v[26:27], v20 offset:25088
  v_mul_f32 v9, v9, v73
  v_mul_f32 v10, v10, v74
  v_mfma_f32_16x16x32_bf16 v[84:87], v[32:35], v[132:135], v[84:87]
  ds_read_b64_tr_b16 v[28:29], v20 offset:28672
  v_mul_f32 v11, v11, v75
  s_waitcnt lgkmcnt(7)
  v_mfma_f32_16x16x32_bf16 v[84:87], v[36:39], v[140:143], v[84:87]
  ds_read_b64_tr_b16 v[30:31], v20 offset:29184
  v_cvt_pk_bf16_f32 v14, v8, v9
  s_waitcnt lgkmcnt(6)
  v_mfma_f32_16x16x32_bf16 v[84:87], v[40:43], v[148:151], v[84:87]
  ds_read_b64_tr_b16 v[32:33], v20 offset:32768
  v_cvt_pk_bf16_f32 v15, v10, v11
  s_waitcnt lgkmcnt(5)
  v_mfma_f32_16x16x32_bf16 v[84:87], v[44:47], v[156:159], v[84:87]
  ds_read_b64_tr_b16 v[34:35], v20 offset:33280
  s_add_u32 s66, s68, 0
  v_mfma_f32_16x16x32_bf16 v[80:83], v[36:39], v[136:139], v[80:83]
  ds_read_b64_tr_b16 v[36:37], v20 offset:36864
  buffer_store_dwordx4 v[12:15], v4, s[44:47], s66 offen offset:0 sc1
  v_mul_f32 v76, v68, v76
  v_mfma_f32_16x16x32_bf16 v[80:83], v[40:43], v[144:147], v[80:83]
  ds_read_b64_tr_b16 v[38:39], v20 offset:37376
  v_mul_f32 v77, v69, v77
  v_mfma_f32_16x16x32_bf16 v[80:83], v[44:47], v[152:155], v[80:83]
  ds_read_b64_tr_b16 v[40:41], v20 offset:40960
  v_mul_f32 v78, v70, v78
  s_waitcnt lgkmcnt(7)
  v_mfma_f32_16x16x32_bf16 v[88:91], v[24:27], v[112:115], 0
  ds_read_b64_tr_b16 v[42:43], v20 offset:41472
  v_mul_f32 v79, v71, v79
  s_waitcnt lgkmcnt(6)
  v_mfma_f32_16x16x32_bf16 v[88:91], v[28:31], v[120:123], v[88:91]
  ds_read_b64_tr_b16 v[44:45], v20 offset:45056
  v_fma_f32 v8, v68, v68, s76
  s_waitcnt lgkmcnt(5)
  v_mfma_f32_16x16x32_bf16 v[88:91], v[32:35], v[128:131], v[88:91]
  ds_read_b64_tr_b16 v[46:47], v20 offset:45568
  v_fma_f32 v9, v69, v69, s76
  v_fma_f32 v10, v70, v70, s76
  v_mfma_f32_16x16x32_bf16 v[92:95], v[24:27], v[116:119], 0
  v_xor_b32 v21, 0, v22
  ds_read_b64_tr_b16 v[24:25], v21 offset:0
  v_fma_f32 v11, v71, v71, s76
  v_mfma_f32_16x16x32_bf16 v[92:95], v[28:31], v[124:127], v[92:95]
  ds_read_b64_tr_b16 v[26:27], v21 offset:512
  v_mul_f32 v68, s77, v68
  v_mfma_f32_16x16x32_bf16 v[92:95], v[32:35], v[132:135], v[92:95]
  ds_read_b64_tr_b16 v[28:29], v21 offset:4096
  v_mul_f32 v69, s77, v69
  s_waitcnt lgkmcnt(7)
  v_mfma_f32_16x16x32_bf16 v[92:95], v[36:39], v[140:143], v[92:95]
  ds_read_b64_tr_b16 v[30:31], v21 offset:4608
  v_mul_f32 v70, s77, v70
  s_waitcnt lgkmcnt(6)
  v_mfma_f32_16x16x32_bf16 v[92:95], v[40:43], v[148:151], v[92:95]
  ds_read_b64_tr_b16 v[32:33], v21 offset:8192
  v_mul_f32 v71, s77, v71
  v_mul_f32 v8, v8, v68
  s_waitcnt lgkmcnt(5)
  v_mfma_f32_16x16x32_bf16 v[92:95], v[44:47], v[156:159], v[92:95]
  ds_read_b64_tr_b16 v[34:35], v21 offset:8704
  v_mul_f32 v9, v9, v69
  v_mfma_f32_16x16x32_bf16 v[88:91], v[36:39], v[136:139], v[88:91]
  ds_read_b64_tr_b16 v[36:37], v21 offset:12288
  v_mul_f32 v10, v10, v70
  v_mfma_f32_16x16x32_bf16 v[88:91], v[40:43], v[144:147], v[88:91]
  ds_read_b64_tr_b16 v[38:39], v21 offset:12800
  v_mul_f32 v11, v11, v71
  v_mfma_f32_16x16x32_bf16 v[88:91], v[44:47], v[152:155], v[88:91]
  ds_read_b64_tr_b16 v[40:41], v21 offset:16384
  v_exp_f32 v8, v8
  s_waitcnt lgkmcnt(7)
  v_mfma_f32_16x16x32_bf16 v[48:51], v[24:27], v[112:115], 0
  ds_read_b64_tr_b16 v[42:43], v21 offset:16896
  v_exp_f32 v9, v9
  v_exp_f32 v10, v10
  s_waitcnt lgkmcnt(6)
  v_mfma_f32_16x16x32_bf16 v[48:51], v[28:31], v[120:123], v[48:51]
  ds_read_b64_tr_b16 v[44:45], v21 offset:20480
  v_exp_f32 v11, v11
  s_waitcnt lgkmcnt(5)
  v_mfma_f32_16x16x32_bf16 v[48:51], v[32:35], v[128:131], v[48:51]
  ds_read_b64_tr_b16 v[46:47], v21 offset:20992
  v_add_f32 v8, 1.0, v8
  v_mfma_f32_16x16x32_bf16 v[52:55], v[24:27], v[116:119], 0
  ds_read_b64_tr_b16 v[24:25], v21 offset:24576
  v_add_f32 v9, 1.0, v9
  v_mfma_f32_16x16x32_bf16 v[52:55], v[28:31], v[124:127], v[52:55]
  ds_read_b64_tr_b16 v[26:27], v21 offset:25088
  v_add_f32 v10, 1.0, v10
  v_mfma_f32_16x16x32_bf16 v[52:55], v[32:35], v[132:135], v[52:55]
  ds_read_b64_tr_b16 v[28:29], v21 offset:28672
  v_add_f32 v11, 1.0, v11
  v_rcp_f32 v8, v8
  s_waitcnt lgkmcnt(7)
  v_mfma_f32_16x16x32_bf16 v[52:55], v[36:39], v[140:143], v[52:55]
  ds_read_b64_tr_b16 v[30:31], v21 offset:29184
  v_rcp_f32 v9, v9
  s_waitcnt lgkmcnt(6)
  v_mfma_f32_16x16x32_bf16 v[52:55], v[40:43], v[148:151], v[52:55]
  ds_read_b64_tr_b16 v[32:33], v21 offset:32768
  v_rcp_f32 v10, v10
  s_waitcnt lgkmcnt(5)
  v_mfma_f32_16x16x32_bf16 v[52:55], v[44:47], v[156:159], v[52:55]
  ds_read_b64_tr_b16 v[34:35], v21 offset:33280
  v_rcp_f32 v11, v11
  v_mfma_f32_16x16x32_bf16 v[48:51], v[36:39], v[136:139], v[48:51]
  ds_read_b64_tr_b16 v[36:37], v21 offset:36864
  v_mul_f32 v8, v8, v76
  v_mfma_f32_16x16x32_bf16 v[48:51], v[40:43], v[144:147], v[48:51]
  ds_read_b64_tr_b16 v[38:39], v21 offset:37376
  v_mul_f32 v9, v9, v77
  v_mul_f32 v10, v10, v78
  v_mfma_f32_16x16x32_bf16 v[48:51], v[44:47], v[152:155], v[48:51]
  ds_read_b64_tr_b16 v[40:41], v21 offset:40960
  v_mul_f32 v11, v11, v79
  s_waitcnt lgkmcnt(7)
  v_mfma_f32_16x16x32_bf16 v[56:59], v[24:27], v[112:115], 0
  ds_read_b64_tr_b16 v[42:43], v21 offset:41472
  v_cvt_pk_bf16_f32 v18, v8, v9
  s_waitcnt lgkmcnt(6)
  v_mfma_f32_16x16x32_bf16 v[56:59], v[28:31], v[120:123], v[56:59]
  ds_read_b64_tr_b16 v[44:45], v21 offset:45056
  v_cvt_pk_bf16_f32 v19, v10, v11
  s_waitcnt lgkmcnt(5)
  v_mfma_f32_16x16x32_bf16 v[56:59], v[32:35], v[128:131], v[56:59]
  ds_read_b64_tr_b16 v[46:47], v21 offset:45568
  buffer_store_dwordx4 v[16:19], v4, s[44:47], s66 offen offset:256 sc1
  v_mfma_f32_16x16x32_bf16 v[60:63], v[24:27], v[116:119], 0
  v_xor_b32 v20, 32, v22
  ds_read_b64_tr_b16 v[24:25], v20 offset:0
  v_mfma_f32_16x16x32_bf16 v[60:63], v[28:31], v[124:127], v[60:63]
  ds_read_b64_tr_b16 v[26:27], v20 offset:512
  v_mfma_f32_16x16x32_bf16 v[60:63], v[32:35], v[132:135], v[60:63]
  ds_read_b64_tr_b16 v[28:29], v20 offset:4096
  s_waitcnt lgkmcnt(7)
  v_mfma_f32_16x16x32_bf16 v[60:63], v[36:39], v[140:143], v[60:63]
  ds_read_b64_tr_b16 v[30:31], v20 offset:4608
  s_waitcnt lgkmcnt(6)
  v_mfma_f32_16x16x32_bf16 v[60:63], v[40:43], v[148:151], v[60:63]
  ds_read_b64_tr_b16 v[32:33], v20 offset:8192
  s_waitcnt lgkmcnt(5)
  v_mfma_f32_16x16x32_bf16 v[60:63], v[44:47], v[156:159], v[60:63]
  ds_read_b64_tr_b16 v[34:35], v20 offset:8704
  v_mfma_f32_16x16x32_bf16 v[56:59], v[36:39], v[136:139], v[56:59]
  ds_read_b64_tr_b16 v[36:37], v20 offset:12288
  v_mfma_f32_16x16x32_bf16 v[56:59], v[40:43], v[144:147], v[56:59]
  ds_read_b64_tr_b16 v[38:39], v20 offset:12800
  v_mfma_f32_16x16x32_bf16 v[56:59], v[44:47], v[152:155], v[56:59]
  ds_read_b64_tr_b16 v[40:41], v20 offset:16384
  s_waitcnt lgkmcnt(7)
  v_mfma_f32_16x16x32_bf16 v[64:67], v[24:27], v[112:115], 0
  ds_read_b64_tr_b16 v[42:43], v20 offset:16896
  s_waitcnt lgkmcnt(6)
  v_mfma_f32_16x16x32_bf16 v[64:67], v[28:31], v[120:123], v[64:67]
  ds_read_b64_tr_b16 v[44:45], v20 offset:20480
  s_waitcnt lgkmcnt(5)
  v_mfma_f32_16x16x32_bf16 v[64:67], v[32:35], v[128:131], v[64:67]
  ds_read_b64_tr_b16 v[46:47], v20 offset:20992
  v_mfma_f32_16x16x32_bf16 v[68:71], v[24:27], v[116:119], 0
  ds_read_b64_tr_b16 v[24:25], v20 offset:24576
  v_mfma_f32_16x16x32_bf16 v[68:71], v[28:31], v[124:127], v[68:71]
  ds_read_b64_tr_b16 v[26:27], v20 offset:25088
  v_mfma_f32_16x16x32_bf16 v[68:71], v[32:35], v[132:135], v[68:71]
  ds_read_b64_tr_b16 v[28:29], v20 offset:28672
  s_waitcnt lgkmcnt(7)
  v_mfma_f32_16x16x32_bf16 v[68:71], v[36:39], v[140:143], v[68:71]
  ds_read_b64_tr_b16 v[30:31], v20 offset:29184
  s_waitcnt lgkmcnt(6)
  v_mfma_f32_16x16x32_bf16 v[68:71], v[40:43], v[148:151], v[68:71]
  ds_read_b64_tr_b16 v[32:33], v20 offset:32768
  s_waitcnt lgkmcnt(5)
  v_mfma_f32_16x16x32_bf16 v[68:71], v[44:47], v[156:159], v[68:71]
  ds_read_b64_tr_b16 v[34:35], v20 offset:33280
  v_mfma_f32_16x16x32_bf16 v[64:67], v[36:39], v[136:139], v[64:67]
  ds_read_b64_tr_b16 v[36:37], v20 offset:36864
  v_mfma_f32_16x16x32_bf16 v[64:67], v[40:43], v[144:147], v[64:67]
  ds_read_b64_tr_b16 v[38:39], v20 offset:37376
  v_mfma_f32_16x16x32_bf16 v[64:67], v[44:47], v[152:155], v[64:67]
  ds_read_b64_tr_b16 v[40:41], v20 offset:40960
  s_waitcnt lgkmcnt(7)
  v_mfma_f32_16x16x32_bf16 v[72:75], v[24:27], v[112:115], 0
  ds_read_b64_tr_b16 v[42:43], v20 offset:41472
  s_waitcnt lgkmcnt(6)
  v_mfma_f32_16x16x32_bf16 v[72:75], v[28:31], v[120:123], v[72:75]
  ds_read_b64_tr_b16 v[44:45], v20 offset:45056
  s_waitcnt lgkmcnt(5)
  v_mfma_f32_16x16x32_bf16 v[72:75], v[32:35], v[128:131], v[72:75]
  ds_read_b64_tr_b16 v[46:47], v20 offset:45568
  s_cmp_lt_u32 s56, 4
  s_cbranch_scc1 gated_mix__softmax_full_mha__geglu_ffn__prompt_kernel_l29
  v_mfma_f32_16x16x32_bf16 v[76:79], v[24:27], v[116:119], 0
  v_mfma_f32_16x16x32_bf16 v[76:79], v[28:31], v[124:127], v[76:79]
  v_mfma_f32_16x16x32_bf16 v[76:79], v[32:35], v[132:135], v[76:79]
  s_waitcnt lgkmcnt(4)
  v_mfma_f32_16x16x32_bf16 v[76:79], v[36:39], v[140:143], v[76:79]
  s_waitcnt lgkmcnt(2)
  v_mfma_f32_16x16x32_bf16 v[76:79], v[40:43], v[148:151], v[76:79]
  s_waitcnt lgkmcnt(0)
  v_mfma_f32_16x16x32_bf16 v[76:79], v[44:47], v[156:159], v[76:79]
  s_waitcnt vmcnt(16)
  s_waitcnt lgkmcnt(0)
  s_barrier
  v_mfma_f32_16x16x32_bf16 v[72:75], v[36:39], v[136:139], v[72:75]
  v_mfma_f32_16x16x32_bf16 v[72:75], v[40:43], v[144:147], v[72:75]
  v_mfma_f32_16x16x32_bf16 v[72:75], v[44:47], v[152:155], v[72:75]
  s_mov_b32 s40, s20
  s_and_b32 s41, s21, 0xffff
  s_mov_b32 s42, 2359296
  s_mov_b32 s43, 0x00020000
  s_lshr_b32 s4, s2, 3
  s_and_b32 s63, s4, 3
  s_lshl_b32 s5, s57, 2
  s_add_u32 s5, s5, s63
  s_lshr_b32 s6, s4, 2
  s_and_b32 s7, s56, 3
  s_mul_i32 s12, s7, 2336
  s_lshl_b32 s65, s6, 3
  s_lshl_b32 s64, s7, 1
  s_add_u32 s18, s65, s64
  s_mul_i32 s15, s7, 3072
  s_add_u32 s15, s15, 149504
  s_mov_b32 s19, 0
  s_add_u32 s63, s5, 32
  s_mul_i32 s64, s63, 171
  s_lshr_b32 s64, s64, 9
  s_mul_i32 s65, s64, 3
  s_sub_u32 s63, s63, s65
  s_mul_i32 s63, s63, 288
  s_lshl_b32 s64, s64, 18
  s_add_u32 s8, s63, s64
  s_add_u32 s8, s8, 24846336
  s_add_u32 s63, s5, 64
  s_mul_i32 s64, s63, 171
  s_lshr_b32 s64, s64, 9
  s_mul_i32 s65, s64, 3
  s_sub_u32 s63, s63, s65
  s_mul_i32 s63, s63, 288
  s_lshl_b32 s64, s64, 18
  s_add_u32 s9, s63, s64
  s_add_u32 s9, s9, 24846336
  s_sub_u32 s9, s9, s8
  v_add_u32 v8, 0, v0
  v_mul_u32_u24 v9, 57, v8
  v_lshrrev_b32 v9, 10, v9
  v_mul_u32_u24 v10, 18, v9
  v_sub_u32 v8, v8, v10
  v_lshlrev_b32 v8, 4, v8
  v_lshrrev_b32 v10, 1, v9
  v_lshl_add_u32 v10, v10, 10, v8
  v_and_b32 v11, 1, v9
  v_mul_lo_u32 v11, v11, s9
  v_add_u32 v120, v10, v11
  v_add_u32 v8, 48, v0
  v_mul_u32_u24 v9, 57, v8
  v_lshrrev_b32 v9, 10, v9
  v_mul_u32_u24 v10, 18, v9
  v_sub_u32 v8, v8, v10
  v_lshlrev_b32 v8, 4, v8
  v_lshrrev_b32 v10, 1, v9
  v_lshl_add_u32 v10, v10, 10, v8
  v_and_b32 v11, 1, v9
  v_mul_lo_u32 v11, v11, s9
  v_add_u32 v121, v10, v11
  v_add_u32 v8, 96, v0
  v_mul_u32_u24 v9, 57, v8
  v_lshrrev_b32 v9, 10, v9
  v_mul_u32_u24 v10, 18, v9
  v_sub_u32 v8, v8, v10
  v_lshlrev_b32 v8, 4, v8
  v_lshrrev_b32 v10, 1, v9
  v_lshl_add_u32 v10, v10, 10, v8
  v_and_b32 v11, 1, v9
  v_mul_lo_u32 v11, v11, s9
  v_add_u32 v122, v10, v11
  v_add_u32 v22, 49152, v1
  v_xor_b32 v21, 96, v22
  ds_read_b64_tr_b16 v[24:25], v21 offset:0
  ds_read_b64_tr_b16 v[26:27], v21 offset:512
  ds_read_b64_tr_b16 v[28:29], v21 offset:4096
  ds_read_b64_tr_b16 v[30:31], v21 offset:4608
  ds_read_b64_tr_b16 v[32:33], v21 offset:8192
  ds_read_b64_tr_b16 v[34:35], v21 offset:8704
  ds_read_b64_tr_b16 v[36:37], v21 offset:12288
  ds_read_b64_tr_b16 v[38:39], v21 offset:12800
  ds_read_b64_tr_b16 v[40:41], v21 offset:16384
  s_branch gated_mix__softmax_full_mha__geglu_ffn__prompt_kernel_l30
gated_mix__softmax_full_mha__geglu_ffn__prompt_kernel_l29:
  s_cmp_ge_u32 s84, 3
  s_cselect_b32 s63, s96, s67
  s_add_u32 m0, s85, 98304
  s_add_u32 s63, s63, 3539072
  buffer_load_dwordx4 v2, s[32:35], s63 offen lds
  s_cmp_ge_u32 s84, 3
  s_cselect_b32 s63, s96, s67
  s_add_u32 m0, s85, 122880
  s_add_u32 s63, s63, 3539072
  buffer_load_dwordx4 v2, s[36:39], s63 offen lds
  s_cmp_ge_u32 s84, 2
  s_cselect_b32 s63, s96, s67
  s_add_u32 m0, s85, 106496
  s_add_u32 s63, s63, 4128896
  buffer_load_dwordx4 v2, s[32:35], s63 offen lds
  s_cmp_ge_u32 s84, 2
  s_cselect_b32 s63, s96, s67
  s_add_u32 m0, s85, 131072
  s_add_u32 s63, s63, 4128896
  buffer_load_dwordx4 v2, s[36:39], s63 offen lds
  s_cmp_ge_u32 s84, 1
  s_cselect_b32 s63, s96, s67
  s_add_u32 m0, s85, 114688
  s_add_u32 s63, s63, 4718720
  buffer_load_dwordx4 v2, s[32:35], s63 offen lds
  s_cmp_ge_u32 s84, 1
  s_cselect_b32 s63, s96, s67
  s_add_u32 m0, s85, 139264
  s_add_u32 s63, s63, 4718720
  buffer_load_dwordx4 v2, s[36:39], s63 offen lds
  s_mov_b32 s40, s20
  s_and_b32 s41, s21, 0xffff
  s_mov_b32 s42, 2359296
  s_mov_b32 s43, 0x00020000
  s_lshr_b32 s4, s2, 3
  s_and_b32 s63, s4, 3
  s_lshl_b32 s5, s57, 2
  s_add_u32 s5, s5, s63
  s_lshr_b32 s6, s4, 2
  s_and_b32 s7, s56, 3
  s_mul_i32 s12, s7, 2336
  s_lshl_b32 s65, s6, 3
  s_lshl_b32 s64, s7, 1
  s_add_u32 s18, s65, s64
  s_mul_i32 s15, s7, 3072
  s_add_u32 s15, s15, 149504
  s_mov_b32 s19, 0
  s_add_u32 s63, s5, 32
  s_mul_i32 s64, s63, 171
  s_lshr_b32 s64, s64, 9
  s_mul_i32 s65, s64, 3
  s_sub_u32 s63, s63, s65
  s_mul_i32 s63, s63, 288
  s_lshl_b32 s64, s64, 18
  s_add_u32 s8, s63, s64
  s_add_u32 s8, s8, 24846336
  s_add_u32 s63, s5, 64
  s_mul_i32 s64, s63, 171
  s_lshr_b32 s64, s64, 9
  s_mul_i32 s65, s64, 3
  s_sub_u32 s63, s63, s65
  s_mul_i32 s63, s63, 288
  s_lshl_b32 s64, s64, 18
  s_add_u32 s9, s63, s64
  s_add_u32 s9, s9, 24846336
  s_sub_u32 s9, s9, s8
  s_add_u32 s63, s5, 0
  s_mul_i32 s64, s63, 171
  s_lshr_b32 s64, s64, 9
  s_mul_i32 s65, s64, 3
  s_sub_u32 s63, s63, s65
  s_mul_i32 s63, s63, 288
  s_lshl_b32 s64, s64, 18
  s_add_u32 s16, s63, s64
  s_add_u32 s16, s16, 24846336
  s_lshl_b32 s63, s18, 12
  s_add_u32 s16, s16, s63
  s_lshl_b32 s63, s18, 4
  s_add_u32 s63, s63, s5
  s_mul_i32 s17, s63, 2304
  s_add_u32 s17, s17, 33234944
  v_mov_b32 v12, -1
  v_mov_b32 v13, -1
  v_mov_b32 v14, -1
  v_mov_b32 v15, -1
  v_lshlrev_b32 v8, 4, v0
  buffer_store_dwordx4 v[12:15], v8, s[44:47], s17 offen sc1
  buffer_store_dwordx4 v[12:15], v8, s[44:47], s17 offen offset:1024 sc1
  s_mov_b64 exec, 0xffff
  buffer_store_dwordx4 v[12:15], v8, s[44:47], s17 offen offset:2048 sc1
  s_mov_b64 exec, -1
  v_add_u32 v8, 0, v0
  v_mul_u32_u24 v9, 57, v8
  v_lshrrev_b32 v9, 10, v9
  v_mul_u32_u24 v10, 18, v9
  v_sub_u32 v8, v8, v10
  v_lshlrev_b32 v8, 4, v8
  v_lshrrev_b32 v10, 1, v9
  v_lshl_add_u32 v10, v10, 10, v8
  v_and_b32 v11, 1, v9
  v_mul_lo_u32 v11, v11, s9
  v_add_u32 v120, v10, v11
  v_lshl_add_u32 v128, v9, 10, v8
  v_add_u32 v8, 48, v0
  v_mul_u32_u24 v9, 57, v8
  v_lshrrev_b32 v9, 10, v9
  v_mul_u32_u24 v10, 18, v9
  v_sub_u32 v8, v8, v10
  v_lshlrev_b32 v8, 4, v8
  v_lshrrev_b32 v10, 1, v9
  v_lshl_add_u32 v10, v10, 10, v8
  v_and_b32 v11, 1, v9
  v_mul_lo_u32 v11, v11, s9
  v_add_u32 v121, v10, v11
  v_lshl_add_u32 v129, v9, 10, v8
  v_add_u32 v8, 96, v0
  v_mul_u32_u24 v9, 57, v8
  v_lshrrev_b32 v9, 10, v9
  v_mul_u32_u24 v10, 18, v9
  v_sub_u32 v8, v8, v10
  v_lshlrev_b32 v8, 4, v8
  v_lshrrev_b32 v10, 1, v9
  v_lshl_add_u32 v10, v10, 10, v8
  v_and_b32 v11, 1, v9
  v_mul_lo_u32 v11, v11, s9
  v_add_u32 v122, v10, v11
  v_lshl_add_u32 v130, v9, 10, v8
  v_lshlrev_b32 v8, 2, v0
  v_and_b32 v8, 63, v8
  v_mov_b32 v9, 0
  v_add_u32 v8, 161792, v8
  ds_write_b32 v8, v9
  v_add_u32 v22, 49152, v1
  s_waitcnt vmcnt(11)
  s_waitcnt lgkmcnt(0)
  s_barrier
  v_mfma_f32_16x16x32_bf16 v[76:79], v[24:27], v[116:119], 0
  v_xor_b32 v21, 96, v22
  ds_read_b64_tr_b16 v[24:25], v21 offset:0
  ds_read_b64_tr_b16 v[26:27], v21 offset:512
  v_mfma_f32_16x16x32_bf16 v[76:79], v[28:31], v[124:127], v[76:79]
  ds_read_b64_tr_b16 v[28:29], v21 offset:4096
  ds_read_b64_tr_b16 v[30:31], v21 offset:4608
  v_mfma_f32_16x16x32_bf16 v[76:79], v[32:35], v[132:135], v[76:79]
  ds_read_b64_tr_b16 v[32:33], v21 offset:8192
  ds_read_b64_tr_b16 v[34:35], v21 offset:8704
  v_mfma_f32_16x16x32_bf16 v[76:79], v[36:39], v[140:143], v[76:79]
  v_mfma_f32_16x16x32_bf16 v[76:79], v[40:43], v[148:151], v[76:79]
  v_mfma_f32_16x16x32_bf16 v[76:79], v[44:47], v[156:159], v[76:79]
  v_mfma_f32_16x16x32_bf16 v[72:75], v[36:39], v[136:139], v[72:75]
  ds_read_b64_tr_b16 v[36:37], v21 offset:12288
  ds_read_b64_tr_b16 v[38:39], v21 offset:12800
  v_mfma_f32_16x16x32_bf16 v[72:75], v[40:43], v[144:147], v[72:75]
  ds_read_b64_tr_b16 v[40:41], v21 offset:16384
  v_mfma_f32_16x16x32_bf16 v[72:75], v[44:47], v[152:155], v[72:75]
gated_mix__softmax_full_mha__geglu_ffn__prompt_kernel_l30:
  s_waitcnt lgkmcnt(7)
  v_mfma_f32_16x16x32_bf16 v[96:99], v[24:27], v[160:163], v[96:99]
  ds_read_b64_tr_b16 v[42:43], v21 offset:16896
  s_waitcnt lgkmcnt(6)
  v_mfma_f32_16x16x32_bf16 v[96:99], v[28:31], v[168:171], v[96:99]
  ds_read_b64_tr_b16 v[44:45], v21 offset:20480
  s_cmp_ge_u32 s56, 4
  s_cbranch_scc1 gated_mix__softmax_full_mha__geglu_ffn__prompt_kernel_l31
  v_and_b32 v112, 31, v0
  v_lshlrev_b32 v112, 2, v112
  buffer_load_dword v113, v112, s[44:47], s99 offen sc1
gated_mix__softmax_full_mha__geglu_ffn__prompt_kernel_l31:
  s_waitcnt lgkmcnt(5)
  v_mfma_f32_16x16x32_bf16 v[96:99], v[32:35], v[176:179], v[96:99]
  ds_read_b64_tr_b16 v[46:47], v21 offset:20992
  v_mfma_f32_16x16x32_bf16 v[100:103], v[24:27], v[164:167], v[100:103]
  ds_read_b64_tr_b16 v[24:25], v21 offset:24576
  v_mfma_f32_16x16x32_bf16 v[100:103], v[28:31], v[172:175], v[100:103]
  ds_read_b64_tr_b16 v[26:27], v21 offset:25088
  v_mfma_f32_16x16x32_bf16 v[100:103], v[32:35], v[180:183], v[100:103]
  ds_read_b64_tr_b16 v[28:29], v21 offset:28672
  s_waitcnt lgkmcnt(7)
  v_mfma_f32_16x16x32_bf16 v[100:103], v[36:39], v[188:191], v[100:103]
  ds_read_b64_tr_b16 v[30:31], v21 offset:29184
  s_waitcnt lgkmcnt(6)
  v_mfma_f32_16x16x32_bf16 v[100:103], v[40:43], v[196:199], v[100:103]
  ds_read_b64_tr_b16 v[32:33], v21 offset:32768
  s_waitcnt lgkmcnt(5)
  v_mfma_f32_16x16x32_bf16 v[100:103], v[44:47], v[204:207], v[100:103]
  ds_read_b64_tr_b16 v[34:35], v21 offset:33280
  v_mfma_f32_16x16x32_bf16 v[96:99], v[36:39], v[184:187], v[96:99]
  ds_read_b64_tr_b16 v[36:37], v21 offset:36864
  v_mfma_f32_16x16x32_bf16 v[96:99], v[40:43], v[192:195], v[96:99]
  ds_read_b64_tr_b16 v[38:39], v21 offset:37376
  v_mfma_f32_16x16x32_bf16 v[96:99], v[44:47], v[200:203], v[96:99]
  ds_read_b64_tr_b16 v[40:41], v21 offset:40960
  s_waitcnt lgkmcnt(7)
  v_mfma_f32_16x16x32_bf16 v[104:107], v[24:27], v[160:163], v[104:107]
  ds_read_b64_tr_b16 v[42:43], v21 offset:41472
  s_waitcnt lgkmcnt(6)
  v_mfma_f32_16x16x32_bf16 v[104:107], v[28:31], v[168:171], v[104:107]
  ds_read_b64_tr_b16 v[44:45], v21 offset:45056
  s_waitcnt lgkmcnt(5)
  v_mfma_f32_16x16x32_bf16 v[104:107], v[32:35], v[176:179], v[104:107]
  ds_read_b64_tr_b16 v[46:47], v21 offset:45568
  s_cmp_lt_u32 s56, 4
  s_cbranch_scc1 gated_mix__softmax_full_mha__geglu_ffn__prompt_kernel_l32
  v_mfma_f32_16x16x32_bf16 v[108:111], v[24:27], v[164:167], v[108:111]
  v_mfma_f32_16x16x32_bf16 v[108:111], v[28:31], v[172:175], v[108:111]
  v_mfma_f32_16x16x32_bf16 v[108:111], v[32:35], v[180:183], v[108:111]
  s_waitcnt lgkmcnt(4)
  v_mfma_f32_16x16x32_bf16 v[108:111], v[36:39], v[188:191], v[108:111]
  s_waitcnt lgkmcnt(2)
  v_mfma_f32_16x16x32_bf16 v[108:111], v[40:43], v[196:199], v[108:111]
  s_waitcnt lgkmcnt(0)
  v_mfma_f32_16x16x32_bf16 v[108:111], v[44:47], v[204:207], v[108:111]
  s_waitcnt vmcnt(0)
  s_waitcnt lgkmcnt(0)
  s_barrier
  v_mfma_f32_16x16x32_bf16 v[104:107], v[36:39], v[184:187], v[104:107]
  v_mfma_f32_16x16x32_bf16 v[104:107], v[40:43], v[192:195], v[104:107]
  v_mfma_f32_16x16x32_bf16 v[104:107], v[44:47], v[200:203], v[104:107]
  s_cmp_lg_u32 s56, 7
  s_cbranch_scc1 gated_mix__softmax_full_mha__geglu_ffn__prompt_kernel_l34
  v_lshrrev_b32 v8, 1, v0
  v_and_b32 v9, 1, v0
  s_lshl_b32 s63, s58, 1
  v_add_u32 v9, s63, v9
  v_bfe_u32 v10, v0, 3, 1
  s_lshl_b32 s63, s59, 1
  v_add_u32 v10, s63, v10
  v_and_b32 v11, 7, v0
  v_cmp_gt_u32 vcc, 32, v0
  s_nop 1
  v_cndmask_b32 v8, v10, v8, vcc
  v_cndmask_b32 v9, v11, v9, vcc
  s_add_u32 s63, s58, 8
  v_mov_b32 v10, s63
  v_mov_b32 v11, s59
  v_cndmask_b32 v10, v10, v11, vcc
  v_and_b32 v11, 3, v8
  v_lshl_add_u32 v9, v11, 3, v9
  v_lshrrev_b32 v8, 2, v8
  v_lshlrev_b32 v8, 1, v8
  v_lshl_add_u32 v8, v9, 3, v8
  v_lshlrev_b32 v8, 9, v8
  v_lshl_add_u32 v8, v10, 2, v8
  s_lshr_b32 s63, s57, 2
  s_lshl_b32 s63, s63, 9
  s_and_b32 s64, s57, 3
  s_lshl_b32 s64, s64, 6
  s_add_u32 s63, s63, s64
  s_add_u32 s63, s63, 45088896
  v_mov_b32 v11, s0
  s_mov_b32 exec_hi, 0xffff
  buffer_store_dword v11, v8, s[44:47], s63 offen sc1
  s_mov_b32 exec_hi, -1
gated_mix__softmax_full_mha__geglu_ffn__prompt_kernel_l34:
  v_add_u32 v7, 98304, v1
  v_xor_b32 v21, 96, v7
  ds_read_b64_tr_b16 v[24:25], v21 offset:0
  ds_read_b64_tr_b16 v[26:27], v21 offset:512
  ds_read_b64_tr_b16 v[28:29], v21 offset:4096
  ds_read_b64_tr_b16 v[30:31], v21 offset:4608
  ds_read_b64_tr_b16 v[32:33], v21 offset:8192
  ds_read_b64_tr_b16 v[34:35], v21 offset:8704
  ds_read_b64_tr_b16 v[36:37], v21 offset:12288
  ds_read_b64_tr_b16 v[38:39], v21 offset:12800
  ds_read_b64_tr_b16 v[40:41], v21 offset:16384
  s_branch gated_mix__softmax_full_mha__geglu_ffn__prompt_kernel_l33
gated_mix__softmax_full_mha__geglu_ffn__prompt_kernel_l32:
  v_add_u32 v7, 98304, v1
  s_waitcnt vmcnt(4)
  s_waitcnt lgkmcnt(0)
  s_barrier
  v_mfma_f32_16x16x32_bf16 v[108:111], v[24:27], v[164:167], v[108:111]
  v_xor_b32 v21, 96, v7
  ds_read_b64_tr_b16 v[24:25], v21 offset:0
  ds_read_b64_tr_b16 v[26:27], v21 offset:512
  v_mfma_f32_16x16x32_bf16 v[108:111], v[28:31], v[172:175], v[108:111]
  ds_read_b64_tr_b16 v[28:29], v21 offset:4096
  ds_read_b64_tr_b16 v[30:31], v21 offset:4608
  v_mfma_f32_16x16x32_bf16 v[108:111], v[32:35], v[180:183], v[108:111]
  ds_read_b64_tr_b16 v[32:33], v21 offset:8192
  ds_read_b64_tr_b16 v[34:35], v21 offset:8704
  v_mfma_f32_16x16x32_bf16 v[108:111], v[36:39], v[188:191], v[108:111]
  v_mfma_f32_16x16x32_bf16 v[108:111], v[40:43], v[196:199], v[108:111]
  v_mfma_f32_16x16x32_bf16 v[108:111], v[44:47], v[204:207], v[108:111]
  v_mfma_f32_16x16x32_bf16 v[104:107], v[36:39], v[184:187], v[104:107]
  ds_read_b64_tr_b16 v[36:37], v21 offset:12288
  ds_read_b64_tr_b16 v[38:39], v21 offset:12800
  v_mfma_f32_16x16x32_bf16 v[104:107], v[40:43], v[192:195], v[104:107]
  ds_read_b64_tr_b16 v[40:41], v21 offset:16384
  v_mfma_f32_16x16x32_bf16 v[104:107], v[44:47], v[200:203], v[104:107]
gated_mix__softmax_full_mha__geglu_ffn__prompt_kernel_l33:
  s_waitcnt lgkmcnt(7)
  v_mfma_f32_16x16x32_bf16 v[96:99], v[24:27], v[208:211], v[96:99]
  ds_read_b64_tr_b16 v[42:43], v21 offset:16896
  s_waitcnt lgkmcnt(6)
  v_mfma_f32_16x16x32_bf16 v[96:99], v[28:31], v[216:219], v[96:99]
  ds_read_b64_tr_b16 v[44:45], v21 offset:20480
  s_waitcnt lgkmcnt(5)
  v_mfma_f32_16x16x32_bf16 v[96:99], v[32:35], v[224:227], v[96:99]
  ds_read_b64_tr_b16 v[46:47], v21 offset:20992
  v_mfma_f32_16x16x32_bf16 v[100:103], v[24:27], v[212:215], v[100:103]
  ds_read_b64_tr_b16 v[24:25], v21 offset:24576
  v_mfma_f32_16x16x32_bf16 v[100:103], v[28:31], v[220:223], v[100:103]
  ds_read_b64_tr_b16 v[26:27], v21 offset:25088
  v_mfma_f32_16x16x32_bf16 v[100:103], v[32:35], v[228:231], v[100:103]
  ds_read_b64_tr_b16 v[28:29], v21 offset:28672
  s_waitcnt lgkmcnt(7)
  v_mfma_f32_16x16x32_bf16 v[100:103], v[36:39], v[236:239], v[100:103]
  ds_read_b64_tr_b16 v[30:31], v21 offset:29184
  s_waitcnt lgkmcnt(6)
  v_mfma_f32_16x16x32_bf16 v[100:103], v[40:43], v[244:247], v[100:103]
  ds_read_b64_tr_b16 v[32:33], v21 offset:32768
  s_cmp_ge_u32 s56, 4
  s_cbranch_scc1 gated_mix__softmax_full_mha__geglu_ffn__prompt_kernel_l35
  s_cmp_lg_u32 s19, 0
  s_cbranch_scc1 gated_mix__softmax_full_mha__geglu_ffn__prompt_kernel_kt8
  s_waitcnt vmcnt(0)
  v_cmp_ne_u32 vcc, s0, v113
  s_and_b32 vcc_lo, vcc_lo, 33554176
  s_cbranch_scc1 gated_mix__softmax_full_mha__geglu_ffn__prompt_kernel_kt8
  s_mov_b32 s19, 1
  s_mov_b32 exec_hi, 0xffff
  s_add_u32 m0, s15, 0
  s_nop 0
  buffer_load_dwordx4 v128, s[44:47], s16 offen sc1 lds
  s_add_u32 m0, s15, 768
  s_nop 0
  buffer_load_dwordx4 v129, s[44:47], s16 offen sc1 lds
  s_add_u32 m0, s15, 1536
  s_nop 0
  buffer_load_dwordx4 v130, s[44:47], s16 offen sc1 lds
  s_lshl_b32 s63, s7, 12
  s_add_u32 s63, s63, s8
  s_add_u32 s64, s63, 0
  s_add_u32 m0, s12, 0
  s_nop 0
  buffer_load_dwordx4 v120, s[44:47], s64 offen sc1 lds
  s_add_u32 m0, s12, 768
  s_nop 0
  buffer_load_dwordx4 v121, s[44:47], s64 offen sc1 lds
  s_add_u32 m0, s12, 1536
  s_nop 0
  buffer_load_dwordx4 v122, s[44:47], s64 offen sc1 lds
  s_add_u32 s64, s63, 16384
  s_add_u32 m0, s12, 9344
  s_nop 0
  buffer_load_dwordx4 v120, s[44:47], s64 offen sc1 lds
  s_add_u32 m0, s12, 10112
  s_nop 0
  buffer_load_dwordx4 v121, s[44:47], s64 offen sc1 lds
  s_add_u32 m0, s12, 10880
  s_nop 0
  buffer_load_dwordx4 v122, s[44:47], s64 offen sc1 lds
  s_add_u32 s64, s63, 32768
  s_add_u32 m0, s12, 18688
  s_nop 0
  buffer_load_dwordx4 v120, s[44:47], s64 offen sc1 lds
  s_add_u32 m0, s12, 19456
  s_nop 0
  buffer_load_dwordx4 v121, s[44:47], s64 offen sc1 lds
  s_add_u32 m0, s12, 20224
  s_nop 0
  buffer_load_dwordx4 v122, s[44:47], s64 offen sc1 lds
  s_add_u32 s64, s63, 49152
  s_add_u32 m0, s12, 28032
  s_nop 0
  buffer_load_dwordx4 v120, s[44:47], s64 offen sc1 lds
  s_add_u32 m0, s12, 28800
  s_nop 0
  buffer_load_dwordx4 v121, s[44:47], s64 offen sc1 lds
  s_add_u32 m0, s12, 29568
  s_nop 0
  buffer_load_dwordx4 v122, s[44:47], s64 offen sc1 lds
  s_add_u32 s64, s63, 65536
  s_add_u32 m0, s12, 37376
  s_nop 0
  buffer_load_dwordx4 v120, s[44:47], s64 offen sc1 lds
  s_add_u32 m0, s12, 38144
  s_nop 0
  buffer_load_dwordx4 v121, s[44:47], s64 offen sc1 lds
  s_add_u32 m0, s12, 38912
  s_nop 0
  buffer_load_dwordx4 v122, s[44:47], s64 offen sc1 lds
  s_mov_b32 exec_hi, -1
gated_mix__softmax_full_mha__geglu_ffn__prompt_kernel_kt8:
gated_mix__softmax_full_mha__geglu_ffn__prompt_kernel_l35:
  s_waitcnt lgkmcnt(5)
  v_mfma_f32_16x16x32_bf16 v[100:103], v[44:47], v[252:255], v[100:103]
  ds_read_b64_tr_b16 v[34:35], v21 offset:33280
  v_mfma_f32_16x16x32_bf16 v[96:99], v[36:39], v[232:235], v[96:99]
  ds_read_b64_tr_b16 v[36:37], v21 offset:36864
  v_mfma_f32_16x16x32_bf16 v[96:99], v[40:43], v[240:243], v[96:99]
  ds_read_b64_tr_b16 v[38:39], v21 offset:37376
  v_mfma_f32_16x16x32_bf16 v[96:99], v[44:47], v[248:251], v[96:99]
  ds_read_b64_tr_b16 v[40:41], v21 offset:40960
  s_waitcnt lgkmcnt(7)
  v_mfma_f32_16x16x32_bf16 v[104:107], v[24:27], v[208:211], v[104:107]
  ds_read_b64_tr_b16 v[42:43], v21 offset:41472
  s_waitcnt lgkmcnt(6)
  v_mfma_f32_16x16x32_bf16 v[104:107], v[28:31], v[216:219], v[104:107]
  ds_read_b64_tr_b16 v[44:45], v21 offset:45056
  s_waitcnt lgkmcnt(5)
  v_mfma_f32_16x16x32_bf16 v[104:107], v[32:35], v[224:227], v[104:107]
  ds_read_b64_tr_b16 v[46:47], v21 offset:45568
  v_mfma_f32_16x16x32_bf16 v[108:111], v[24:27], v[212:215], v[108:111]
  v_xor_b32 v20, 64, v22
  ds_read_b64_tr_b16 v[24:25], v20 offset:0
  v_mfma_f32_16x16x32_bf16 v[108:111], v[28:31], v[220:223], v[108:111]
  ds_read_b64_tr_b16 v[26:27], v20 offset:512
  v_mfma_f32_16x16x32_bf16 v[108:111], v[32:35], v[228:231], v[108:111]
  ds_read_b64_tr_b16 v[28:29], v20 offset:4096
  s_waitcnt lgkmcnt(7)
  v_mfma_f32_16x16x32_bf16 v[108:111], v[36:39], v[236:239], v[108:111]
  ds_read_b64_tr_b16 v[30:31], v20 offset:4608
  s_waitcnt lgkmcnt(6)
  v_mfma_f32_16x16x32_bf16 v[108:111], v[40:43], v[244:247], v[108:111]
  ds_read_b64_tr_b16 v[32:33], v20 offset:8192
  s_waitcnt lgkmcnt(5)
  v_mfma_f32_16x16x32_bf16 v[108:111], v[44:47], v[252:255], v[108:111]
  ds_read_b64_tr_b16 v[34:35], v20 offset:8704
  v_mfma_f32_16x16x32_bf16 v[104:107], v[36:39], v[232:235], v[104:107]
  ds_read_b64_tr_b16 v[36:37], v20 offset:12288
  v_mfma_f32_16x16x32_bf16 v[104:107], v[40:43], v[240:243], v[104:107]
  ds_read_b64_tr_b16 v[38:39], v20 offset:12800
  v_mfma_f32_16x16x32_bf16 v[104:107], v[44:47], v[248:251], v[104:107]
  ds_read_b64_tr_b16 v[40:41], v20 offset:16384
  s_waitcnt lgkmcnt(7)
  v_mfma_f32_16x16x32_bf16 v[80:83], v[24:27], v[160:163], v[80:83]
  ds_read_b64_tr_b16 v[42:43], v20 offset:16896
  s_waitcnt lgkmcnt(6)
  v_mfma_f32_16x16x32_bf16 v[80:83], v[28:31], v[168:171], v[80:83]
  ds_read_b64_tr_b16 v[44:45], v20 offset:20480
  s_waitcnt lgkmcnt(5)
  v_mfma_f32_16x16x32_bf16 v[80:83], v[32:35], v[176:179], v[80:83]
  ds_read_b64_tr_b16 v[46:47], v20 offset:20992
  v_mul_f32 v104, v96, v104
  v_mfma_f32_16x16x32_bf16 v[84:87], v[24:27], v[164:167], v[84:87]
  v_xor_b32 v21, 64, v7
  ds_read_b64_tr_b16 v[24:25], v21 offset:0
  v_mul_f32 v105, v97, v105
  v_mfma_f32_16x16x32_bf16 v[84:87], v[28:31], v[172:175], v[84:87]
  ds_read_b64_tr_b16 v[26:27], v21 offset:512
  v_mul_f32 v106, v98, v106
  v_mul_f32 v107, v99, v107
  v_mfma_f32_16x16x32_bf16 v[84:87], v[32:35], v[180:183], v[84:87]
  ds_read_b64_tr_b16 v[28:29], v21 offset:4096
  v_fma_f32 v8, v96, v96, s76
  s_waitcnt lgkmcnt(7)
  v_mfma_f32_16x16x32_bf16 v[84:87], v[36:39], v[188:191], v[84:87]
  ds_read_b64_tr_b16 v[30:31], v21 offset:4608
  v_fma_f32 v9, v97, v97, s76
  v_fma_f32 v10, v98, v98, s76
  s_waitcnt lgkmcnt(6)
  v_mfma_f32_16x16x32_bf16 v[84:87], v[40:43], v[196:199], v[84:87]
  ds_read_b64_tr_b16 v[32:33], v21 offset:8192
  v_fma_f32 v11, v99, v99, s76
  s_waitcnt lgkmcnt(5)
  v_mfma_f32_16x16x32_bf16 v[84:87], v[44:47], v[204:207], v[84:87]
  ds_read_b64_tr_b16 v[34:35], v21 offset:8704
  v_mul_f32 v96, s77, v96
  v_mul_f32 v97, s77, v97
  v_mfma_f32_16x16x32_bf16 v[80:83], v[36:39], v[184:187], v[80:83]
  ds_read_b64_tr_b16 v[36:37], v21 offset:12288
  v_mul_f32 v98, s77, v98
  v_mfma_f32_16x16x32_bf16 v[80:83], v[40:43], v[192:195], v[80:83]
  ds_read_b64_tr_b16 v[38:39], v21 offset:12800
  v_mul_f32 v99, s77, v99
  v_mul_f32 v8, v8, v96
  v_mfma_f32_16x16x32_bf16 v[80:83], v[44:47], v[200:203], v[80:83]
  ds_read_b64_tr_b16 v[40:41], v21 offset:16384
  v_mul_f32 v9, v9, v97
  s_waitcnt lgkmcnt(7)
  v_mfma_f32_16x16x32_bf16 v[80:83], v[24:27], v[208:211], v[80:83]
  ds_read_b64_tr_b16 v[42:43], v21 offset:16896
  v_mul_f32 v10, v10, v98
  s_waitcnt lgkmcnt(6)
  v_mfma_f32_16x16x32_bf16 v[80:83], v[28:31], v[216:219], v[80:83]
  ds_read_b64_tr_b16 v[44:45], v21 offset:20480
  v_mul_f32 v11, v11, v99
  v_exp_f32 v8, v8
  s_waitcnt lgkmcnt(5)
  v_mfma_f32_16x16x32_bf16 v[80:83], v[32:35], v[224:227], v[80:83]
  ds_read_b64_tr_b16 v[46:47], v21 offset:20992
  v_exp_f32 v9, v9
  v_mfma_f32_16x16x32_bf16 v[84:87], v[24:27], v[212:215], v[84:87]
  v_xor_b32 v20, 64, v22
  ds_read_b64_tr_b16 v[24:25], v20 offset:24576
  v_exp_f32 v10, v10
  v_exp_f32 v11, v11
  v_mfma_f32_16x16x32_bf16 v[84:87], v[28:31], v[220:223], v[84:87]
  ds_read_b64_tr_b16 v[26:27], v20 offset:25088
  v_add_f32 v8, 1.0, v8
  v_mfma_f32_16x16x32_bf16 v[84:87], v[32:35], v[228:231], v[84:87]
  ds_read_b64_tr_b16 v[28:29], v20 offset:28672
  v_add_f32 v9, 1.0, v9
  v_add_f32 v10, 1.0, v10
  s_waitcnt lgkmcnt(7)
  v_mfma_f32_16x16x32_bf16 v[84:87], v[36:39], v[236:239], v[84:87]
  ds_read_b64_tr_b16 v[30:31], v20 offset:29184
  v_add_f32 v11, 1.0, v11
  s_waitcnt lgkmcnt(6)
  v_mfma_f32_16x16x32_bf16 v[84:87], v[40:43], v[244:247], v[84:87]
  ds_read_b64_tr_b16 v[32:33], v20 offset:32768
  v_rcp_f32 v8, v8
  v_rcp_f32 v9, v9
  s_waitcnt lgkmcnt(5)
  v_mfma_f32_16x16x32_bf16 v[84:87], v[44:47], v[252:255], v[84:87]
  ds_read_b64_tr_b16 v[34:35], v20 offset:33280
  v_rcp_f32 v10, v10
  v_mfma_f32_16x16x32_bf16 v[80:83], v[36:39], v[232:235], v[80:83]
  ds_read_b64_tr_b16 v[36:37], v20 offset:36864
  v_rcp_f32 v11, v11
  v_mfma_f32_16x16x32_bf16 v[80:83], v[40:43], v[240:243], v[80:83]
  ds_read_b64_tr_b16 v[38:39], v20 offset:37376
  v_mul_f32 v8, v8, v104
  v_mul_f32 v9, v9, v105
  v_mfma_f32_16x16x32_bf16 v[80:83], v[44:47], v[248:251], v[80:83]
  ds_read_b64_tr_b16 v[40:41], v20 offset:40960
  v_mul_f32 v10, v10, v106
  s_waitcnt lgkmcnt(7)
  v_mfma_f32_16x16x32_bf16 v[88:91], v[24:27], v[160:163], v[88:91]
  ds_read_b64_tr_b16 v[42:43], v20 offset:41472
  v_mul_f32 v11, v11, v107
  v_cvt_pk_bf16_f32 v14, v8, v9
  s_waitcnt lgkmcnt(6)
  v_mfma_f32_16x16x32_bf16 v[88:91], v[28:31], v[168:171], v[88:91]
  ds_read_b64_tr_b16 v[44:45], v20 offset:45056
  v_cvt_pk_bf16_f32 v15, v10, v11
  s_waitcnt lgkmcnt(5)
  v_mfma_f32_16x16x32_bf16 v[88:91], v[32:35], v[176:179], v[88:91]
  ds_read_b64_tr_b16 v[46:47], v20 offset:45568
  v_mul_f32 v108, v100, v108
  v_mul_f32 v109, v101, v109
  v_mfma_f32_16x16x32_bf16 v[92:95], v[24:27], v[164:167], v[92:95]
  v_xor_b32 v21, 64, v7
  ds_read_b64_tr_b16 v[24:25], v21 offset:24576
  v_mul_f32 v110, v102, v110
  v_mfma_f32_16x16x32_bf16 v[92:95], v[28:31], v[172:175], v[92:95]
  ds_read_b64_tr_b16 v[26:27], v21 offset:25088
  v_mul_f32 v111, v103, v111
  v_fma_f32 v8, v100, v100, s76
  v_mfma_f32_16x16x32_bf16 v[92:95], v[32:35], v[180:183], v[92:95]
  ds_read_b64_tr_b16 v[28:29], v21 offset:28672
  v_fma_f32 v9, v101, v101, s76
  s_waitcnt lgkmcnt(7)
  v_mfma_f32_16x16x32_bf16 v[92:95], v[36:39], v[188:191], v[92:95]
  ds_read_b64_tr_b16 v[30:31], v21 offset:29184
  v_fma_f32 v10, v102, v102, s76
  v_fma_f32 v11, v103, v103, s76
  s_waitcnt lgkmcnt(6)
  v_mfma_f32_16x16x32_bf16 v[92:95], v[40:43], v[196:199], v[92:95]
  ds_read_b64_tr_b16 v[32:33], v21 offset:32768
  v_mul_f32 v100, s77, v100
  s_waitcnt lgkmcnt(5)
  v_mfma_f32_16x16x32_bf16 v[92:95], v[44:47], v[204:207], v[92:95]
  ds_read_b64_tr_b16 v[34:35], v21 offset:33280
  v_mul_f32 v101, s77, v101
  v_mfma_f32_16x16x32_bf16 v[88:91], v[36:39], v[184:187], v[88:91]
  ds_read_b64_tr_b16 v[36:37], v21 offset:36864
  v_mul_f32 v102, s77, v102
  v_mul_f32 v103, s77, v103
  v_mfma_f32_16x16x32_bf16 v[88:91], v[40:43], v[192:195], v[88:91]
  ds_read_b64_tr_b16 v[38:39], v21 offset:37376
  v_mul_f32 v8, v8, v100
  v_mfma_f32_16x16x32_bf16 v[88:91], v[44:47], v[200:203], v[88:91]
  ds_read_b64_tr_b16 v[40:41], v21 offset:40960
  v_mul_f32 v9, v9, v101
  v_mul_f32 v10, v10, v102
  s_waitcnt lgkmcnt(7)
  v_mfma_f32_16x16x32_bf16 v[88:91], v[24:27], v[208:211], v[88:91]
  ds_read_b64_tr_b16 v[42:43], v21 offset:41472
  v_mul_f32 v11, v11, v103
  s_waitcnt lgkmcnt(6)
  v_mfma_f32_16x16x32_bf16 v[88:91], v[28:31], v[216:219], v[88:91]
  ds_read_b64_tr_b16 v[44:45], v21 offset:45056
  v_exp_f32 v8, v8
  v_exp_f32 v9, v9
  s_waitcnt lgkmcnt(5)
  v_mfma_f32_16x16x32_bf16 v[88:91], v[32:35], v[224:227], v[88:91]
  ds_read_b64_tr_b16 v[46:47], v21 offset:45568
  v_exp_f32 v10, v10
  v_mfma_f32_16x16x32_bf16 v[92:95], v[24:27], v[212:215], v[92:95]
  v_xor_b32 v20, 0, v22
  ds_read_b64_tr_b16 v[24:25], v20 offset:0
  v_exp_f32 v11, v11
  v_add_f32 v8, 1.0, v8
  v_mfma_f32_16x16x32_bf16 v[92:95], v[28:31], v[220:223], v[92:95]
  ds_read_b64_tr_b16 v[26:27], v20 offset:512
  v_add_f32 v9, 1.0, v9
  v_mfma_f32_16x16x32_bf16 v[92:95], v[32:35], v[228:231], v[92:95]
  ds_read_b64_tr_b16 v[28:29], v20 offset:4096
  v_add_f32 v10, 1.0, v10
  s_waitcnt lgkmcnt(7)
  v_mfma_f32_16x16x32_bf16 v[92:95], v[36:39], v[236:239], v[92:95]
  ds_read_b64_tr_b16 v[30:31], v20 offset:4608
  v_add_f32 v11, 1.0, v11
  v_rcp_f32 v8, v8
  s_waitcnt lgkmcnt(6)
  v_mfma_f32_16x16x32_bf16 v[92:95], v[40:43], v[244:247], v[92:95]
  ds_read_b64_tr_b16 v[32:33], v20 offset:8192
  v_rcp_f32 v9, v9
  s_waitcnt lgkmcnt(5)
  v_mfma_f32_16x16x32_bf16 v[92:95], v[44:47], v[252:255], v[92:95]
  ds_read_b64_tr_b16 v[34:35], v20 offset:8704
  v_rcp_f32 v10, v10
  v_rcp_f32 v11, v11
  v_mfma_f32_16x16x32_bf16 v[88:91], v[36:39], v[232:235], v[88:91]
  ds_read_b64_tr_b16 v[36:37], v20 offset:12288
  s_cmp_ge_u32 s56, 4
  s_cbranch_scc1 gated_mix__softmax_full_mha__geglu_ffn__prompt_kernel_l36
  v_and_b32 v112, 31, v0
  v_lshlrev_b32 v112, 2, v112
  buffer_load_dword v113, v112, s[44:47], s99 offen sc1
gated_mix__softmax_full_mha__geglu_ffn__prompt_kernel_l36:
  v_mul_f32 v8, v8, v108
  v_mfma_f32_16x16x32_bf16 v[88:91], v[40:43], v[240:243], v[88:91]
  ds_read_b64_tr_b16 v[38:39], v20 offset:12800
  v_mul_f32 v9, v9, v109
  v_mul_f32 v10, v10, v110
  v_mfma_f32_16x16x32_bf16 v[88:91], v[44:47], v[248:251], v[88:91]
  ds_read_b64_tr_b16 v[40:41], v20 offset:16384
  v_mul_f32 v11, v11, v111
  s_waitcnt lgkmcnt(7)
  v_mfma_f32_16x16x32_bf16 v[48:51], v[24:27], v[160:163], v[48:51]
  ds_read_b64_tr_b16 v[42:43], v20 offset:16896
  v_cvt_pk_bf16_f32 v18, v8, v9
  v_cvt_pk_bf16_f32 v19, v10, v11
  s_waitcnt lgkmcnt(6)
  v_mfma_f32_16x16x32_bf16 v[48:51], v[28:31], v[168:171], v[48:51]
  ds_read_b64_tr_b16 v[44:45], v20 offset:20480
  s_waitcnt lgkmcnt(5)
  v_mfma_f32_16x16x32_bf16 v[48:51], v[32:35], v[176:179], v[48:51]
  ds_read_b64_tr_b16 v[46:47], v20 offset:20992
  v_mul_f32 v88, v80, v88
  v_mfma_f32_16x16x32_bf16 v[52:55], v[24:27], v[164:167], v[52:55]
  v_xor_b32 v21, 0, v7
  ds_read_b64_tr_b16 v[24:25], v21 offset:0
  v_mul_f32 v89, v81, v89
  v_mul_f32 v90, v82, v90
  v_mfma_f32_16x16x32_bf16 v[52:55], v[28:31], v[172:175], v[52:55]
  ds_read_b64_tr_b16 v[26:27], v21 offset:512
  v_mul_f32 v91, v83, v91
  v_mfma_f32_16x16x32_bf16 v[52:55], v[32:35], v[180:183], v[52:55]
  ds_read_b64_tr_b16 v[28:29], v21 offset:4096
  v_fma_f32 v8, v80, v80, s76
  s_waitcnt lgkmcnt(7)
  v_mfma_f32_16x16x32_bf16 v[52:55], v[36:39], v[188:191], v[52:55]
  ds_read_b64_tr_b16 v[30:31], v21 offset:4608
  v_fma_f32 v9, v81, v81, s76
  v_fma_f32 v10, v82, v82, s76
  s_waitcnt lgkmcnt(6)
  v_mfma_f32_16x16x32_bf16 v[52:55], v[40:43], v[196:199], v[52:55]
  ds_read_b64_tr_b16 v[32:33], v21 offset:8192
  v_fma_f32 v11, v83, v83, s76
  s_waitcnt lgkmcnt(5)
  v_mfma_f32_16x16x32_bf16 v[52:55], v[44:47], v[204:207], v[52:55]
  ds_read_b64_tr_b16 v[34:35], v21 offset:8704
  v_mul_f32 v80, s77, v80
  v_mul_f32 v81, s77, v81
  v_mfma_f32_16x16x32_bf16 v[48:51], v[36:39], v[184:187], v[48:51]
  ds_read_b64_tr_b16 v[36:37], v21 offset:12288
  v_mul_f32 v82, s77, v82
  v_mfma_f32_16x16x32_bf16 v[48:51], v[40:43], v[192:195], v[48:51]
  ds_read_b64_tr_b16 v[38:39], v21 offset:12800
  v_mul_f32 v83, s77, v83
  v_mul_f32 v8, v8, v80
  v_mfma_f32_16x16x32_bf16 v[48:51], v[44:47], v[200:203], v[48:51]
  ds_read_b64_tr_b16 v[40:41], v21 offset:16384
  v_mul_f32 v9, v9, v81
  s_waitcnt lgkmcnt(7)
  v_mfma_f32_16x16x32_bf16 v[48:51], v[24:27], v[208:211], v[48:51]
  ds_read_b64_tr_b16 v[42:43], v21 offset:16896
  v_mul_f32 v10, v10, v82
  v_mul_f32 v11, v11, v83
  s_waitcnt lgkmcnt(6)
  v_mfma_f32_16x16x32_bf16 v[48:51], v[28:31], v[216:219], v[48:51]
  ds_read_b64_tr_b16 v[44:45], v21 offset:20480
  v_exp_f32 v8, v8
  s_waitcnt lgkmcnt(5)
  v_mfma_f32_16x16x32_bf16 v[48:51], v[32:35], v[224:227], v[48:51]
  ds_read_b64_tr_b16 v[46:47], v21 offset:20992
  v_exp_f32 v9, v9
  v_mfma_f32_16x16x32_bf16 v[52:55], v[24:27], v[212:215], v[52:55]
  v_xor_b32 v20, 0, v22
  ds_read_b64_tr_b16 v[24:25], v20 offset:24576
  v_exp_f32 v10, v10
  v_exp_f32 v11, v11
  v_mfma_f32_16x16x32_bf16 v[52:55], v[28:31], v[220:223], v[52:55]
  ds_read_b64_tr_b16 v[26:27], v20 offset:25088
  v_add_f32 v8, 1.0, v8
  v_mfma_f32_16x16x32_bf16 v[52:55], v[32:35], v[228:231], v[52:55]
  ds_read_b64_tr_b16 v[28:29], v20 offset:28672
  v_add_f32 v9, 1.0, v9
  v_add_f32 v10, 1.0, v10
  s_waitcnt lgkmcnt(7)
  v_mfma_f32_16x16x32_bf16 v[52:55], v[36:39], v[236:239], v[52:55]
  ds_read_b64_tr_b16 v[30:31], v20 offset:29184
  v_add_f32 v11, 1.0, v11
  s_waitcnt lgkmcnt(6)
  v_mfma_f32_16x16x32_bf16 v[52:55], v[40:43], v[244:247], v[52:55]
  ds_read_b64_tr_b16 v[32:33], v20 offset:32768
  v_rcp_f32 v8, v8
  v_rcp_f32 v9, v9
  s_waitcnt lgkmcnt(5)
  v_mfma_f32_16x16x32_bf16 v[52:55], v[44:47], v[252:255], v[52:55]
  ds_read_b64_tr_b16 v[34:35], v20 offset:33280
  v_rcp_f32 v10, v10
  v_mfma_f32_16x16x32_bf16 v[48:51], v[36:39], v[232:235], v[48:51]
  ds_read_b64_tr_b16 v[36:37], v20 offset:36864
  v_rcp_f32 v11, v11
  v_mul_f32 v8, v8, v88
  v_mfma_f32_16x16x32_bf16 v[48:51], v[40:43], v[240:243], v[48:51]
  ds_read_b64_tr_b16 v[38:39], v20 offset:37376
  v_mul_f32 v9, v9, v89
  v_mfma_f32_16x16x32_bf16 v[48:51], v[44:47], v[248:251], v[48:51]
  ds_read_b64_tr_b16 v[40:41], v20 offset:40960
  v_mul_f32 v10, v10, v90
  v_mul_f32 v11, v11, v91
  s_waitcnt lgkmcnt(7)
  v_mfma_f32_16x16x32_bf16 v[56:59], v[24:27], v[160:163], v[56:59]
  ds_read_b64_tr_b16 v[42:43], v20 offset:41472
  v_cvt_pk_bf16_f32 v12, v8, v9
  s_waitcnt lgkmcnt(6)
  v_mfma_f32_16x16x32_bf16 v[56:59], v[28:31], v[168:171], v[56:59]
  ds_read_b64_tr_b16 v[44:45], v20 offset:45056
  v_cvt_pk_bf16_f32 v13, v10, v11
  s_waitcnt lgkmcnt(5)
  v_mfma_f32_16x16x32_bf16 v[56:59], v[32:35], v[176:179], v[56:59]
  ds_read_b64_tr_b16 v[46:47], v20 offset:45568
  s_add_u32 s66, s68, 24576
  buffer_store_dwordx4 v[12:15], v4, s[44:47], s66 offen offset:0 sc1
  v_mfma_f32_16x16x32_bf16 v[60:63], v[24:27], v[164:167], v[60:63]
  v_xor_b32 v21, 0, v7
  ds_read_b64_tr_b16 v[24:25], v21 offset:24576
  s_cmp_ge_u32 s56, 4
  s_cbranch_scc1 gated_mix__softmax_full_mha__geglu_ffn__prompt_kernel_l37
  s_cmp_lg_u32 s19, 0
  s_cbranch_scc1 gated_mix__softmax_full_mha__geglu_ffn__prompt_kernel_kt100
  s_waitcnt vmcnt(1)
  v_cmp_ne_u32 vcc, s0, v113
  s_and_b32 vcc_lo, vcc_lo, 33554176
  s_cbranch_scc1 gated_mix__softmax_full_mha__geglu_ffn__prompt_kernel_kt100
  s_mov_b32 s19, 1
  s_mov_b32 exec_hi, 0xffff
  s_add_u32 m0, s15, 0
  s_nop 0
  buffer_load_dwordx4 v128, s[44:47], s16 offen sc1 lds
  s_add_u32 m0, s15, 768
  s_nop 0
  buffer_load_dwordx4 v129, s[44:47], s16 offen sc1 lds
  s_add_u32 m0, s15, 1536
  s_nop 0
  buffer_load_dwordx4 v130, s[44:47], s16 offen sc1 lds
  s_lshl_b32 s63, s7, 12
  s_add_u32 s63, s63, s8
  s_add_u32 s64, s63, 0
  s_add_u32 m0, s12, 0
  s_nop 0
  buffer_load_dwordx4 v120, s[44:47], s64 offen sc1 lds
  s_add_u32 m0, s12, 768
  s_nop 0
  buffer_load_dwordx4 v121, s[44:47], s64 offen sc1 lds
  s_add_u32 m0, s12, 1536
  s_nop 0
  buffer_load_dwordx4 v122, s[44:47], s64 offen sc1 lds
  s_add_u32 s64, s63, 16384
  s_add_u32 m0, s12, 9344
  s_nop 0
  buffer_load_dwordx4 v120, s[44:47], s64 offen sc1 lds
  s_add_u32 m0, s12, 10112
  s_nop 0
  buffer_load_dwordx4 v121, s[44:47], s64 offen sc1 lds
  s_add_u32 m0, s12, 10880
  s_nop 0
  buffer_load_dwordx4 v122, s[44:47], s64 offen sc1 lds
  s_add_u32 s64, s63, 32768
  s_add_u32 m0, s12, 18688
  s_nop 0
  buffer_load_dwordx4 v120, s[44:47], s64 offen sc1 lds
  s_add_u32 m0, s12, 19456
  s_nop 0
  buffer_load_dwordx4 v121, s[44:47], s64 offen sc1 lds
  s_add_u32 m0, s12, 20224
  s_nop 0
  buffer_load_dwordx4 v122, s[44:47], s64 offen sc1 lds
  s_add_u32 s64, s63, 49152
  s_add_u32 m0, s12, 28032
  s_nop 0
  buffer_load_dwordx4 v120, s[44:47], s64 offen sc1 lds
  s_add_u32 m0, s12, 28800
  s_nop 0
  buffer_load_dwordx4 v121, s[44:47], s64 offen sc1 lds
  s_add_u32 m0, s12, 29568
  s_nop 0
  buffer_load_dwordx4 v122, s[44:47], s64 offen sc1 lds
  s_add_u32 s64, s63, 65536
  s_add_u32 m0, s12, 37376
  s_nop 0
  buffer_load_dwordx4 v120, s[44:47], s64 offen sc1 lds
  s_add_u32 m0, s12, 38144
  s_nop 0
  buffer_load_dwordx4 v121, s[44:47], s64 offen sc1 lds
  s_add_u32 m0, s12, 38912
  s_nop 0
  buffer_load_dwordx4 v122, s[44:47], s64 offen sc1 lds
  s_mov_b32 exec_hi, -1
gated_mix__softmax_full_mha__geglu_ffn__prompt_kernel_kt100:
gated_mix__softmax_full_mha__geglu_ffn__prompt_kernel_l37:
  v_mul_f32 v92, v84, v92
  v_mfma_f32_16x16x32_bf16 v[60:63], v[28:31], v[172:175], v[60:63]
  ds_read_b64_tr_b16 v[26:27], v21 offset:25088
  v_mul_f32 v93, v85, v93
  v_mul_f32 v94, v86, v94
  v_mfma_f32_16x16x32_bf16 v[60:63], v[32:35], v[180:183], v[60:63]
  ds_read_b64_tr_b16 v[28:29], v21 offset:28672
  v_mul_f32 v95, v87, v95
  s_waitcnt lgkmcnt(7)
  v_mfma_f32_16x16x32_bf16 v[60:63], v[36:39], v[188:191], v[60:63]
  ds_read_b64_tr_b16 v[30:31], v21 offset:29184
  v_fma_f32 v8, v84, v84, s76
  v_fma_f32 v9, v85, v85, s76
  s_waitcnt lgkmcnt(6)
  v_mfma_f32_16x16x32_bf16 v[60:63], v[40:43], v[196:199], v[60:63]
  ds_read_b64_tr_b16 v[32:33], v21 offset:32768
  v_fma_f32 v10, v86, v86, s76
  s_waitcnt lgkmcnt(5)
  v_mfma_f32_16x16x32_bf16 v[60:63], v[44:47], v[204:207], v[60:63]
  ds_read_b64_tr_b16 v[34:35], v21 offset:33280
  v_fma_f32 v11, v87, v87, s76
  v_mul_f32 v84, s77, v84
  v_mfma_f32_16x16x32_bf16 v[56:59], v[36:39], v[184:187], v[56:59]
  ds_read_b64_tr_b16 v[36:37], v21 offset:36864
  v_mul_f32 v85, s77, v85
  v_mfma_f32_16x16x32_bf16 v[56:59], v[40:43], v[192:195], v[56:59]
  ds_read_b64_tr_b16 v[38:39], v21 offset:37376
  v_mul_f32 v86, s77, v86
  v_mfma_f32_16x16x32_bf16 v[56:59], v[44:47], v[200:203], v[56:59]
  ds_read_b64_tr_b16 v[40:41], v21 offset:40960
  v_mul_f32 v87, s77, v87
  v_mul_f32 v8, v8, v84
  s_waitcnt lgkmcnt(7)
  v_mfma_f32_16x16x32_bf16 v[56:59], v[24:27], v[208:211], v[56:59]
  ds_read_b64_tr_b16 v[42:43], v21 offset:41472
  v_mul_f32 v9, v9, v85
  s_waitcnt lgkmcnt(6)
  v_mfma_f32_16x16x32_bf16 v[56:59], v[28:31], v[216:219], v[56:59]
  ds_read_b64_tr_b16 v[44:45], v21 offset:45056
  v_mul_f32 v10, v10, v86
  v_mul_f32 v11, v11, v87
  s_waitcnt lgkmcnt(5)
  v_mfma_f32_16x16x32_bf16 v[56:59], v[32:35], v[224:227], v[56:59]
  ds_read_b64_tr_b16 v[46:47], v21 offset:45568
  v_exp_f32 v8, v8
  v_mfma_f32_16x16x32_bf16 v[60:63], v[24:27], v[212:215], v[60:63]
  v_xor_b32 v20, 32, v22
  ds_read_b64_tr_b16 v[24:25], v20 offset:0
  v_exp_f32 v9, v9
  v_exp_f32 v10, v10
  v_mfma_f32_16x16x32_bf16 v[60:63], v[28:31], v[220:223], v[60:63]
  ds_read_b64_tr_b16 v[26:27], v20 offset:512
  v_exp_f32 v11, v11
  v_mfma_f32_16x16x32_bf16 v[60:63], v[32:35], v[228:231], v[60:63]
  ds_read_b64_tr_b16 v[28:29], v20 offset:4096
  v_add_f32 v8, 1.0, v8
  v_add_f32 v9, 1.0, v9
  s_waitcnt lgkmcnt(7)
  v_mfma_f32_16x16x32_bf16 v[60:63], v[36:39], v[236:239], v[60:63]
  ds_read_b64_tr_b16 v[30:31], v20 offset:4608
  v_add_f32 v10, 1.0, v10
  s_waitcnt lgkmcnt(6)
  v_mfma_f32_16x16x32_bf16 v[60:63], v[40:43], v[244:247], v[60:63]
  ds_read_b64_tr_b16 v[32:33], v20 offset:8192
  v_add_f32 v11, 1.0, v11
  v_rcp_f32 v8, v8
  s_waitcnt lgkmcnt(5)
  v_mfma_f32_16x16x32_bf16 v[60:63], v[44:47], v[252:255], v[60:63]
  ds_read_b64_tr_b16 v[34:35], v20 offset:8704
  v_rcp_f32 v9, v9
  v_mfma_f32_16x16x32_bf16 v[56:59], v[36:39], v[232:235], v[56:59]
  ds_read_b64_tr_b16 v[36:37], v20 offset:12288
  v_rcp_f32 v10, v10
  v_mfma_f32_16x16x32_bf16 v[56:59], v[40:43], v[240:243], v[56:59]
  ds_read_b64_tr_b16 v[38:39], v20 offset:12800
  v_rcp_f32 v11, v11
  v_mul_f32 v8, v8, v92
  v_mfma_f32_16x16x32_bf16 v[56:59], v[44:47], v[248:251], v[56:59]
  ds_read_b64_tr_b16 v[40:41], v20 offset:16384
  v_mul_f32 v9, v9, v93
  s_waitcnt lgkmcnt(7)
  v_mfma_f32_16x16x32_bf16 v[64:67], v[24:27], v[160:163], v[64:67]
  ds_read_b64_tr_b16 v[42:43], v20 offset:16896
  v_mul_f32 v10, v10, v94
  v_mul_f32 v11, v11, v95
  s_waitcnt lgkmcnt(6)
  v_mfma_f32_16x16x32_bf16 v[64:67], v[28:31], v[168:171], v[64:67]
  ds_read_b64_tr_b16 v[44:45], v20 offset:20480
  v_cvt_pk_bf16_f32 v16, v8, v9
  s_waitcnt lgkmcnt(5)
  v_mfma_f32_16x16x32_bf16 v[64:67], v[32:35], v[176:179], v[64:67]
  ds_read_b64_tr_b16 v[46:47], v20 offset:20992
  v_cvt_pk_bf16_f32 v17, v10, v11
  buffer_store_dwordx4 v[16:19], v4, s[44:47], s66 offen offset:256 sc1
  v_mfma_f32_16x16x32_bf16 v[68:71], v[24:27], v[164:167], v[68:71]
  v_xor_b32 v21, 32, v7
  ds_read_b64_tr_b16 v[24:25], v21 offset:0
  v_mul_f32 v56, v48, v56
  v_mfma_f32_16x16x32_bf16 v[68:71], v[28:31], v[172:175], v[68:71]
  ds_read_b64_tr_b16 v[26:27], v21 offset:512
  v_mul_f32 v57, v49, v57
  v_mul_f32 v58, v50, v58
  v_mfma_f32_16x16x32_bf16 v[68:71], v[32:35], v[180:183], v[68:71]
  ds_read_b64_tr_b16 v[28:29], v21 offset:4096
  v_mul_f32 v59, v51, v59
  s_waitcnt lgkmcnt(7)
  v_mfma_f32_16x16x32_bf16 v[68:71], v[36:39], v[188:191], v[68:71]
  ds_read_b64_tr_b16 v[30:31], v21 offset:4608
  v_fma_f32 v8, v48, v48, s76
  s_waitcnt lgkmcnt(6)
  v_mfma_f32_16x16x32_bf16 v[68:71], v[40:43], v[196:199], v[68:71]
  ds_read_b64_tr_b16 v[32:33], v21 offset:8192
  v_fma_f32 v9, v49, v49, s76
  v_fma_f32 v10, v50, v50, s76
  s_waitcnt lgkmcnt(5)
  v_mfma_f32_16x16x32_bf16 v[68:71], v[44:47], v[204:207], v[68:71]
  ds_read_b64_tr_b16 v[34:35], v21 offset:8704
  v_fma_f32 v11, v51, v51, s76
  v_mfma_f32_16x16x32_bf16 v[64:67], v[36:39], v[184:187], v[64:67]
  ds_read_b64_tr_b16 v[36:37], v21 offset:12288
  v_mul_f32 v48, s77, v48
  v_mul_f32 v49, s77, v49
  v_mfma_f32_16x16x32_bf16 v[64:67], v[40:43], v[192:195], v[64:67]
  ds_read_b64_tr_b16 v[38:39], v21 offset:12800
  v_mul_f32 v50, s77, v50
  v_mfma_f32_16x16x32_bf16 v[64:67], v[44:47], v[200:203], v[64:67]
  ds_read_b64_tr_b16 v[40:41], v21 offset:16384
  v_mul_f32 v51, s77, v51
  v_mul_f32 v8, v8, v48
  s_waitcnt lgkmcnt(7)
  v_mfma_f32_16x16x32_bf16 v[64:67], v[24:27], v[208:211], v[64:67]
  ds_read_b64_tr_b16 v[42:43], v21 offset:16896
  v_mul_f32 v9, v9, v49
  s_waitcnt lgkmcnt(6)
  v_mfma_f32_16x16x32_bf16 v[64:67], v[28:31], v[216:219], v[64:67]
  ds_read_b64_tr_b16 v[44:45], v21 offset:20480
  v_mul_f32 v10, v10, v50
  v_mul_f32 v11, v11, v51
  s_waitcnt lgkmcnt(5)
  v_mfma_f32_16x16x32_bf16 v[64:67], v[32:35], v[224:227], v[64:67]
  ds_read_b64_tr_b16 v[46:47], v21 offset:20992
  v_exp_f32 v8, v8
  v_mfma_f32_16x16x32_bf16 v[68:71], v[24:27], v[212:215], v[68:71]
  v_xor_b32 v20, 32, v22
  ds_read_b64_tr_b16 v[24:25], v20 offset:24576
  v_exp_f32 v9, v9
  v_exp_f32 v10, v10
  v_mfma_f32_16x16x32_bf16 v[68:71], v[28:31], v[220:223], v[68:71]
  ds_read_b64_tr_b16 v[26:27], v20 offset:25088
  v_exp_f32 v11, v11
  v_mfma_f32_16x16x32_bf16 v[68:71], v[32:35], v[228:231], v[68:71]
  ds_read_b64_tr_b16 v[28:29], v20 offset:28672
  v_add_f32 v8, 1.0, v8
  s_waitcnt lgkmcnt(7)
  v_mfma_f32_16x16x32_bf16 v[68:71], v[36:39], v[236:239], v[68:71]
  ds_read_b64_tr_b16 v[30:31], v20 offset:29184
  v_add_f32 v9, 1.0, v9
  v_add_f32 v10, 1.0, v10
  s_waitcnt lgkmcnt(6)
  v_mfma_f32_16x16x32_bf16 v[68:71], v[40:43], v[244:247], v[68:71]
  ds_read_b64_tr_b16 v[32:33], v20 offset:32768
  v_add_f32 v11, 1.0, v11
  s_waitcnt lgkmcnt(5)
  v_mfma_f32_16x16x32_bf16 v[68:71], v[44:47], v[252:255], v[68:71]
  ds_read_b64_tr_b16 v[34:35], v20 offset:33280
  v_rcp_f32 v8, v8
  v_rcp_f32 v9, v9
  v_mfma_f32_16x16x32_bf16 v[64:67], v[36:39], v[232:235], v[64:67]
  ds_read_b64_tr_b16 v[36:37], v20 offset:36864
  v_rcp_f32 v10, v10
  v_mfma_f32_16x16x32_bf16 v[64:67], v[40:43], v[240:243], v[64:67]
  ds_read_b64_tr_b16 v[38:39], v20 offset:37376
  v_rcp_f32 v11, v11
  v_mul_f32 v8, v8, v56
  v_mfma_f32_16x16x32_bf16 v[64:67], v[44:47], v[248:251], v[64:67]
  ds_read_b64_tr_b16 v[40:41], v20 offset:40960
  v_mul_f32 v9, v9, v57
  s_waitcnt lgkmcnt(7)
  v_mfma_f32_16x16x32_bf16 v[72:75], v[24:27], v[160:163], v[72:75]
  ds_read_b64_tr_b16 v[42:43], v20 offset:41472
  v_mul_f32 v10, v10, v58
  v_mul_f32 v11, v11, v59
  s_waitcnt lgkmcnt(6)
  v_mfma_f32_16x16x32_bf16 v[72:75], v[28:31], v[168:171], v[72:75]
  ds_read_b64_tr_b16 v[44:45], v20 offset:45056
  v_cvt_pk_bf16_f32 v12, v8, v9
  s_waitcnt lgkmcnt(5)
  v_mfma_f32_16x16x32_bf16 v[72:75], v[32:35], v[176:179], v[72:75]
  ds_read_b64_tr_b16 v[46:47], v20 offset:45568
  v_cvt_pk_bf16_f32 v13, v10, v11
  v_mfma_f32_16x16x32_bf16 v[76:79], v[24:27], v[164:167], v[76:79]
  v_xor_b32 v21, 32, v7
  ds_read_b64_tr_b16 v[24:25], v21 offset:24576
  v_mul_f32 v60, v52, v60
  v_mul_f32 v61, v53, v61
  v_mfma_f32_16x16x32_bf16 v[76:79], v[28:31], v[172:175], v[76:79]
  ds_read_b64_tr_b16 v[26:27], v21 offset:25088
  v_mul_f32 v62, v54, v62
  v_mfma_f32_16x16x32_bf16 v[76:79], v[32:35], v[180:183], v[76:79]
  ds_read_b64_tr_b16 v[28:29], v21 offset:28672
  v_mul_f32 v63, v55, v63
  v_fma_f32 v8, v52, v52, s76
  s_waitcnt lgkmcnt(7)
  v_mfma_f32_16x16x32_bf16 v[76:79], v[36:39], v[188:191], v[76:79]
  ds_read_b64_tr_b16 v[30:31], v21 offset:29184
  v_fma_f32 v9, v53, v53, s76
  s_waitcnt lgkmcnt(6)
  v_mfma_f32_16x16x32_bf16 v[76:79], v[40:43], v[196:199], v[76:79]
  ds_read_b64_tr_b16 v[32:33], v21 offset:32768
  v_fma_f32 v10, v54, v54, s76
  v_fma_f32 v11, v55, v55, s76
  s_waitcnt lgkmcnt(5)
  v_mfma_f32_16x16x32_bf16 v[76:79], v[44:47], v[204:207], v[76:79]
  ds_read_b64_tr_b16 v[34:35], v21 offset:33280
  v_mul_f32 v52, s77, v52
  v_mfma_f32_16x16x32_bf16 v[72:75], v[36:39], v[184:187], v[72:75]
  ds_read_b64_tr_b16 v[36:37], v21 offset:36864
  v_mul_f32 v53, s77, v53
  v_mul_f32 v54, s77, v54
  v_mfma_f32_16x16x32_bf16 v[72:75], v[40:43], v[192:195], v[72:75]
  ds_read_b64_tr_b16 v[38:39], v21 offset:37376
  v_mul_f32 v55, s77, v55
  v_mfma_f32_16x16x32_bf16 v[72:75], v[44:47], v[200:203], v[72:75]
  ds_read_b64_tr_b16 v[40:41], v21 offset:40960
  s_cmp_ge_u32 s56, 4
  s_cbranch_scc0 gated_mix__softmax_full_mha__geglu_ffn__prompt_kernel_l38
  v_and_b32 v112, 15, v0
  s_lshl_b32 s63, s7, 6
  v_lshl_add_u32 v112, v112, 2, s63
  buffer_load_dword v113, v112, s[44:47], s99 offen offset:128 sc1
gated_mix__softmax_full_mha__geglu_ffn__prompt_kernel_l38:
  v_mul_f32 v8, v8, v52
  v_mul_f32 v9, v9, v53
  s_waitcnt lgkmcnt(7)
  v_mfma_f32_16x16x32_bf16 v[72:75], v[24:27], v[208:211], v[72:75]
  ds_read_b64_tr_b16 v[42:43], v21 offset:41472
  v_mul_f32 v10, v10, v54
  s_waitcnt lgkmcnt(6)
  v_mfma_f32_16x16x32_bf16 v[72:75], v[28:31], v[216:219], v[72:75]
  ds_read_b64_tr_b16 v[44:45], v21 offset:45056
  v_mul_f32 v11, v11, v55
  s_waitcnt lgkmcnt(5)
  v_mfma_f32_16x16x32_bf16 v[72:75], v[32:35], v[224:227], v[72:75]
  ds_read_b64_tr_b16 v[46:47], v21 offset:45568
  v_exp_f32 v8, v8
  v_exp_f32 v9, v9
  v_mfma_f32_16x16x32_bf16 v[76:79], v[24:27], v[212:215], v[76:79]
  v_exp_f32 v10, v10
  v_mfma_f32_16x16x32_bf16 v[76:79], v[28:31], v[220:223], v[76:79]
  v_exp_f32 v11, v11
  v_add_f32 v8, 1.0, v8
  v_mfma_f32_16x16x32_bf16 v[76:79], v[32:35], v[228:231], v[76:79]
  v_add_f32 v9, 1.0, v9
  s_waitcnt lgkmcnt(4)
  v_mfma_f32_16x16x32_bf16 v[76:79], v[36:39], v[236:239], v[76:79]
  v_add_f32 v10, 1.0, v10
  v_add_f32 v11, 1.0, v11
  s_waitcnt lgkmcnt(2)
  v_mfma_f32_16x16x32_bf16 v[76:79], v[40:43], v[244:247], v[76:79]
  v_rcp_f32 v8, v8
  s_waitcnt lgkmcnt(0)
  v_mfma_f32_16x16x32_bf16 v[76:79], v[44:47], v[252:255], v[76:79]
  v_rcp_f32 v9, v9
  v_rcp_f32 v10, v10
  v_mfma_f32_16x16x32_bf16 v[72:75], v[36:39], v[232:235], v[72:75]
  v_rcp_f32 v11, v11
  v_mfma_f32_16x16x32_bf16 v[72:75], v[40:43], v[240:243], v[72:75]
  v_mul_f32 v8, v8, v60
  v_mfma_f32_16x16x32_bf16 v[72:75], v[44:47], v[248:251], v[72:75]
  v_mul_f32 v9, v9, v61
  v_mul_f32 v10, v10, v62
  v_mul_f32 v11, v11, v63
  v_cvt_pk_bf16_f32 v16, v8, v9
  v_cvt_pk_bf16_f32 v17, v10, v11
  s_nop 2
  v_mul_f32 v72, v64, v72
  v_mul_f32 v73, v65, v73
  v_mul_f32 v74, v66, v74
  v_mul_f32 v75, v67, v75
  v_fma_f32 v8, v64, v64, s76
  v_fma_f32 v9, v65, v65, s76
  v_fma_f32 v10, v66, v66, s76
  v_fma_f32 v11, v67, v67, s76
  v_mul_f32 v64, s77, v64
  v_mul_f32 v65, s77, v65
  v_mul_f32 v66, s77, v66
  v_mul_f32 v67, s77, v67
  v_mul_f32 v8, v8, v64
  v_mul_f32 v9, v9, v65
  v_mul_f32 v10, v10, v66
  v_mul_f32 v11, v11, v67
  v_exp_f32 v8, v8
  v_exp_f32 v9, v9
  v_exp_f32 v10, v10
  v_exp_f32 v11, v11
  v_add_f32 v8, 1.0, v8
  v_add_f32 v9, 1.0, v9
  v_add_f32 v10, 1.0, v10
  v_add_f32 v11, 1.0, v11
  v_rcp_f32 v8, v8
  v_rcp_f32 v9, v9
  v_rcp_f32 v10, v10
  v_rcp_f32 v11, v11
  v_mul_f32 v8, v8, v72
  v_mul_f32 v9, v9, v73
  v_mul_f32 v10, v10, v74
  v_mul_f32 v11, v11, v75
  v_cvt_pk_bf16_f32 v14, v8, v9
  v_cvt_pk_bf16_f32 v15, v10, v11
  s_add_u32 s66, s68, 16384
  buffer_store_dwordx4 v[12:15], v4, s[44:47], s66 offen offset:0 sc1
  v_mul_f32 v76, v68, v76
  v_mul_f32 v77, v69, v77
  v_mul_f32 v78, v70, v78
  v_mul_f32 v79, v71, v79
  v_fma_f32 v8, v68, v68, s76
  v_fma_f32 v9, v69, v69, s76
  v_fma_f32 v10, v70, v70, s76
  v_fma_f32 v11, v71, v71, s76
  v_mul_f32 v68, s77, v68
  v_mul_f32 v69, s77, v69
  v_mul_f32 v70, s77, v70
  v_mul_f32 v71, s77, v71
  v_mul_f32 v8, v8, v68
  v_mul_f32 v9, v9, v69
  v_mul_f32 v10, v10, v70
  v_mul_f32 v11, v11, v71
  v_exp_f32 v8, v8
  v_exp_f32 v9, v9
  v_exp_f32 v10, v10
  v_exp_f32 v11, v11
  v_add_f32 v8, 1.0, v8
  v_add_f32 v9, 1.0, v9
  v_add_f32 v10, 1.0, v10
  v_add_f32 v11, 1.0, v11
  v_rcp_f32 v8, v8
  v_rcp_f32 v9, v9
  v_rcp_f32 v10, v10
  v_rcp_f32 v11, v11
  v_mul_f32 v8, v8, v76
  v_mul_f32 v9, v9, v77
  v_mul_f32 v10, v10, v78
  v_mul_f32 v11, v11, v79
  v_cvt_pk_bf16_f32 v18, v8, v9
  v_cvt_pk_bf16_f32 v19, v10, v11
  buffer_store_dwordx4 v[16:19], v4, s[44:47], s66 offen offset:256 sc1
  s_cmp_ge_u32 s56, 4
  s_cbranch_scc1 gated_mix__softmax_full_mha__geglu_ffn__prompt_kernel_gemm
  s_setprio 1
  v_mov_b32 v9, 161824
  v_mov_b32 v10, 1
  s_mov_b64 exec, 1
  ds_add_u32 v9, v10
  s_mov_b64 exec, -1
  v_mul_u32_u24 v17, 2336, v0
  v_add_u32 v17, 2304, v17
  v_mov_b32 v18, 0x3f803f80
  v_mov_b32 v19, 0x3f803f80
  v_mov_b32 v20, 0
  v_mov_b32 v21, 0
  s_mov_b64 exec, 1048575
  ds_write2_b64 v17, v[18:19], v[18:19] offset0:0 offset1:1
  ds_write2_b64 v17, v[20:21], v[20:21] offset0:2 offset1:3
  s_mov_b64 exec, -1
  v_lshlrev_b32 v1, 4, v0
  v_lshrrev_b32 v9, 5, v0
  v_bfe_u32 v10, v0, 4, 1
  v_and_b32 v11, 1, v0
  v_lshl_add_u32 v10, v10, 1, v11
  v_bfe_u32 v11, v0, 2, 2
  v_bfe_u32 v12, v0, 1, 1
  v_lshlrev_b32 v12, 3, v12
  v_lshl_add_u32 v13, v11, 4, v12
  v_lshl_add_u32 v15, v9, 7, v13
  v_mul_u32_u24 v16, 288, v10
  v_add_u32 v17, s15, v16
  v_add_u32 v21, v17, v15
  v_and_b32 v18, 0x1f, v13
  v_add_u32 v22, v17, v18
  v_mul_u32_u24 v18, 1152, v9
  v_add_u32 v22, v22, v18
  s_cmp_lg_u32 s19, 0
  s_cbranch_scc1 gated_mix__softmax_full_mha__geglu_ffn__prompt_kernel_kvgo
  s_mov_b32 s14, 0
gated_mix__softmax_full_mha__geglu_ffn__prompt_kernel_c1a:
  buffer_load_dword v20, v112, s[44:47], s99 offen offset:0 sc1
  s_add_u32 s14, s14, 1
  s_waitcnt vmcnt(0)
  v_cmp_ne_u32 vcc, s0, v20
  s_and_b32 vcc_lo, vcc_lo, 33554176
  s_cbranch_scc0 gated_mix__softmax_full_mha__geglu_ffn__prompt_kernel_c1ad
  s_cmp_ge_u32 s14, 0x8000
  s_cbranch_scc1 gated_mix__softmax_full_mha__geglu_ffn__prompt_kernel_c1ad
  s_sleep 4
  s_branch gated_mix__softmax_full_mha__geglu_ffn__prompt_kernel_c1a
gated_mix__softmax_full_mha__geglu_ffn__prompt_kernel_c1ad:
  s_mov_b32 s19, 1
  s_mov_b32 exec_hi, 0xffff
  s_add_u32 m0, s15, 0
  s_nop 0
  buffer_load_dwordx4 v128, s[44:47], s16 offen sc1 lds
  s_add_u32 m0, s15, 768
  s_nop 0
  buffer_load_dwordx4 v129, s[44:47], s16 offen sc1 lds
  s_add_u32 m0, s15, 1536
  s_nop 0
  buffer_load_dwordx4 v130, s[44:47], s16 offen sc1 lds
  s_lshl_b32 s63, s7, 12
  s_add_u32 s63, s63, s8
  s_add_u32 s64, s63, 0
  s_add_u32 m0, s12, 0
  s_nop 0
  buffer_load_dwordx4 v120, s[44:47], s64 offen sc1 lds
  s_add_u32 m0, s12, 768
  s_nop 0
  buffer_load_dwordx4 v121, s[44:47], s64 offen sc1 lds
  s_add_u32 m0, s12, 1536
  s_nop 0
  buffer_load_dwordx4 v122, s[44:47], s64 offen sc1 lds
  s_add_u32 s64, s63, 16384
  s_add_u32 m0, s12, 9344
  s_nop 0
  buffer_load_dwordx4 v120, s[44:47], s64 offen sc1 lds
  s_add_u32 m0, s12, 10112
  s_nop 0
  buffer_load_dwordx4 v121, s[44:47], s64 offen sc1 lds
  s_add_u32 m0, s12, 10880
  s_nop 0
  buffer_load_dwordx4 v122, s[44:47], s64 offen sc1 lds
  s_add_u32 s64, s63, 32768
  s_add_u32 m0, s12, 18688
  s_nop 0
  buffer_load_dwordx4 v120, s[44:47], s64 offen sc1 lds
  s_add_u32 m0, s12, 19456
  s_nop 0
  buffer_load_dwordx4 v121, s[44:47], s64 offen sc1 lds
  s_add_u32 m0, s12, 20224
  s_nop 0
  buffer_load_dwordx4 v122, s[44:47], s64 offen sc1 lds
  s_add_u32 s64, s63, 49152
  s_add_u32 m0, s12, 28032
  s_nop 0
  buffer_load_dwordx4 v120, s[44:47], s64 offen sc1 lds
  s_add_u32 m0, s12, 28800
  s_nop 0
  buffer_load_dwordx4 v121, s[44:47], s64 offen sc1 lds
  s_add_u32 m0, s12, 29568
  s_nop 0
  buffer_load_dwordx4 v122, s[44:47], s64 offen sc1 lds
  s_add_u32 s64, s63, 65536
  s_add_u32 m0, s12, 37376
  s_nop 0
  buffer_load_dwordx4 v120, s[44:47], s64 offen sc1 lds
  s_add_u32 m0, s12, 38144
  s_nop 0
  buffer_load_dwordx4 v121, s[44:47], s64 offen sc1 lds
  s_add_u32 m0, s12, 38912
  s_nop 0
  buffer_load_dwordx4 v122, s[44:47], s64 offen sc1 lds
  s_mov_b32 exec_hi, -1
  s_waitcnt vmcnt(0)
gated_mix__softmax_full_mha__geglu_ffn__prompt_kernel_kvgo:
  v_mov_b32 v196, v120
  v_mov_b32 v197, v121
  v_mov_b32 v198, v122
  s_waitcnt vmcnt(3)
  ds_read_b64_tr_b16 v[96:97], v21 offset:0
  ds_read_b64_tr_b16 v[98:99], v21 offset:64
  ds_read_b64_tr_b16 v[104:105], v21 offset:1152
  ds_read_b64_tr_b16 v[106:107], v21 offset:1216
  ds_read_b64_tr_b16 v[100:101], v22 offset:256
  v_mov_b32 v17, 161820
  v_mov_b32 v18, 1
  s_mov_b64 exec, 1
  ds_add_u32 v17, v18
  s_mov_b64 exec, -1
  v_lshlrev_b32 v16, 1, v16
  v_add_u32 v2, v16, v15
  v_add_u32 v17, v16, v13
  v_add_u32 v17, 256, v17
  v_lshl_add_u32 v18, v11, 4, v12
  v_add_u32 v18, 2272, v18
  v_cmp_gt_u32 vcc, 2, v11
  s_nop 1
  v_cndmask_b32 v3, v18, v17, vcc
  v_mov_b32 v17, 161820
gated_mix__softmax_full_mha__geglu_ffn__prompt_kernel_ac1:
  ds_read_b32 v18, v17
  s_waitcnt lgkmcnt(0)
  v_readfirstlane_b32 s63, v18
  s_nop 0
  s_cmp_ge_u32 s63, 4
  s_cbranch_scc1 gated_mix__softmax_full_mha__geglu_ffn__prompt_kernel_ac1d
  s_sleep 0
  s_branch gated_mix__softmax_full_mha__geglu_ffn__prompt_kernel_ac1
gated_mix__softmax_full_mha__geglu_ffn__prompt_kernel_ac1d:
  ds_read_b64_tr_b16 v[124:125], v3 offset:0
  ds_read_b64_tr_b16 v[112:113], v2 offset:0
  ds_read_b64_tr_b16 v[114:115], v2 offset:64
  v_and_b32 v11, 31, v0
  v_and_b32 v12, 0x13, v11
  v_bfe_u32 v13, v11, 2, 1
  v_lshl_or_b32 v12, v13, 3, v12
  v_bfe_u32 v13, v11, 3, 1
  v_lshl_or_b32 v12, v13, 2, v12
  v_mul_u32_u24 v13, 576, v9
  v_lshl_add_u32 v12, v12, 4, v13
  v_add_u32 v12, 288, v12
  v_add_u32 v13, 1152, v12
  v_mov_b32 v17, 2320
  v_mov_b32 v18, 2304
  v_and_b32 v19, 27, v11
  v_cmp_eq_u32 vcc, 18, v19
  s_nop 1
  v_cndmask_b32 v17, v17, v18, vcc
  v_cmp_gt_u32 vcc, 18, v11
  s_nop 1
  v_cndmask_b32 v4, v17, v12, vcc
  v_cndmask_b32 v14, v17, v13, vcc
  v_cmp_gt_u32 vcc, 32, v0
  v_mov_b32 v101, 0
  s_waitcnt lgkmcnt(0)
  s_nop 0
  v_mfma_f32_32x32x4_2b_bf16 v[208:239], v[124:125], v[100:101], 0
  v_mov_b32 v56, 0
  v_mov_b32 v57, 0
  v_mov_b32 v58, 0
  v_mov_b32 v59, 0
  v_mov_b32 v60, 0
  v_mov_b32 v61, 0
  v_mov_b32 v62, 0
  v_mov_b32 v63, 0
  v_mov_b32 v64, 0
  v_mov_b32 v65, 0
  v_mov_b32 v66, 0
  v_mov_b32 v67, 0
  v_mov_b32 v68, 0
  v_mov_b32 v69, 0
  v_mov_b32 v70, 0
  v_mov_b32 v71, 0
  v_mov_b32 v72, 0
  v_mov_b32 v73, 0
  v_mfma_f32_32x32x16_bf16 v[160:175], v[112:115], v[96:99], v[208:223]
  v_mfma_f32_32x32x16_bf16 v[32:47], v[112:115], v[104:107], v[224:239]
  v_mov_b32 v74, 0
  v_mov_b32 v75, 0
  v_mov_b32 v76, 0
  v_mov_b32 v77, 0
  v_mov_b32 v78, 0
  v_mov_b32 v79, 0
  v_mov_b32 v80, 0
  v_mov_b32 v81, 0
  v_mov_b32 v82, 0
  v_mov_b32 v83, 0
  s_nop 0
  v_max3_f32 v10, v160, v161, v162
  v_max3_f32 v10, v10, v163, v164
  v_max3_f32 v10, v10, v165, v166
  v_max3_f32 v10, v10, v167, v168
  v_max3_f32 v10, v10, v169, v170
  v_max3_f32 v10, v10, v171, v172
  v_max3_f32 v10, v10, v173, v174
  v_max_f32 v10, v10, v175
  v_max3_f32 v12, v32, v33, v34
  v_max3_f32 v12, v12, v35, v36
  v_max3_f32 v12, v12, v37, v38
  v_max3_f32 v12, v12, v39, v40
  v_max3_f32 v12, v12, v41, v42
  v_max3_f32 v12, v12, v43, v44
  v_max3_f32 v12, v12, v45, v46
  v_max_f32 v12, v12, v47
  v_mov_b32 v183, 0
  v_mov_b32 v182, 0
  v_permlane32_swap_b32 v10, v12
  v_max_f32 v10, v10, v12
  v_cvt_pk_bf16_f32 v101, -v10, 0
  s_nop 1
  v_mfma_f32_32x32x4_2b_bf16 v[208:239], v[124:125], v[100:101], 0
  ds_read_b64_tr_b16 v[124:125], v3 offset:2336
  v_mov_b32 v84, 0
  v_mov_b32 v85, 0
  v_mov_b32 v86, 0
  v_mov_b32 v87, 0
  v_mov_b32 v88, 0
  v_mov_b32 v89, 0
  v_mov_b32 v90, 0
  v_mov_b32 v91, 0
  v_mov_b32 v92, 0
  v_mov_b32 v93, 0
  v_mov_b32 v94, 0
  v_mov_b32 v95, 0
  v_mov_b32 v176, 0
  v_mov_b32 v177, 0
  v_mov_b32 v178, 0
  v_mov_b32 v179, 0
  v_mov_b32 v180, 0
  v_mov_b32 v181, 0
  v_mfma_f32_32x32x16_bf16 v[160:175], v[112:115], v[96:99], v[208:223]
  s_mov_b32 s9, 0
  s_waitcnt lgkmcnt(0)
  s_nop 9
.p2align 3
gated_mix__softmax_full_mha__geglu_ffn__prompt_kernel_aloop:
  s_bitcmp1_b32 214, s9
  s_cbranch_scc1 gated_mix__softmax_full_mha__geglu_ffn__prompt_kernel_astub
gated_mix__softmax_full_mha__geglu_ffn__prompt_kernel_acont:
  v_mfma_f32_32x32x16_bf16 v[32:47], v[112:115], v[104:107], v[224:239]
  v_exp_f32 v160, v160
  v_exp_f32 v161, v161
  v_exp_f32 v162, v162
  v_mfma_f32_32x32x16_bf16 v[80:95], v[176:179], v[56:59], v[80:95]
  v_exp_f32 v163, v163
  v_exp_f32 v164, v164
  v_exp_f32 v165, v165
  v_mfma_f32_32x32x16_bf16 v[80:95], v[180:183], v[60:63], v[80:95]
  v_exp_f32 v166, v166
  v_exp_f32 v167, v167
  v_exp_f32 v168, v168
  v_mfma_f32_32x32x4_2b_bf16 v[208:239], v[124:125], v[100:101], 0
  ds_read_b64_tr_b16 v[116:117], v2 offset:2336
  ds_read_b64_tr_b16 v[118:119], v2 offset:2400
  ds_read_b128 v[128:131], v4 offset:0
  ds_read_b128 v[132:135], v14 offset:0
  ds_read_b64_tr_b16 v[124:125], v3 offset:4672
  v_exp_f32 v169, v169
  v_exp_f32 v170, v170
  v_exp_f32 v171, v171
  v_exp_f32 v172, v172
  v_exp_f32 v173, v173
  v_exp_f32 v174, v174
  v_exp_f32 v175, v175
  v_cvt_pk_bf16_f32 v48, v160, v161
  v_cvt_pk_bf16_f32 v49, v162, v163
  v_cvt_pk_bf16_f32 v50, v164, v165
  v_cvt_pk_bf16_f32 v51, v166, v167
  v_cvt_pk_bf16_f32 v52, v168, v169
  v_cvt_pk_bf16_f32 v53, v170, v171
  v_cvt_pk_bf16_f32 v54, v172, v173
  v_cvt_pk_bf16_f32 v55, v174, v175
  s_waitcnt lgkmcnt(0)
  v_mfma_f32_32x32x16_bf16 v[64:79], v[128:131], v[48:51], v[64:79]
  v_exp_f32 v32, v32
  v_exp_f32 v33, v33
  v_exp_f32 v34, v34
  v_mfma_f32_32x32x16_bf16 v[160:175], v[116:119], v[96:99], v[208:223]
  v_exp_f32 v35, v35
  v_exp_f32 v36, v36
  v_exp_f32 v37, v37
  v_mfma_f32_32x32x16_bf16 v[64:79], v[132:135], v[52:55], v[64:79]
  v_exp_f32 v38, v38
  v_exp_f32 v39, v39
  v_exp_f32 v40, v40
  v_exp_f32 v41, v41
  v_exp_f32 v42, v42
  v_exp_f32 v43, v43
  v_exp_f32 v44, v44
  v_exp_f32 v45, v45
  v_exp_f32 v46, v46
  v_exp_f32 v47, v47
  v_cvt_pk_bf16_f32 v56, v32, v33
  v_cvt_pk_bf16_f32 v57, v34, v35
  v_cvt_pk_bf16_f32 v58, v36, v37
  v_cvt_pk_bf16_f32 v59, v38, v39
  v_cvt_pk_bf16_f32 v60, v40, v41
  v_cvt_pk_bf16_f32 v61, v42, v43
  v_cvt_pk_bf16_f32 v62, v44, v45
  v_cvt_pk_bf16_f32 v63, v46, v47
  v_mfma_f32_32x32x16_bf16 v[32:47], v[116:119], v[104:107], v[224:239]
  v_exp_f32 v160, v160
  v_exp_f32 v161, v161
  v_exp_f32 v162, v162
  v_mfma_f32_32x32x16_bf16 v[80:95], v[128:131], v[56:59], v[80:95]
  v_exp_f32 v163, v163
  v_exp_f32 v164, v164
  v_exp_f32 v165, v165
  v_mfma_f32_32x32x16_bf16 v[80:95], v[132:135], v[60:63], v[80:95]
  v_exp_f32 v166, v166
  v_exp_f32 v167, v167
  v_exp_f32 v168, v168
  v_mfma_f32_32x32x4_2b_bf16 v[208:239], v[124:125], v[100:101], 0
  ds_read_b64_tr_b16 v[112:113], v2 offset:4672
  ds_read_b64_tr_b16 v[114:115], v2 offset:4736
  ds_read_b128 v[176:179], v4 offset:2336
  ds_read_b128 v[180:183], v14 offset:2336
  ds_read_b64_tr_b16 v[124:125], v3 offset:7008
  v_exp_f32 v169, v169
  v_exp_f32 v170, v170
  v_exp_f32 v171, v171
  v_exp_f32 v172, v172
  v_exp_f32 v173, v173
  v_exp_f32 v174, v174
  v_exp_f32 v175, v175
  v_cvt_pk_bf16_f32 v48, v160, v161
  v_cvt_pk_bf16_f32 v49, v162, v163
  v_cvt_pk_bf16_f32 v50, v164, v165
  v_cvt_pk_bf16_f32 v51, v166, v167
  v_cvt_pk_bf16_f32 v52, v168, v169
  v_cvt_pk_bf16_f32 v53, v170, v171
  v_cvt_pk_bf16_f32 v54, v172, v173
  v_cvt_pk_bf16_f32 v55, v174, v175
  s_waitcnt lgkmcnt(0)
  v_mfma_f32_32x32x16_bf16 v[64:79], v[176:179], v[48:51], v[64:79]
  v_exp_f32 v32, v32
  v_exp_f32 v33, v33
  v_exp_f32 v34, v34
  v_mfma_f32_32x32x16_bf16 v[160:175], v[112:115], v[96:99], v[208:223]
  v_exp_f32 v35, v35
  v_exp_f32 v36, v36
  v_exp_f32 v37, v37
  v_mfma_f32_32x32x16_bf16 v[64:79], v[180:183], v[52:55], v[64:79]
  v_exp_f32 v38, v38
  v_exp_f32 v39, v39
  v_exp_f32 v40, v40
  v_exp_f32 v41, v41
  v_exp_f32 v42, v42
  v_exp_f32 v43, v43
  v_exp_f32 v44, v44
  v_exp_f32 v45, v45
  v_exp_f32 v46, v46
  v_exp_f32 v47, v47
  v_cvt_pk_bf16_f32 v56, v32, v33
  v_cvt_pk_bf16_f32 v57, v34, v35
  v_cvt_pk_bf16_f32 v58, v36, v37
  v_cvt_pk_bf16_f32 v59, v38, v39
  v_cvt_pk_bf16_f32 v60, v40, v41
  v_cvt_pk_bf16_f32 v61, v42, v43
  v_cvt_pk_bf16_f32 v62, v44, v45
  v_cvt_pk_bf16_f32 v63, v46, v47
  v_mfma_f32_32x32x16_bf16 v[32:47], v[112:115], v[104:107], v[224:239]
  v_exp_f32 v160, v160
  v_exp_f32 v161, v161
  v_exp_f32 v162, v162
  v_mfma_f32_32x32x16_bf16 v[80:95], v[176:179], v[56:59], v[80:95]
  v_exp_f32 v163, v163
  v_exp_f32 v164, v164
  v_exp_f32 v165, v165
  v_mfma_f32_32x32x16_bf16 v[80:95], v[180:183], v[60:63], v[80:95]
  v_exp_f32 v166, v166
  v_exp_f32 v167, v167
  v_exp_f32 v168, v168
  v_mfma_f32_32x32x4_2b_bf16 v[208:239], v[124:125], v[100:101], 0
  ds_read_b64_tr_b16 v[116:117], v2 offset:7008
  ds_read_b64_tr_b16 v[118:119], v2 offset:7072
  ds_read_b128 v[128:131], v4 offset:4672
  ds_read_b128 v[132:135], v14 offset:4672
  ds_read_b64_tr_b16 v[124:125], v3 offset:9344
  v_exp_f32 v169, v169
  v_exp_f32 v170, v170
  v_exp_f32 v171, v171
  v_exp_f32 v172, v172
  v_exp_f32 v173, v173
  v_exp_f32 v174, v174
  v_exp_f32 v175, v175
  v_cvt_pk_bf16_f32 v48, v160, v161
  v_cvt_pk_bf16_f32 v49, v162, v163
  v_cvt_pk_bf16_f32 v50, v164, v165
  v_cvt_pk_bf16_f32 v51, v166, v167
  v_cvt_pk_bf16_f32 v52, v168, v169
  v_cvt_pk_bf16_f32 v53, v170, v171
  v_cvt_pk_bf16_f32 v54, v172, v173
  v_cvt_pk_bf16_f32 v55, v174, v175
  s_waitcnt lgkmcnt(0)
  v_mfma_f32_32x32x16_bf16 v[64:79], v[128:131], v[48:51], v[64:79]
  v_exp_f32 v32, v32
  v_exp_f32 v33, v33
  v_exp_f32 v34, v34
  v_mfma_f32_32x32x16_bf16 v[160:175], v[116:119], v[96:99], v[208:223]
  v_exp_f32 v35, v35
  v_exp_f32 v36, v36
  v_exp_f32 v37, v37
  v_mfma_f32_32x32x16_bf16 v[64:79], v[132:135], v[52:55], v[64:79]
  v_exp_f32 v38, v38
  v_exp_f32 v39, v39
  v_exp_f32 v40, v40
  v_exp_f32 v41, v41
  v_exp_f32 v42, v42
  v_exp_f32 v43, v43
  v_exp_f32 v44, v44
  v_exp_f32 v45, v45
  v_exp_f32 v46, v46
  v_exp_f32 v47, v47
  v_cvt_pk_bf16_f32 v56, v32, v33
  v_cvt_pk_bf16_f32 v57, v34, v35
  v_cvt_pk_bf16_f32 v58, v36, v37
  v_cvt_pk_bf16_f32 v59, v38, v39
  v_cvt_pk_bf16_f32 v60, v40, v41
  v_cvt_pk_bf16_f32 v61, v42, v43
  v_cvt_pk_bf16_f32 v62, v44, v45
  v_cvt_pk_bf16_f32 v63, v46, v47
  v_mfma_f32_32x32x16_bf16 v[32:47], v[116:119], v[104:107], v[224:239]
  v_exp_f32 v160, v160
  v_exp_f32 v161, v161
  v_exp_f32 v162, v162
  v_mfma_f32_32x32x16_bf16 v[80:95], v[128:131], v[56:59], v[80:95]
  v_exp_f32 v163, v163
  v_exp_f32 v164, v164
  v_exp_f32 v165, v165
  v_mfma_f32_32x32x16_bf16 v[80:95], v[132:135], v[60:63], v[80:95]
  v_exp_f32 v166, v166
  v_exp_f32 v167, v167
  v_exp_f32 v168, v168
  v_mfma_f32_32x32x4_2b_bf16 v[208:239], v[124:125], v[100:101], 0
  ds_read_b64_tr_b16 v[112:113], v2 offset:9344
  ds_read_b64_tr_b16 v[114:115], v2 offset:9408
  ds_read_b128 v[176:179], v4 offset:7008
  ds_read_b128 v[180:183], v14 offset:7008
  ds_read_b64_tr_b16 v[124:125], v3 offset:11680
  v_exp_f32 v169, v169
  v_exp_f32 v170, v170
  v_exp_f32 v171, v171
  v_exp_f32 v172, v172
  v_exp_f32 v173, v173
  v_exp_f32 v174, v174
  v_exp_f32 v175, v175
  v_cvt_pk_bf16_f32 v48, v160, v161
  v_cvt_pk_bf16_f32 v49, v162, v163
  v_cvt_pk_bf16_f32 v50, v164, v165
  v_cvt_pk_bf16_f32 v51, v166, v167
  v_cvt_pk_bf16_f32 v52, v168, v169
  v_cvt_pk_bf16_f32 v53, v170, v171
  v_cvt_pk_bf16_f32 v54, v172, v173
  v_cvt_pk_bf16_f32 v55, v174, v175
  s_waitcnt lgkmcnt(0)
  v_mfma_f32_32x32x16_bf16 v[64:79], v[176:179], v[48:51], v[64:79]
  v_exp_f32 v32, v32
  v_exp_f32 v33, v33
  v_exp_f32 v34, v34
  v_mfma_f32_32x32x16_bf16 v[160:175], v[112:115], v[96:99], v[208:223]
  v_exp_f32 v35, v35
  v_exp_f32 v36, v36
  v_exp_f32 v37, v37
  v_mfma_f32_32x32x16_bf16 v[64:79], v[180:183], v[52:55], v[64:79]
  v_exp_f32 v38, v38
  v_exp_f32 v39, v39
  v_exp_f32 v40, v40
  v_exp_f32 v41, v41
  v_exp_f32 v42, v42
  v_exp_f32 v43, v43
  v_exp_f32 v44, v44
  v_exp_f32 v45, v45
  v_exp_f32 v46, v46
  v_exp_f32 v47, v47
  v_cvt_pk_bf16_f32 v56, v32, v33
  v_cvt_pk_bf16_f32 v57, v34, v35
  v_cvt_pk_bf16_f32 v58, v36, v37
  v_cvt_pk_bf16_f32 v59, v38, v39
  v_cvt_pk_bf16_f32 v60, v40, v41
  v_cvt_pk_bf16_f32 v61, v42, v43
  v_cvt_pk_bf16_f32 v62, v44, v45
  v_cvt_pk_bf16_f32 v63, v46, v47
  v_mfma_f32_32x32x16_bf16 v[32:47], v[112:115], v[104:107], v[224:239]
  v_exp_f32 v160, v160
  v_exp_f32 v161, v161
  v_exp_f32 v162, v162
  v_mfma_f32_32x32x16_bf16 v[80:95], v[176:179], v[56:59], v[80:95]
  v_exp_f32 v163, v163
  v_exp_f32 v164, v164
  v_exp_f32 v165, v165
  v_mfma_f32_32x32x16_bf16 v[80:95], v[180:183], v[60:63], v[80:95]
  v_exp_f32 v166, v166
  v_exp_f32 v167, v167
  v_exp_f32 v168, v168
  v_mfma_f32_32x32x4_2b_bf16 v[208:239], v[124:125], v[100:101], 0
  ds_read_b64_tr_b16 v[116:117], v2 offset:11680
  ds_read_b64_tr_b16 v[118:119], v2 offset:11744
  ds_read_b128 v[128:131], v4 offset:9344
  ds_read_b128 v[132:135], v14 offset:9344
  ds_read_b64_tr_b16 v[124:125], v3 offset:14016
  v_exp_f32 v169, v169
  v_exp_f32 v170, v170
  v_exp_f32 v171, v171
  v_exp_f32 v172, v172
  v_exp_f32 v173, v173
  v_exp_f32 v174, v174
  v_exp_f32 v175, v175
  v_cvt_pk_bf16_f32 v48, v160, v161
  v_cvt_pk_bf16_f32 v49, v162, v163
  v_cvt_pk_bf16_f32 v50, v164, v165
  v_cvt_pk_bf16_f32 v51, v166, v167
  v_cvt_pk_bf16_f32 v52, v168, v169
  v_cvt_pk_bf16_f32 v53, v170, v171
  v_cvt_pk_bf16_f32 v54, v172, v173
  v_cvt_pk_bf16_f32 v55, v174, v175
  s_waitcnt lgkmcnt(0)
  v_mfma_f32_32x32x16_bf16 v[64:79], v[128:131], v[48:51], v[64:79]
  v_exp_f32 v32, v32
  v_exp_f32 v33, v33
  v_exp_f32 v34, v34
  v_mfma_f32_32x32x16_bf16 v[160:175], v[116:119], v[96:99], v[208:223]
  v_exp_f32 v35, v35
  v_exp_f32 v36, v36
  v_exp_f32 v37, v37
  v_mfma_f32_32x32x16_bf16 v[64:79], v[132:135], v[52:55], v[64:79]
  v_exp_f32 v38, v38
  v_exp_f32 v39, v39
  v_exp_f32 v40, v40
  v_exp_f32 v41, v41
  v_exp_f32 v42, v42
  v_exp_f32 v43, v43
  v_exp_f32 v44, v44
  v_exp_f32 v45, v45
  v_exp_f32 v46, v46
  v_exp_f32 v47, v47
  v_cvt_pk_bf16_f32 v56, v32, v33
  v_cvt_pk_bf16_f32 v57, v34, v35
  v_cvt_pk_bf16_f32 v58, v36, v37
  v_cvt_pk_bf16_f32 v59, v38, v39
  v_cvt_pk_bf16_f32 v60, v40, v41
  v_cvt_pk_bf16_f32 v61, v42, v43
  v_cvt_pk_bf16_f32 v62, v44, v45
  v_cvt_pk_bf16_f32 v63, v46, v47
  v_mfma_f32_32x32x16_bf16 v[32:47], v[116:119], v[104:107], v[224:239]
  v_exp_f32 v160, v160
  v_exp_f32 v161, v161
  v_exp_f32 v162, v162
  v_mfma_f32_32x32x16_bf16 v[80:95], v[128:131], v[56:59], v[80:95]
  v_exp_f32 v163, v163
  v_exp_f32 v164, v164
  v_exp_f32 v165, v165
  v_mfma_f32_32x32x16_bf16 v[80:95], v[132:135], v[60:63], v[80:95]
  v_exp_f32 v166, v166
  v_exp_f32 v167, v167
  v_exp_f32 v168, v168
  v_mfma_f32_32x32x4_2b_bf16 v[208:239], v[124:125], v[100:101], 0
  ds_read_b64_tr_b16 v[112:113], v2 offset:14016
  ds_read_b64_tr_b16 v[114:115], v2 offset:14080
  ds_read_b128 v[176:179], v4 offset:11680
  ds_read_b128 v[180:183], v14 offset:11680
  ds_read_b64_tr_b16 v[124:125], v3 offset:16352
  v_exp_f32 v169, v169
  v_exp_f32 v170, v170
  v_exp_f32 v171, v171
  v_exp_f32 v172, v172
  v_exp_f32 v173, v173
  v_exp_f32 v174, v174
  v_exp_f32 v175, v175
  v_cvt_pk_bf16_f32 v48, v160, v161
  v_cvt_pk_bf16_f32 v49, v162, v163
  v_cvt_pk_bf16_f32 v50, v164, v165
  v_cvt_pk_bf16_f32 v51, v166, v167
  v_cvt_pk_bf16_f32 v52, v168, v169
  v_cvt_pk_bf16_f32 v53, v170, v171
  v_cvt_pk_bf16_f32 v54, v172, v173
  v_cvt_pk_bf16_f32 v55, v174, v175
  s_waitcnt lgkmcnt(0)
  v_mfma_f32_32x32x16_bf16 v[64:79], v[176:179], v[48:51], v[64:79]
  v_exp_f32 v32, v32
  v_exp_f32 v33, v33
  v_exp_f32 v34, v34
  v_mfma_f32_32x32x16_bf16 v[160:175], v[112:115], v[96:99], v[208:223]
  v_exp_f32 v35, v35
  v_exp_f32 v36, v36
  v_exp_f32 v37, v37
  v_mfma_f32_32x32x16_bf16 v[64:79], v[180:183], v[52:55], v[64:79]
  v_exp_f32 v38, v38
  v_exp_f32 v39, v39
  v_exp_f32 v40, v40
  v_exp_f32 v41, v41
  v_exp_f32 v42, v42
  v_exp_f32 v43, v43
  v_exp_f32 v44, v44
  v_exp_f32 v45, v45
  v_exp_f32 v46, v46
  v_exp_f32 v47, v47
  v_cvt_pk_bf16_f32 v56, v32, v33
  v_cvt_pk_bf16_f32 v57, v34, v35
  v_cvt_pk_bf16_f32 v58, v36, v37
  v_cvt_pk_bf16_f32 v59, v38, v39
  v_cvt_pk_bf16_f32 v60, v40, v41
  v_cvt_pk_bf16_f32 v61, v42, v43
  v_cvt_pk_bf16_f32 v62, v44, v45
  v_cvt_pk_bf16_f32 v63, v46, v47
  v_mfma_f32_32x32x16_bf16 v[32:47], v[112:115], v[104:107], v[224:239]
  v_exp_f32 v160, v160
  v_exp_f32 v161, v161
  v_exp_f32 v162, v162
  v_mfma_f32_32x32x16_bf16 v[80:95], v[176:179], v[56:59], v[80:95]
  v_exp_f32 v163, v163
  v_exp_f32 v164, v164
  v_exp_f32 v165, v165
  v_mfma_f32_32x32x16_bf16 v[80:95], v[180:183], v[60:63], v[80:95]
  v_exp_f32 v166, v166
  v_exp_f32 v167, v167
  v_exp_f32 v168, v168
  v_mfma_f32_32x32x4_2b_bf16 v[208:239], v[124:125], v[100:101], 0
  ds_read_b64_tr_b16 v[116:117], v2 offset:16352
  ds_read_b64_tr_b16 v[118:119], v2 offset:16416
  ds_read_b128 v[128:131], v4 offset:14016
  ds_read_b128 v[132:135], v14 offset:14016
  ds_read_b64_tr_b16 v[124:125], v3 offset:18688
  v_exp_f32 v169, v169
  v_exp_f32 v170, v170
  v_exp_f32 v171, v171
  v_exp_f32 v172, v172
  v_exp_f32 v173, v173
  v_exp_f32 v174, v174
  v_exp_f32 v175, v175
  v_cvt_pk_bf16_f32 v48, v160, v161
  v_cvt_pk_bf16_f32 v49, v162, v163
  v_cvt_pk_bf16_f32 v50, v164, v165
  v_cvt_pk_bf16_f32 v51, v166, v167
  v_cvt_pk_bf16_f32 v52, v168, v169
  v_cvt_pk_bf16_f32 v53, v170, v171
  v_cvt_pk_bf16_f32 v54, v172, v173
  v_cvt_pk_bf16_f32 v55, v174, v175
  s_waitcnt lgkmcnt(0)
  v_mfma_f32_32x32x16_bf16 v[64:79], v[128:131], v[48:51], v[64:79]
  v_exp_f32 v32, v32
  v_exp_f32 v33, v33
  v_exp_f32 v34, v34
  v_mfma_f32_32x32x16_bf16 v[160:175], v[116:119], v[96:99], v[208:223]
  v_exp_f32 v35, v35
  v_exp_f32 v36, v36
  v_exp_f32 v37, v37
  v_mfma_f32_32x32x16_bf16 v[64:79], v[132:135], v[52:55], v[64:79]
  v_exp_f32 v38, v38
  v_exp_f32 v39, v39
  v_exp_f32 v40, v40
  v_exp_f32 v41, v41
  v_exp_f32 v42, v42
  v_exp_f32 v43, v43
  v_exp_f32 v44, v44
  v_exp_f32 v45, v45
  v_exp_f32 v46, v46
  v_exp_f32 v47, v47
  v_cvt_pk_bf16_f32 v56, v32, v33
  v_cvt_pk_bf16_f32 v57, v34, v35
  v_cvt_pk_bf16_f32 v58, v36, v37
  v_cvt_pk_bf16_f32 v59, v38, v39
  v_cvt_pk_bf16_f32 v60, v40, v41
  v_cvt_pk_bf16_f32 v61, v42, v43
  v_cvt_pk_bf16_f32 v62, v44, v45
  v_cvt_pk_bf16_f32 v63, v46, v47
  v_mfma_f32_32x32x16_bf16 v[32:47], v[116:119], v[104:107], v[224:239]
  v_exp_f32 v160, v160
  v_exp_f32 v161, v161
  v_exp_f32 v162, v162
  v_mfma_f32_32x32x16_bf16 v[80:95], v[128:131], v[56:59], v[80:95]
  v_exp_f32 v163, v163
  v_exp_f32 v164, v164
  v_exp_f32 v165, v165
  v_mfma_f32_32x32x16_bf16 v[80:95], v[132:135], v[60:63], v[80:95]
  v_exp_f32 v166, v166
  v_exp_f32 v167, v167
  v_exp_f32 v168, v168
  v_mfma_f32_32x32x4_2b_bf16 v[208:239], v[124:125], v[100:101], 0
  ds_read_b64_tr_b16 v[112:113], v2 offset:18688
  ds_read_b64_tr_b16 v[114:115], v2 offset:18752
  ds_read_b128 v[176:179], v4 offset:16352
  ds_read_b128 v[180:183], v14 offset:16352
  ds_read_b64_tr_b16 v[124:125], v3 offset:21024
  v_exp_f32 v169, v169
  v_exp_f32 v170, v170
  v_exp_f32 v171, v171
  v_exp_f32 v172, v172
  v_exp_f32 v173, v173
  v_exp_f32 v174, v174
  v_exp_f32 v175, v175
  v_cvt_pk_bf16_f32 v48, v160, v161
  v_cvt_pk_bf16_f32 v49, v162, v163
  v_cvt_pk_bf16_f32 v50, v164, v165
  v_cvt_pk_bf16_f32 v51, v166, v167
  v_cvt_pk_bf16_f32 v52, v168, v169
  v_cvt_pk_bf16_f32 v53, v170, v171
  v_cvt_pk_bf16_f32 v54, v172, v173
  v_cvt_pk_bf16_f32 v55, v174, v175
  s_waitcnt lgkmcnt(0)
  v_mfma_f32_32x32x16_bf16 v[64:79], v[176:179], v[48:51], v[64:79]
  v_exp_f32 v32, v32
  v_exp_f32 v33, v33
  v_exp_f32 v34, v34
  v_mfma_f32_32x32x16_bf16 v[160:175], v[112:115], v[96:99], v[208:223]
  v_exp_f32 v35, v35
  v_exp_f32 v36, v36
  v_exp_f32 v37, v37
  v_mfma_f32_32x32x16_bf16 v[64:79], v[180:183], v[52:55], v[64:79]
  s_add_u32 s9, s9, 1
  s_cmp_lt_u32 s9, 8
  v_add_u32 v2, 18688, v2
  v_add_u32 v3, 18688, v3
  v_add_u32 v4, 18688, v4
  v_add_u32 v14, 18688, v14
  v_exp_f32 v38, v38
  v_exp_f32 v39, v39
  v_exp_f32 v40, v40
  v_exp_f32 v41, v41
  v_exp_f32 v42, v42
  v_exp_f32 v43, v43
  v_exp_f32 v44, v44
  v_exp_f32 v45, v45
  v_exp_f32 v46, v46
  v_exp_f32 v47, v47
  v_cvt_pk_bf16_f32 v56, v32, v33
  v_cvt_pk_bf16_f32 v57, v34, v35
  v_cvt_pk_bf16_f32 v58, v36, v37
  v_cvt_pk_bf16_f32 v59, v38, v39
  v_cvt_pk_bf16_f32 v60, v40, v41
  v_cvt_pk_bf16_f32 v61, v42, v43
  v_cvt_pk_bf16_f32 v62, v44, v45
  v_cvt_pk_bf16_f32 v63, v46, v47
  s_cbranch_scc1 gated_mix__softmax_full_mha__geglu_ffn__prompt_kernel_aloop
  v_mfma_f32_32x32x16_bf16 v[80:95], v[176:179], v[56:59], v[80:95]
  v_mfma_f32_32x32x16_bf16 v[80:95], v[180:183], v[60:63], v[80:95]
  s_mov_b32 s9, 0
gated_mix__softmax_full_mha__geglu_ffn__prompt_kernel_aepi:
  s_mov_b32 s65, 1568669696
  s_mov_b32 s64, 897581056
  v_mov_b32 v13, 0x7f000000
  s_waitcnt vmcnt(0)
  v_rcp_f32 v152, v74
  v_maximum3_f32 v10, |v64|, |v65|, |v66|
  v_mul_f32 v152, v152, v5
  v_maximum3_f32 v10, v10, |v67|, |v68|
  v_maximum3_f32 v10, v10, |v69|, |v70|
  v_maximum3_f32 v10, v10, |v71|, |v72|
  v_maximum3_f32 v10, v10, v10, |v73|
  v_mul_f32 v64, v64, v152
  v_mul_f32 v65, v65, v152
  v_mul_f32 v66, v66, v152
  v_mul_f32 v67, v67, v152
  v_mul_f32 v68, v68, v152
  v_mul_f32 v69, v69, v152
  v_mul_f32 v70, v70, v152
  v_mul_f32 v71, v71, v152
  v_mul_f32 v72, v72, v152
  v_mul_f32 v73, v73, v152
  v_cvt_pk_bf16_f32 v144, v64, v65
  v_cvt_pk_bf16_f32 v145, v66, v67
  v_cvt_pk_bf16_f32 v146, v68, v69
  v_cvt_pk_bf16_f32 v147, v70, v71
  v_cvt_pk_bf16_f32 v148, v72, v73
  v_rcp_f32 v192, v90
  v_maximum3_f32 v11, |v80|, |v81|, |v82|
  v_mul_f32 v192, v192, v6
  v_maximum3_f32 v11, v11, |v83|, |v84|
  v_maximum3_f32 v11, v11, |v85|, |v86|
  v_maximum3_f32 v11, v11, |v87|, |v88|
  v_maximum3_f32 v10, v10, v11, |v89|
  v_maximum3_f32 v11, v74, v90, v90
  v_minimum3_f32 v12, v74, v90, v90
  v_cmp_gt_f32 s[86:87], v13, v10
  v_cmp_ge_f32 vcc, s65, v11
  s_nop 0
  s_and_b64 s[86:87], vcc, s[86:87]
  v_cmp_le_f32 vcc, s64, v12
  s_nop 0
  s_and_b64 vcc, vcc, s[86:87]
  s_cmp_eq_u64 vcc, -1
  s_cbranch_scc0 gated_mix__softmax_full_mha__geglu_ffn__prompt_kernel_slow
gated_mix__softmax_full_mha__geglu_ffn__prompt_kernel_aepi2:
  buffer_store_dwordx4 v[144:147], v7, s[44:47], s17 offen sc1
  buffer_store_dword v148, v8, s[44:47], s17 offen offset:1024 sc1
  v_mul_f32 v80, v80, v192
  v_mul_f32 v81, v81, v192
  v_mul_f32 v82, v82, v192
  v_mul_f32 v83, v83, v192
  v_mul_f32 v84, v84, v192
  v_mul_f32 v85, v85, v192
  v_mul_f32 v86, v86, v192
  v_mul_f32 v87, v87, v192
  v_mul_f32 v88, v88, v192
  v_mul_f32 v89, v89, v192
  v_cvt_pk_bf16_f32 v184, v80, v81
  v_cvt_pk_bf16_f32 v185, v82, v83
  v_cvt_pk_bf16_f32 v186, v84, v85
  v_cvt_pk_bf16_f32 v187, v86, v87
  v_cvt_pk_bf16_f32 v188, v88, v89
  buffer_store_dwordx4 v[184:187], v7, s[44:47], s17 offen offset:1152 sc1
  buffer_store_dword v188, v8, s[44:47], s17 offen offset:2176 sc1
  v_mov_b32 v12, 161816
  v_mov_b32 v13, 1
  s_mov_b64 exec, 1
  ds_add_u32 v12, v13
  s_mov_b64 exec, -1
  s_lshr_b32 s64, s7, 1
  s_mul_i32 s63, s64, 9216
  v_add_u32 v10, s63, v1
  s_and_b32 s65, s7, 1
  s_lshl_b32 s63, s65, 12
  v_add_u32 v11, s63, v10
  s_lshl_b32 s9, s2, 2
  s_add_u32 s9, s9, s7
  s_mul_i32 s65, s9, 5120
  s_add_u32 s65, s65, 35602432
  s_add_u32 s64, s65, 4096
  s_lshl_b32 s9, s9, 5
  s_add_u32 s9, s9, 45056000
  v_mov_b32 v16, 0
  v_mov_b32 v17, s0
  v_mov_b32 v12, 161796
gated_mix__softmax_full_mha__geglu_ffn__prompt_kernel_ar:
  ds_read_b32 v13, v12
  s_waitcnt lgkmcnt(0)
  v_readfirstlane_b32 s63, v13
  s_nop 0
  s_cmp_ge_u32 s63, 4
  s_cbranch_scc1 gated_mix__softmax_full_mha__geglu_ffn__prompt_kernel_ard
  s_sleep 1
  s_branch gated_mix__softmax_full_mha__geglu_ffn__prompt_kernel_ar
gated_mix__softmax_full_mha__geglu_ffn__prompt_kernel_ard:
  ds_read_b128 v[32:35], v11 offset:0
  ds_read_b128 v[36:39], v11 offset:1024
  ds_read_b128 v[40:43], v11 offset:2048
  ds_read_b128 v[44:47], v11 offset:3072
  ds_read_b128 v[48:51], v10 offset:8192
  ds_read_b128 v[52:55], v11 offset:18432
  ds_read_b128 v[56:59], v11 offset:19456
  ds_read_b128 v[60:63], v11 offset:20480
  ds_read_b128 v[64:67], v11 offset:21504
  ds_read_b128 v[68:71], v10 offset:26624
  ds_read_b128 v[72:75], v11 offset:36864
  ds_read_b128 v[76:79], v11 offset:37888
  ds_read_b128 v[80:83], v11 offset:38912
  ds_read_b128 v[84:87], v11 offset:39936
  ds_read_b128 v[88:91], v10 offset:45056
  s_waitcnt lgkmcnt(5)
  v_add_f32 v32, v32, v52
  v_add_f32 v33, v33, v53
  v_add_f32 v34, v34, v54
  v_add_f32 v35, v35, v55
  v_add_f32 v36, v36, v56
  v_add_f32 v37, v37, v57
  v_add_f32 v38, v38, v58
  v_add_f32 v39, v39, v59
  v_add_f32 v40, v40, v60
  v_add_f32 v41, v41, v61
  v_add_f32 v42, v42, v62
  v_add_f32 v43, v43, v63
  v_add_f32 v44, v44, v64
  v_add_f32 v45, v45, v65
  v_add_f32 v46, v46, v66
  v_add_f32 v47, v47, v67
  v_add_f32 v48, v48, v68
  v_add_f32 v49, v49, v69
  v_add_f32 v50, v50, v70
  v_add_f32 v51, v51, v71
  ds_read_b128 v[52:55], v11 offset:55296
  ds_read_b128 v[56:59], v11 offset:56320
  ds_read_b128 v[60:63], v11 offset:57344
  ds_read_b128 v[64:67], v11 offset:58368
  ds_read_b128 v[68:71], v10 offset:63488
  s_waitcnt lgkmcnt(5)
  v_add_f32 v32, v32, v72
  v_add_f32 v33, v33, v73
  v_add_f32 v34, v34, v74
  v_add_f32 v35, v35, v75
  v_add_f32 v36, v36, v76
  v_add_f32 v37, v37, v77
  v_add_f32 v38, v38, v78
  v_add_f32 v39, v39, v79
  v_add_f32 v40, v40, v80
  v_add_f32 v41, v41, v81
  v_add_f32 v42, v42, v82
  v_add_f32 v43, v43, v83
  v_add_f32 v44, v44, v84
  v_add_f32 v45, v45, v85
  v_add_f32 v46, v46, v86
  v_add_f32 v47, v47, v87
  v_add_f32 v48, v48, v88
  v_add_f32 v49, v49, v89
  v_add_f32 v50, v50, v90
  v_add_f32 v51, v51, v91
  s_waitcnt lgkmcnt(0)
  v_add_f32 v32, v32, v52
  v_add_f32 v33, v33, v53
  v_add_f32 v34, v34, v54
  v_add_f32 v35, v35, v55
  v_add_f32 v36, v36, v56
  v_add_f32 v37, v37, v57
  v_add_f32 v38, v38, v58
  v_add_f32 v39, v39, v59
  v_add_f32 v40, v40, v60
  v_add_f32 v41, v41, v61
  v_add_f32 v42, v42, v62
  v_add_f32 v43, v43, v63
  v_add_f32 v44, v44, v64
  v_add_f32 v45, v45, v65
  v_add_f32 v46, v46, v66
  v_add_f32 v47, v47, v67
  v_add_f32 v48, v48, v68
  v_add_f32 v49, v49, v69
  v_add_f32 v50, v50, v70
  v_add_f32 v51, v51, v71
  buffer_store_dwordx4 v[32:35], v1, s[44:47], s65 offen offset:0 sc1
  buffer_store_dwordx4 v[36:39], v1, s[44:47], s65 offen offset:1024 sc1
  buffer_store_dwordx4 v[40:43], v1, s[44:47], s65 offen offset:2048 sc1
  buffer_store_dwordx4 v[44:47], v1, s[44:47], s65 offen offset:3072 sc1
  buffer_store_dwordx4 v[48:51], v1, s[44:47], s64 offen sc1
  s_waitcnt vmcnt(0)
  s_mov_b64 exec, 1
  buffer_store_dword v17, v16, s[44:47], s9 offen sc1
  s_mov_b64 exec, -1
  s_endpgm
gated_mix__softmax_full_mha__geglu_ffn__prompt_kernel_slow:
  s_cmp_lg_u32 s9, 0
  s_cbranch_scc1 gated_mix__softmax_full_mha__geglu_ffn__prompt_kernel_aepi2
  s_nop 7
  s_sub_u32 s65, s15, 149504
  v_add_u32 v2, s65, v2
  v_add_u32 v3, s65, v3
  v_add_u32 v4, s65, v4
  v_add_u32 v14, s65, v14
  v_mov_b32 v101, 0
  v_mov_b32 v144, 0xff000000
  v_mov_b32 v145, 0xff000000
  s_mov_b32 s9, 0
  s_mov_b32 s65, s8
  v_mov_b32 v64, 0
  v_mov_b32 v65, 0
  v_mov_b32 v66, 0
  v_mov_b32 v67, 0
  v_mov_b32 v68, 0
  v_mov_b32 v69, 0
  v_mov_b32 v70, 0
  v_mov_b32 v71, 0
  v_mov_b32 v72, 0
  v_mov_b32 v73, 0
  v_mov_b32 v74, 0
  v_mov_b32 v75, 0
  v_mov_b32 v76, 0
  v_mov_b32 v77, 0
  v_mov_b32 v78, 0
  v_mov_b32 v79, 0
  v_mov_b32 v80, 0
  v_mov_b32 v81, 0
  v_mov_b32 v82, 0
  v_mov_b32 v83, 0
  v_mov_b32 v84, 0
  v_mov_b32 v85, 0
  v_mov_b32 v86, 0
  v_mov_b32 v87, 0
  v_mov_b32 v88, 0
  v_mov_b32 v89, 0
  v_mov_b32 v90, 0
  v_mov_b32 v91, 0
  v_mov_b32 v92, 0
  v_mov_b32 v93, 0
  v_mov_b32 v94, 0
  v_mov_b32 v95, 0
  v_mov_b32 v17, s15
  v_add_u32 v17, 2304, v17
  v_mov_b32 v18, 0x3f803f80
  v_mov_b32 v19, 0x3f803f80
  ds_write2_b64 v17, v[18:19], v[18:19] offset0:0 offset1:1
  ds_write2_b64 v17, v[64:65], v[64:65] offset0:2 offset1:3
gated_mix__softmax_full_mha__geglu_ffn__prompt_kernel_sloop:
  s_mov_b32 exec_hi, 0xffff
  s_add_u32 s64, s65, 0
  s_add_u32 m0, s15, 0
  s_nop 0
  buffer_load_dwordx4 v196, s[44:47], s64 offen sc1 lds
  s_add_u32 m0, s15, 768
  s_nop 0
  buffer_load_dwordx4 v197, s[44:47], s64 offen sc1 lds
  s_add_u32 m0, s15, 1536
  s_nop 0
  buffer_load_dwordx4 v198, s[44:47], s64 offen sc1 lds
  s_mov_b32 exec_hi, -1
  s_waitcnt vmcnt(0)
  ds_read_b64_tr_b16 v[112:113], v2 offset:0
  ds_read_b64_tr_b16 v[114:115], v2 offset:64
  ds_read_b64_tr_b16 v[124:125], v3 offset:0
  ds_read_b128 v[128:131], v4
  ds_read_b128 v[132:135], v14
  s_waitcnt lgkmcnt(0)
  v_mfma_f32_32x32x4_2b_bf16 v[208:239], v[124:125], v[100:101], 0
  s_nop 15
  s_nop 1
  v_mfma_f32_32x32x16_bf16 v[160:175], v[112:115], v[96:99], v[208:223]
  v_mfma_f32_32x32x16_bf16 v[32:47], v[112:115], v[104:107], v[224:239]
  s_nop 10
  v_max3_f32 v10, v160, v161, v144
  v_max3_f32 v10, v10, v162, v163
  v_max3_f32 v10, v10, v164, v165
  v_max3_f32 v10, v10, v166, v167
  v_max3_f32 v10, v10, v168, v169
  v_max3_f32 v10, v10, v170, v171
  v_max3_f32 v10, v10, v172, v173
  v_max3_f32 v10, v10, v174, v175
  v_mov_b32 v11, v10
  s_nop 1
  v_permlane32_swap_b32 v10, v11
  v_max_f32 v10, v10, v11
  v_sub_f32 v11, v144, v10
  v_exp_f32 v11, v11
  v_mov_b32 v144, v10
  v_sub_f32 v160, v160, v10
  v_sub_f32 v161, v161, v10
  v_sub_f32 v162, v162, v10
  v_sub_f32 v163, v163, v10
  v_sub_f32 v164, v164, v10
  v_sub_f32 v165, v165, v10
  v_sub_f32 v166, v166, v10
  v_sub_f32 v167, v167, v10
  v_sub_f32 v168, v168, v10
  v_sub_f32 v169, v169, v10
  v_sub_f32 v170, v170, v10
  v_sub_f32 v171, v171, v10
  v_sub_f32 v172, v172, v10
  v_sub_f32 v173, v173, v10
  v_sub_f32 v174, v174, v10
  v_sub_f32 v175, v175, v10
  v_exp_f32 v160, v160
  v_exp_f32 v161, v161
  v_exp_f32 v162, v162
  v_exp_f32 v163, v163
  v_exp_f32 v164, v164
  v_exp_f32 v165, v165
  v_exp_f32 v166, v166
  v_exp_f32 v167, v167
  v_exp_f32 v168, v168
  v_exp_f32 v169, v169
  v_exp_f32 v170, v170
  v_exp_f32 v171, v171
  v_exp_f32 v172, v172
  v_exp_f32 v173, v173
  v_exp_f32 v174, v174
  v_exp_f32 v175, v175
  v_mul_f32 v64, v64, v11
  v_mul_f32 v65, v65, v11
  v_mul_f32 v66, v66, v11
  v_mul_f32 v67, v67, v11
  v_mul_f32 v68, v68, v11
  v_mul_f32 v69, v69, v11
  v_mul_f32 v70, v70, v11
  v_mul_f32 v71, v71, v11
  v_mul_f32 v72, v72, v11
  v_mul_f32 v73, v73, v11
  v_mul_f32 v74, v74, v11
  v_mul_f32 v75, v75, v11
  v_mul_f32 v76, v76, v11
  v_mul_f32 v77, v77, v11
  v_mul_f32 v78, v78, v11
  v_mul_f32 v79, v79, v11
  v_cvt_pk_bf16_f32 v48, v160, v161
  v_cvt_pk_bf16_f32 v49, v162, v163
  v_cvt_pk_bf16_f32 v50, v164, v165
  v_cvt_pk_bf16_f32 v51, v166, v167
  v_cvt_pk_bf16_f32 v52, v168, v169
  v_cvt_pk_bf16_f32 v53, v170, v171
  v_cvt_pk_bf16_f32 v54, v172, v173
  v_cvt_pk_bf16_f32 v55, v174, v175
  v_mfma_f32_32x32x16_bf16 v[64:79], v[128:131], v[48:51], v[64:79]
  s_nop 0
  v_mfma_f32_32x32x16_bf16 v[64:79], v[132:135], v[52:55], v[64:79]
  v_max3_f32 v10, v32, v33, v145
  v_max3_f32 v10, v10, v34, v35
  v_max3_f32 v10, v10, v36, v37
  v_max3_f32 v10, v10, v38, v39
  v_max3_f32 v10, v10, v40, v41
  v_max3_f32 v10, v10, v42, v43
  v_max3_f32 v10, v10, v44, v45
  v_max3_f32 v10, v10, v46, v47
  v_mov_b32 v11, v10
  s_nop 1
  v_permlane32_swap_b32 v10, v11
  v_max_f32 v10, v10, v11
  v_sub_f32 v11, v145, v10
  v_exp_f32 v11, v11
  v_mov_b32 v145, v10
  v_sub_f32 v32, v32, v10
  v_sub_f32 v33, v33, v10
  v_sub_f32 v34, v34, v10
  v_sub_f32 v35, v35, v10
  v_sub_f32 v36, v36, v10
  v_sub_f32 v37, v37, v10
  v_sub_f32 v38, v38, v10
  v_sub_f32 v39, v39, v10
  v_sub_f32 v40, v40, v10
  v_sub_f32 v41, v41, v10
  v_sub_f32 v42, v42, v10
  v_sub_f32 v43, v43, v10
  v_sub_f32 v44, v44, v10
  v_sub_f32 v45, v45, v10
  v_sub_f32 v46, v46, v10
  v_sub_f32 v47, v47, v10
  v_exp_f32 v32, v32
  v_exp_f32 v33, v33
  v_exp_f32 v34, v34
  v_exp_f32 v35, v35
  v_exp_f32 v36, v36
  v_exp_f32 v37, v37
  v_exp_f32 v38, v38
  v_exp_f32 v39, v39
  v_exp_f32 v40, v40
  v_exp_f32 v41, v41
  v_exp_f32 v42, v42
  v_exp_f32 v43, v43
  v_exp_f32 v44, v44
  v_exp_f32 v45, v45
  v_exp_f32 v46, v46
  v_exp_f32 v47, v47
  v_mul_f32 v80, v80, v11
  v_mul_f32 v81, v81, v11
  v_mul_f32 v82, v82, v11
  v_mul_f32 v83, v83, v11
  v_mul_f32 v84, v84, v11
  v_mul_f32 v85, v85, v11
  v_mul_f32 v86, v86, v11
  v_mul_f32 v87, v87, v11
  v_mul_f32 v88, v88, v11
  v_mul_f32 v89, v89, v11
  v_mul_f32 v90, v90, v11
  v_mul_f32 v91, v91, v11
  v_mul_f32 v92, v92, v11
  v_mul_f32 v93, v93, v11
  v_mul_f32 v94, v94, v11
  v_mul_f32 v95, v95, v11
  v_cvt_pk_bf16_f32 v56, v32, v33
  v_cvt_pk_bf16_f32 v57, v34, v35
  v_cvt_pk_bf16_f32 v58, v36, v37
  v_cvt_pk_bf16_f32 v59, v38, v39
  v_cvt_pk_bf16_f32 v60, v40, v41
  v_cvt_pk_bf16_f32 v61, v42, v43
  v_cvt_pk_bf16_f32 v62, v44, v45
  v_cvt_pk_bf16_f32 v63, v46, v47
  v_mfma_f32_32x32x16_bf16 v[80:95], v[128:131], v[56:59], v[80:95]
  s_nop 0
  v_mfma_f32_32x32x16_bf16 v[80:95], v[132:135], v[60:63], v[80:95]
  s_add_u32 s65, s65, 4096
  s_add_u32 s9, s9, 1
  s_cmp_lt_u32 s9, 64
  s_nop 8
  s_cbranch_scc1 gated_mix__softmax_full_mha__geglu_ffn__prompt_kernel_sloop
  s_branch gated_mix__softmax_full_mha__geglu_ffn__prompt_kernel_aepi
gated_mix__softmax_full_mha__geglu_ffn__prompt_kernel_astub:
  s_cmp_eq_u32 s9, 2
  s_cbranch_scc1 gated_mix__softmax_full_mha__geglu_ffn__prompt_kernel_astub2
  s_cmp_eq_u32 s9, 4
  s_cbranch_scc1 gated_mix__softmax_full_mha__geglu_ffn__prompt_kernel_astub4
  s_cmp_eq_u32 s9, 6
  s_cbranch_scc1 gated_mix__softmax_full_mha__geglu_ffn__prompt_kernel_astub6
  s_cmp_eq_u32 s9, 7
  s_cbranch_scc1 gated_mix__softmax_full_mha__geglu_ffn__prompt_kernel_astub7
  s_waitcnt vmcnt(0)
  v_mov_b32 v10, 161828
  v_mov_b32 v11, 1
  s_mov_b64 exec, 1
  ds_add_u32 v10, v11
  s_mov_b64 exec, -1
  s_nop 3
  s_branch gated_mix__softmax_full_mha__geglu_ffn__prompt_kernel_acont
gated_mix__softmax_full_mha__geglu_ffn__prompt_kernel_astub2:
  v_mov_b32 v10, 161800
gated_mix__softmax_full_mha__geglu_ffn__prompt_kernel_ap2:
  ds_read_b32 v11, v10
  s_waitcnt lgkmcnt(0)
  v_readfirstlane_b32 s63, v11
  s_nop 0
  s_cmp_ge_u32 s63, 4
  s_cbranch_scc1 gated_mix__softmax_full_mha__geglu_ffn__prompt_kernel_ap2d
  s_sleep 1
  s_branch gated_mix__softmax_full_mha__geglu_ffn__prompt_kernel_ap2
gated_mix__softmax_full_mha__geglu_ffn__prompt_kernel_ap2d:
  s_branch gated_mix__softmax_full_mha__geglu_ffn__prompt_kernel_acont
gated_mix__softmax_full_mha__geglu_ffn__prompt_kernel_astub4:
  v_mov_b32 v10, 161804
gated_mix__softmax_full_mha__geglu_ffn__prompt_kernel_ap3:
  ds_read_b32 v11, v10
  s_waitcnt lgkmcnt(0)
  v_readfirstlane_b32 s63, v11
  s_nop 0
  s_cmp_ge_u32 s63, 4
  s_cbranch_scc1 gated_mix__softmax_full_mha__geglu_ffn__prompt_kernel_ap3d
  s_sleep 1
  s_branch gated_mix__softmax_full_mha__geglu_ffn__prompt_kernel_ap3
gated_mix__softmax_full_mha__geglu_ffn__prompt_kernel_ap3d:
  s_branch gated_mix__softmax_full_mha__geglu_ffn__prompt_kernel_acont
gated_mix__softmax_full_mha__geglu_ffn__prompt_kernel_astub6:
  v_mov_b32 v10, 161792
  v_mov_b32 v11, 1
  s_mov_b64 exec, 1
  ds_add_u32 v10, v11
  s_mov_b64 exec, -1
  s_nop 3
  s_branch gated_mix__softmax_full_mha__geglu_ffn__prompt_kernel_acont
gated_mix__softmax_full_mha__geglu_ffn__prompt_kernel_astub7:
  v_mov_b32 v10, 161832
gated_mix__softmax_full_mha__geglu_ffn__prompt_kernel_ap7:
  ds_read_b32 v11, v10
  s_waitcnt lgkmcnt(0)
  v_readfirstlane_b32 s63, v11
  s_nop 0
  s_cmp_ge_u32 s63, 1
  s_cbranch_scc1 gated_mix__softmax_full_mha__geglu_ffn__prompt_kernel_ap7d
  s_sleep 1
  s_branch gated_mix__softmax_full_mha__geglu_ffn__prompt_kernel_ap7
gated_mix__softmax_full_mha__geglu_ffn__prompt_kernel_ap7d:
  v_and_b32 v11, 7, v0
  v_bfe_u32 v12, v0, 3, 1
  v_lshl_add_u32 v11, v12, 4, v11
  v_bfe_u32 v12, v0, 4, 1
  v_lshl_add_u32 v11, v12, 3, v11
  v_lshlrev_b32 v12, 2, v11
  s_lshl_b32 s64, s18, 7
  s_add_u32 s64, s64, 35594240
  buffer_load_dword v5, v12, s[44:47], s64 offen sc1
  buffer_load_dword v6, v12, s[44:47], s64 offen offset:128 sc1
  v_cmp_gt_u32 vcc, 32, v0
  v_mov_b32 v13, 2147483648
  s_nop 0
  v_cndmask_b32 v8, v13, v12, vcc
  v_lshlrev_b32 v12, 4, v11
  v_lshl_add_u32 v7, v9, 9, v12
  s_branch gated_mix__softmax_full_mha__geglu_ffn__prompt_kernel_acont
gated_mix__softmax_full_mha__geglu_ffn__prompt_kernel_gemm:
  v_mov_b32 v244, 161824
  v_mov_b32 v245, 1
  s_mov_b64 exec, 1
  ds_add_u32 v244, v245
  s_mov_b64 exec, -1
  v_lshlrev_b32 v1, 4, v0
  s_and_b32 s13, s57, 1
  s_mul_i32 s9, s13, 144
  s_mul_i32 s64, s7, 36
  s_add_u32 s9, s9, s64
  s_lshr_b32 s64, s57, 1
  s_lshl_b32 s64, s64, 2
  s_lshr_b32 s65, s4, 3
  s_add_u32 s6, s64, s65
  s_and_b32 s5, s4, 7
  s_mul_i32 s88, s6, 288
  s_add_u32 s88, s88, s9
  s_lshl_b32 s88, s88, 12
  s_mul_i32 s89, s5, 288
  s_add_u32 s89, s89, s9
  s_mul_i32 s89, s89, 2304
  s_add_u32 s89, s89, 18874368
  s_lshl_b32 s64, s7, 12
  s_add_u32 s8, s8, s64
  v_mov_b32 v236, v120
  v_mov_b32 v237, v121
  v_mov_b32 v238, v122
  v_bfe_u32 v2, v0, 3, 1
  v_bfe_u32 v3, v0, 4, 1
  v_cmp_eq_u32 vcc, v2, v3
  v_lshrrev_b32 v3, 5, v0
  v_lshlrev_b32 v3, 7, v3
  v_and_b32 v2, 7, v0
  v_lshl_add_u32 v3, v2, 4, v3
  v_mov_b32 v2, 2147483648
  v_cndmask_b32 v2, v2, v3, vcc
  v_mov_b32 v246, 0
  s_lshl_b32 s64, s13, 11
  v_add_u32 v232, s64, v1
  v_xor_b32 v233, 2048, v232
  s_waitcnt vmcnt(2)
  v_cmp_ne_u32 vcc, s0, v113
  s_and_b32 vcc_lo, vcc_lo, 4095
  s_cbranch_scc0 gated_mix__softmax_full_mha__geglu_ffn__prompt_kernel_gc1ok
  s_mov_b32 s14, 0
gated_mix__softmax_full_mha__geglu_ffn__prompt_kernel_gc1:
  buffer_load_dword v245, v112, s[44:47], s99 offen offset:128 sc1
  s_add_u32 s14, s14, 1
  s_waitcnt vmcnt(0)
  v_cmp_ne_u32 vcc, s0, v245
  s_and_b32 vcc_lo, vcc_lo, 4095
  s_cbranch_scc0 gated_mix__softmax_full_mha__geglu_ffn__prompt_kernel_gc1d
  s_cmp_ge_u32 s14, 0x8000
  s_cbranch_scc1 gated_mix__softmax_full_mha__geglu_ffn__prompt_kernel_gc1d
  s_sleep 4
  s_branch gated_mix__softmax_full_mha__geglu_ffn__prompt_kernel_gc1
gated_mix__softmax_full_mha__geglu_ffn__prompt_kernel_gc1d:
gated_mix__softmax_full_mha__geglu_ffn__prompt_kernel_gc1ok:
  s_add_u32 s10, s88, 0
  s_add_u32 s11, s89, 0
  buffer_load_dwordx4 v[148:151], v232, s[44:47], s10 offen offset:0 sc1
  buffer_load_dwordx4 v[152:155], v232, s[44:47], s10 offen offset:1024 sc1
  buffer_load_dwordx4 v[156:159], v233, s[44:47], s10 offen offset:0 sc1
  buffer_load_dwordx4 v[160:163], v233, s[44:47], s10 offen offset:1024 sc1
  buffer_load_dwordx4 v[164:167], v1, s[44:47], s11 offen sc1
  buffer_load_dwordx4 v[168:171], v1, s[44:47], s11 offen offset:1024 sc1
  buffer_load_dwordx4 v[172:175], v2, s[44:47], s11 offen offset:2048 sc1
  s_add_u32 s10, s88, 4096
  s_add_u32 s11, s89, 2304
  buffer_load_dwordx4 v[176:179], v232, s[44:47], s10 offen offset:0 sc1
  buffer_load_dwordx4 v[180:183], v232, s[44:47], s10 offen offset:1024 sc1
  buffer_load_dwordx4 v[184:187], v233, s[44:47], s10 offen offset:0 sc1
  buffer_load_dwordx4 v[188:191], v233, s[44:47], s10 offen offset:1024 sc1
  buffer_load_dwordx4 v[192:195], v1, s[44:47], s11 offen sc1
  buffer_load_dwordx4 v[196:199], v1, s[44:47], s11 offen offset:1024 sc1
  buffer_load_dwordx4 v[200:203], v2, s[44:47], s11 offen offset:2048 sc1
  s_add_u32 s10, s88, 8192
  s_add_u32 s11, s89, 4608
  buffer_load_dwordx4 v[204:207], v232, s[44:47], s10 offen offset:0 sc1
  buffer_load_dwordx4 v[208:211], v232, s[44:47], s10 offen offset:1024 sc1
  buffer_load_dwordx4 v[212:215], v233, s[44:47], s10 offen offset:0 sc1
  buffer_load_dwordx4 v[216:219], v233, s[44:47], s10 offen offset:1024 sc1
  buffer_load_dwordx4 v[220:223], v1, s[44:47], s11 offen sc1
  buffer_load_dwordx4 v[224:227], v1, s[44:47], s11 offen offset:1024 sc1
  buffer_load_dwordx4 v[228:231], v2, s[44:47], s11 offen offset:2048 sc1
  s_waitcnt vmcnt(14)
  v_mov_b32 v244, 161828
  v_mov_b32 v245, 1
  s_mov_b64 exec, 1
  ds_add_u32 v244, v245
  s_mov_b64 exec, -1
  s_setprio 0
  s_add_u32 s10, s88, 12288
  s_add_u32 s11, s89, 6912
  v_mfma_f32_32x32x16_bf16 v[4:19], v[164:167], v[148:151], 0
  v_mfma_f32_32x32x16_bf16 v[20:35], v[168:171], v[148:151], 0
  v_mfma_f32_16x16x32_bf16 v[36:39], v[172:175], v[148:151], 0
  buffer_load_dwordx4 v[148:151], v232, s[44:47], s10 offen offset:0 sc1
  v_mfma_f32_32x32x16_bf16 v[40:55], v[164:167], v[152:155], 0
  v_mfma_f32_32x32x16_bf16 v[56:71], v[168:171], v[152:155], 0
  v_mfma_f32_16x16x32_bf16 v[72:75], v[172:175], v[152:155], 0
  buffer_load_dwordx4 v[152:155], v232, s[44:47], s10 offen offset:1024 sc1
  v_mfma_f32_32x32x16_bf16 v[76:91], v[164:167], v[156:159], 0
  v_mfma_f32_32x32x16_bf16 v[92:107], v[168:171], v[156:159], 0
  v_mfma_f32_16x16x32_bf16 v[108:111], v[172:175], v[156:159], 0
  buffer_load_dwordx4 v[156:159], v233, s[44:47], s10 offen offset:0 sc1
  v_mfma_f32_32x32x16_bf16 v[112:127], v[164:167], v[160:163], 0
  v_mfma_f32_32x32x16_bf16 v[128:143], v[168:171], v[160:163], 0
  v_mfma_f32_16x16x32_bf16 v[144:147], v[172:175], v[160:163], 0
  buffer_load_dwordx4 v[160:163], v233, s[44:47], s10 offen offset:1024 sc1
  buffer_load_dwordx4 v[164:167], v1, s[44:47], s11 offen sc1
  buffer_load_dwordx4 v[168:171], v1, s[44:47], s11 offen offset:1024 sc1
  buffer_load_dwordx4 v[172:175], v2, s[44:47], s11 offen offset:2048 sc1
  s_waitcnt vmcnt(14)
  v_mov_b32 v244, 161824
gated_mix__softmax_full_mha__geglu_ffn__prompt_kernel_gwd:
  ds_read_b32 v245, v244
  s_waitcnt lgkmcnt(0)
  v_readfirstlane_b32 s63, v245
  s_nop 0
  s_cmp_ge_u32 s63, 8
  s_cbranch_scc1 gated_mix__softmax_full_mha__geglu_ffn__prompt_kernel_gwdd
  s_sleep 1
  s_branch gated_mix__softmax_full_mha__geglu_ffn__prompt_kernel_gwd
gated_mix__softmax_full_mha__geglu_ffn__prompt_kernel_gwdd:
  v_mov_b32 v244, 161820
gated_mix__softmax_full_mha__geglu_ffn__prompt_kernel_gq1:
  ds_read_b32 v245, v244
  s_waitcnt lgkmcnt(0)
  v_readfirstlane_b32 s63, v245
  s_nop 0
  s_cmp_ge_u32 s63, 1
  s_cbranch_scc1 gated_mix__softmax_full_mha__geglu_ffn__prompt_kernel_gq1d
  s_sleep 1
  s_branch gated_mix__softmax_full_mha__geglu_ffn__prompt_kernel_gq1
gated_mix__softmax_full_mha__geglu_ffn__prompt_kernel_gq1d:
  v_mul_u32_u24 v239, 2336, v0
  v_add_u32 v239, 49024, v239
  v_mov_b32 v240, 0x3f803f80
  v_mov_b32 v241, 0x3f803f80
  v_mov_b32 v242, 0
  v_mov_b32 v243, 0
  s_mov_b64 exec, -1
  s_mov_b32 exec_hi, 4095
  ds_write2_b64 v239, v[240:241], v[240:241] offset0:0 offset1:1
  ds_write2_b64 v239, v[242:243], v[242:243] offset0:2 offset1:3
  s_mov_b64 exec, -1
  s_add_u32 s10, s88, 32768
  s_add_u32 s11, s89, 18432
  v_mfma_f32_32x32x16_bf16 v[4:19], v[192:195], v[176:179], v[4:19]
  v_mfma_f32_32x32x16_bf16 v[20:35], v[196:199], v[176:179], v[20:35]
  v_mfma_f32_16x16x32_bf16 v[36:39], v[200:203], v[176:179], v[36:39]
  buffer_load_dwordx4 v[176:179], v232, s[44:47], s10 offen offset:0 sc1
  v_mfma_f32_32x32x16_bf16 v[40:55], v[192:195], v[180:183], v[40:55]
  v_mfma_f32_32x32x16_bf16 v[56:71], v[196:199], v[180:183], v[56:71]
  v_mfma_f32_16x16x32_bf16 v[72:75], v[200:203], v[180:183], v[72:75]
  buffer_load_dwordx4 v[180:183], v232, s[44:47], s10 offen offset:1024 sc1
  v_mfma_f32_32x32x16_bf16 v[76:91], v[192:195], v[184:187], v[76:91]
  v_mfma_f32_32x32x16_bf16 v[92:107], v[196:199], v[184:187], v[92:107]
  v_mfma_f32_16x16x32_bf16 v[108:111], v[200:203], v[184:187], v[108:111]
  buffer_load_dwordx4 v[184:187], v233, s[44:47], s10 offen offset:0 sc1
  v_mfma_f32_32x32x16_bf16 v[112:127], v[192:195], v[188:191], v[112:127]
  v_mfma_f32_32x32x16_bf16 v[128:143], v[196:199], v[188:191], v[128:143]
  v_mfma_f32_16x16x32_bf16 v[144:147], v[200:203], v[188:191], v[144:147]
  buffer_load_dwordx4 v[188:191], v233, s[44:47], s10 offen offset:1024 sc1
  s_mov_b32 exec_hi, 0xffff
  s_add_u32 s64, s8, 81920
  s_add_u32 m0, s12, 46720
  s_nop 0
  buffer_load_dwordx4 v236, s[44:47], s64 offen sc1 lds
  s_add_u32 m0, s12, 47488
  s_nop 0
  buffer_load_dwordx4 v237, s[44:47], s64 offen sc1 lds
  s_add_u32 m0, s12, 48256
  s_nop 0
  buffer_load_dwordx4 v238, s[44:47], s64 offen sc1 lds
  s_add_u32 s64, s8, 98304
  s_add_u32 m0, s12, 56064
  s_nop 0
  buffer_load_dwordx4 v236, s[44:47], s64 offen sc1 lds
  s_add_u32 m0, s12, 56832
  s_nop 0
  buffer_load_dwordx4 v237, s[44:47], s64 offen sc1 lds
  s_add_u32 m0, s12, 57600
  s_nop 0
  buffer_load_dwordx4 v238, s[44:47], s64 offen sc1 lds
  s_mov_b32 exec_hi, -1
  buffer_load_dwordx4 v[192:195], v1, s[44:47], s11 offen sc1
  buffer_load_dwordx4 v[196:199], v1, s[44:47], s11 offen offset:1024 sc1
  buffer_load_dwordx4 v[200:203], v2, s[44:47], s11 offen offset:2048 sc1
  s_waitcnt vmcnt(20)
  s_add_u32 s10, s88, 36864
  s_add_u32 s11, s89, 20736
  v_mfma_f32_32x32x16_bf16 v[4:19], v[220:223], v[204:207], v[4:19]
  v_mfma_f32_32x32x16_bf16 v[20:35], v[224:227], v[204:207], v[20:35]
  v_mfma_f32_16x16x32_bf16 v[36:39], v[228:231], v[204:207], v[36:39]
  buffer_load_dwordx4 v[204:207], v232, s[44:47], s10 offen offset:0 sc1
  v_mfma_f32_32x32x16_bf16 v[40:55], v[220:223], v[208:211], v[40:55]
  v_mfma_f32_32x32x16_bf16 v[56:71], v[224:227], v[208:211], v[56:71]
  v_mfma_f32_16x16x32_bf16 v[72:75], v[228:231], v[208:211], v[72:75]
  buffer_load_dwordx4 v[208:211], v232, s[44:47], s10 offen offset:1024 sc1
  v_mfma_f32_32x32x16_bf16 v[76:91], v[220:223], v[212:215], v[76:91]
  v_mfma_f32_32x32x16_bf16 v[92:107], v[224:227], v[212:215], v[92:107]
  v_mfma_f32_16x16x32_bf16 v[108:111], v[228:231], v[212:215], v[108:111]
  buffer_load_dwordx4 v[212:215], v233, s[44:47], s10 offen offset:0 sc1
  v_mfma_f32_32x32x16_bf16 v[112:127], v[220:223], v[216:219], v[112:127]
  v_mfma_f32_32x32x16_bf16 v[128:143], v[224:227], v[216:219], v[128:143]
  v_mfma_f32_16x16x32_bf16 v[144:147], v[228:231], v[216:219], v[144:147]
  buffer_load_dwordx4 v[216:219], v233, s[44:47], s10 offen offset:1024 sc1
  s_mov_b32 exec_hi, 0xffff
  s_add_u32 s64, s8, 114688
  s_add_u32 m0, s12, 65408
  s_nop 0
  buffer_load_dwordx4 v236, s[44:47], s64 offen sc1 lds
  s_add_u32 m0, s12, 66176
  s_nop 0
  buffer_load_dwordx4 v237, s[44:47], s64 offen sc1 lds
  s_add_u32 m0, s12, 66944
  s_nop 0
  buffer_load_dwordx4 v238, s[44:47], s64 offen sc1 lds
  s_add_u32 s64, s8, 131072
  s_add_u32 m0, s12, 74752
  s_nop 0
  buffer_load_dwordx4 v236, s[44:47], s64 offen sc1 lds
  s_add_u32 m0, s12, 75520
  s_nop 0
  buffer_load_dwordx4 v237, s[44:47], s64 offen sc1 lds
  s_add_u32 m0, s12, 76288
  s_nop 0
  buffer_load_dwordx4 v238, s[44:47], s64 offen sc1 lds
  s_mov_b32 exec_hi, -1
  buffer_load_dwordx4 v[220:223], v1, s[44:47], s11 offen sc1
  buffer_load_dwordx4 v[224:227], v1, s[44:47], s11 offen offset:1024 sc1
  buffer_load_dwordx4 v[228:231], v2, s[44:47], s11 offen offset:2048 sc1
  s_waitcnt vmcnt(26)
  s_add_u32 s10, s88, 40960
  s_add_u32 s11, s89, 23040
  v_mfma_f32_32x32x16_bf16 v[4:19], v[164:167], v[148:151], v[4:19]
  v_mfma_f32_32x32x16_bf16 v[20:35], v[168:171], v[148:151], v[20:35]
  v_mfma_f32_16x16x32_bf16 v[36:39], v[172:175], v[148:151], v[36:39]
  buffer_load_dwordx4 v[148:151], v232, s[44:47], s10 offen offset:0 sc1
  v_mfma_f32_32x32x16_bf16 v[40:55], v[164:167], v[152:155], v[40:55]
  v_mfma_f32_32x32x16_bf16 v[56:71], v[168:171], v[152:155], v[56:71]
  v_mfma_f32_16x16x32_bf16 v[72:75], v[172:175], v[152:155], v[72:75]
  buffer_load_dwordx4 v[152:155], v232, s[44:47], s10 offen offset:1024 sc1
  v_mfma_f32_32x32x16_bf16 v[76:91], v[164:167], v[156:159], v[76:91]
  v_mfma_f32_32x32x16_bf16 v[92:107], v[168:171], v[156:159], v[92:107]
  v_mfma_f32_16x16x32_bf16 v[108:111], v[172:175], v[156:159], v[108:111]
  buffer_load_dwordx4 v[156:159], v233, s[44:47], s10 offen offset:0 sc1
  v_mfma_f32_32x32x16_bf16 v[112:127], v[164:167], v[160:163], v[112:127]
  v_mfma_f32_32x32x16_bf16 v[128:143], v[168:171], v[160:163], v[128:143]
  v_mfma_f32_16x16x32_bf16 v[144:147], v[172:175], v[160:163], v[144:147]
  buffer_load_dwordx4 v[160:163], v233, s[44:47], s10 offen offset:1024 sc1
  s_mov_b32 exec_hi, 0xffff
  s_add_u32 s64, s8, 147456
  s_add_u32 m0, s12, 84096
  s_nop 0
  buffer_load_dwordx4 v236, s[44:47], s64 offen sc1 lds
  s_add_u32 m0, s12, 84864
  s_nop 0
  buffer_load_dwordx4 v237, s[44:47], s64 offen sc1 lds
  s_add_u32 m0, s12, 85632
  s_nop 0
  buffer_load_dwordx4 v238, s[44:47], s64 offen sc1 lds
  s_mov_b32 exec_hi, -1
  buffer_load_dwordx4 v[164:167], v1, s[44:47], s11 offen sc1
  buffer_load_dwordx4 v[168:171], v1, s[44:47], s11 offen offset:1024 sc1
  buffer_load_dwordx4 v[172:175], v2, s[44:47], s11 offen offset:2048 sc1
  s_waitcnt vmcnt(23)
  s_add_u32 s10, s88, 45056
  s_add_u32 s11, s89, 25344
  v_mfma_f32_32x32x16_bf16 v[4:19], v[192:195], v[176:179], v[4:19]
  v_mfma_f32_32x32x16_bf16 v[20:35], v[196:199], v[176:179], v[20:35]
  v_mfma_f32_16x16x32_bf16 v[36:39], v[200:203], v[176:179], v[36:39]
  buffer_load_dwordx4 v[176:179], v232, s[44:47], s10 offen offset:0 sc1
  v_mfma_f32_32x32x16_bf16 v[40:55], v[192:195], v[180:183], v[40:55]
  v_mfma_f32_32x32x16_bf16 v[56:71], v[196:199], v[180:183], v[56:71]
  v_mfma_f32_16x16x32_bf16 v[72:75], v[200:203], v[180:183], v[72:75]
  buffer_load_dwordx4 v[180:183], v232, s[44:47], s10 offen offset:1024 sc1
  v_mfma_f32_32x32x16_bf16 v[76:91], v[192:195], v[184:187], v[76:91]
  v_mfma_f32_32x32x16_bf16 v[92:107], v[196:199], v[184:187], v[92:107]
  v_mfma_f32_16x16x32_bf16 v[108:111], v[200:203], v[184:187], v[108:111]
  buffer_load_dwordx4 v[184:187], v233, s[44:47], s10 offen offset:0 sc1
  v_mfma_f32_32x32x16_bf16 v[112:127], v[192:195], v[188:191], v[112:127]
  v_mfma_f32_32x32x16_bf16 v[128:143], v[196:199], v[188:191], v[128:143]
  v_mfma_f32_16x16x32_bf16 v[144:147], v[200:203], v[188:191], v[144:147]
  buffer_load_dwordx4 v[188:191], v233, s[44:47], s10 offen offset:1024 sc1
  s_mov_b32 exec_hi, 0xffff
  s_add_u32 s64, s8, 163840
  s_add_u32 m0, s12, 93440
  s_nop 0
  buffer_load_dwordx4 v236, s[44:47], s64 offen sc1 lds
  s_add_u32 m0, s12, 94208
  s_nop 0
  buffer_load_dwordx4 v237, s[44:47], s64 offen sc1 lds
  s_add_u32 m0, s12, 94976
  s_nop 0
  buffer_load_dwordx4 v238, s[44:47], s64 offen sc1 lds
  s_mov_b32 exec_hi, -1
  buffer_load_dwordx4 v[192:195], v1, s[44:47], s11 offen sc1
  buffer_load_dwordx4 v[196:199], v1, s[44:47], s11 offen offset:1024 sc1
  buffer_load_dwordx4 v[200:203], v2, s[44:47], s11 offen offset:2048 sc1
  s_waitcnt vmcnt(20)
  v_mov_b32 v244, 161800
  v_mov_b32 v245, 1
  s_mov_b64 exec, 1
  ds_add_u32 v244, v245
  s_mov_b64 exec, -1
  s_cmp_lg_u32 s56, 4
  s_cbranch_scc1 gated_mix__softmax_full_mha__geglu_ffn__prompt_kernel_c2s5
  v_mov_b32 v244, 161828
gated_mix__softmax_full_mha__geglu_ffn__prompt_kernel_gst:
  ds_read_b32 v245, v244
  s_waitcnt lgkmcnt(0)
  v_readfirstlane_b32 s63, v245
  s_nop 0
  s_cmp_ge_u32 s63, 8
  s_cbranch_scc1 gated_mix__softmax_full_mha__geglu_ffn__prompt_kernel_gstd
  s_sleep 2
  s_branch gated_mix__softmax_full_mha__geglu_ffn__prompt_kernel_gst
gated_mix__softmax_full_mha__geglu_ffn__prompt_kernel_gstd:
  v_mov_b32 v244, 128
  v_mov_b32 v254, 1
  s_mov_b64 exec, 1
  buffer_atomic_add v254, v244, s[48:51], 0 offen sc0 sc1
  s_mov_b64 exec, -1
gated_mix__softmax_full_mha__geglu_ffn__prompt_kernel_c2s5:
  s_add_u32 s10, s88, 65536
  s_add_u32 s11, s89, 36864
  v_mfma_f32_32x32x16_bf16 v[4:19], v[220:223], v[204:207], v[4:19]
  v_mfma_f32_32x32x16_bf16 v[20:35], v[224:227], v[204:207], v[20:35]
  v_mfma_f32_16x16x32_bf16 v[36:39], v[228:231], v[204:207], v[36:39]
  buffer_load_dwordx4 v[204:207], v232, s[44:47], s10 offen offset:0 sc1
  v_mfma_f32_32x32x16_bf16 v[40:55], v[220:223], v[208:211], v[40:55]
  v_mfma_f32_32x32x16_bf16 v[56:71], v[224:227], v[208:211], v[56:71]
  v_mfma_f32_16x16x32_bf16 v[72:75], v[228:231], v[208:211], v[72:75]
  buffer_load_dwordx4 v[208:211], v232, s[44:47], s10 offen offset:1024 sc1
  v_mfma_f32_32x32x16_bf16 v[76:91], v[220:223], v[212:215], v[76:91]
  v_mfma_f32_32x32x16_bf16 v[92:107], v[224:227], v[212:215], v[92:107]
  v_mfma_f32_16x16x32_bf16 v[108:111], v[228:231], v[212:215], v[108:111]
  buffer_load_dwordx4 v[212:215], v233, s[44:47], s10 offen offset:0 sc1
  v_mfma_f32_32x32x16_bf16 v[112:127], v[220:223], v[216:219], v[112:127]
  v_mfma_f32_32x32x16_bf16 v[128:143], v[224:227], v[216:219], v[128:143]
  v_mfma_f32_16x16x32_bf16 v[144:147], v[228:231], v[216:219], v[144:147]
  buffer_load_dwordx4 v[216:219], v233, s[44:47], s10 offen offset:1024 sc1
  s_mov_b32 exec_hi, 0xffff
  s_add_u32 s64, s8, 180224
  s_add_u32 m0, s12, 102784
  s_nop 0
  buffer_load_dwordx4 v236, s[44:47], s64 offen sc1 lds
  s_add_u32 m0, s12, 103552
  s_nop 0
  buffer_load_dwordx4 v237, s[44:47], s64 offen sc1 lds
  s_add_u32 m0, s12, 104320
  s_nop 0
  buffer_load_dwordx4 v238, s[44:47], s64 offen sc1 lds
  s_mov_b32 exec_hi, -1
  buffer_load_dwordx4 v[220:223], v1, s[44:47], s11 offen sc1
  buffer_load_dwordx4 v[224:227], v1, s[44:47], s11 offen offset:1024 sc1
  buffer_load_dwordx4 v[228:231], v2, s[44:47], s11 offen offset:2048 sc1
  s_waitcnt vmcnt(20)
  s_add_u32 s10, s88, 69632
  s_add_u32 s11, s89, 39168
  v_mfma_f32_32x32x16_bf16 v[4:19], v[164:167], v[148:151], v[4:19]
  v_mfma_f32_32x32x16_bf16 v[20:35], v[168:171], v[148:151], v[20:35]
  v_mfma_f32_16x16x32_bf16 v[36:39], v[172:175], v[148:151], v[36:39]
  buffer_load_dwordx4 v[148:151], v232, s[44:47], s10 offen offset:0 sc1
  v_mfma_f32_32x32x16_bf16 v[40:55], v[164:167], v[152:155], v[40:55]
  v_mfma_f32_32x32x16_bf16 v[56:71], v[168:171], v[152:155], v[56:71]
  v_mfma_f32_16x16x32_bf16 v[72:75], v[172:175], v[152:155], v[72:75]
  buffer_load_dwordx4 v[152:155], v232, s[44:47], s10 offen offset:1024 sc1
  v_mfma_f32_32x32x16_bf16 v[76:91], v[164:167], v[156:159], v[76:91]
  v_mfma_f32_32x32x16_bf16 v[92:107], v[168:171], v[156:159], v[92:107]
  v_mfma_f32_16x16x32_bf16 v[108:111], v[172:175], v[156:159], v[108:111]
  buffer_load_dwordx4 v[156:159], v233, s[44:47], s10 offen offset:0 sc1
  v_mfma_f32_32x32x16_bf16 v[112:127], v[164:167], v[160:163], v[112:127]
  v_mfma_f32_32x32x16_bf16 v[128:143], v[168:171], v[160:163], v[128:143]
  v_mfma_f32_16x16x32_bf16 v[144:147], v[172:175], v[160:163], v[144:147]
  buffer_load_dwordx4 v[160:163], v233, s[44:47], s10 offen offset:1024 sc1
  s_mov_b32 exec_hi, 0xffff
  s_add_u32 s64, s8, 196608
  s_add_u32 m0, s12, 112128
  s_nop 0
  buffer_load_dwordx4 v236, s[44:47], s64 offen sc1 lds
  s_add_u32 m0, s12, 112896
  s_nop 0
  buffer_load_dwordx4 v237, s[44:47], s64 offen sc1 lds
  s_add_u32 m0, s12, 113664
  s_nop 0
  buffer_load_dwordx4 v238, s[44:47], s64 offen sc1 lds
  s_mov_b32 exec_hi, -1
  buffer_load_dwordx4 v[164:167], v1, s[44:47], s11 offen sc1
  buffer_load_dwordx4 v[168:171], v1, s[44:47], s11 offen offset:1024 sc1
  buffer_load_dwordx4 v[172:175], v2, s[44:47], s11 offen offset:2048 sc1
  s_waitcnt vmcnt(20)
  s_add_u32 s10, s88, 73728
  s_add_u32 s11, s89, 41472
  v_mfma_f32_32x32x16_bf16 v[4:19], v[192:195], v[176:179], v[4:19]
  v_mfma_f32_32x32x16_bf16 v[20:35], v[196:199], v[176:179], v[20:35]
  v_mfma_f32_16x16x32_bf16 v[36:39], v[200:203], v[176:179], v[36:39]
  buffer_load_dwordx4 v[176:179], v232, s[44:47], s10 offen offset:0 sc1
  v_mfma_f32_32x32x16_bf16 v[40:55], v[192:195], v[180:183], v[40:55]
  v_mfma_f32_32x32x16_bf16 v[56:71], v[196:199], v[180:183], v[56:71]
  v_mfma_f32_16x16x32_bf16 v[72:75], v[200:203], v[180:183], v[72:75]
  buffer_load_dwordx4 v[180:183], v232, s[44:47], s10 offen offset:1024 sc1
  v_mfma_f32_32x32x16_bf16 v[76:91], v[192:195], v[184:187], v[76:91]
  v_mfma_f32_32x32x16_bf16 v[92:107], v[196:199], v[184:187], v[92:107]
  v_mfma_f32_16x16x32_bf16 v[108:111], v[200:203], v[184:187], v[108:111]
  buffer_load_dwordx4 v[184:187], v233, s[44:47], s10 offen offset:0 sc1
  v_mfma_f32_32x32x16_bf16 v[112:127], v[192:195], v[188:191], v[112:127]
  v_mfma_f32_32x32x16_bf16 v[128:143], v[196:199], v[188:191], v[128:143]
  v_mfma_f32_16x16x32_bf16 v[144:147], v[200:203], v[188:191], v[144:147]
  buffer_load_dwordx4 v[188:191], v233, s[44:47], s10 offen offset:1024 sc1
  s_mov_b32 exec_hi, 0xffff
  s_add_u32 s64, s8, 212992
  s_add_u32 m0, s12, 121472
  s_nop 0
  buffer_load_dwordx4 v236, s[44:47], s64 offen sc1 lds
  s_add_u32 m0, s12, 122240
  s_nop 0
  buffer_load_dwordx4 v237, s[44:47], s64 offen sc1 lds
  s_add_u32 m0, s12, 123008
  s_nop 0
  buffer_load_dwordx4 v238, s[44:47], s64 offen sc1 lds
  s_mov_b32 exec_hi, -1
  buffer_load_dwordx4 v[192:195], v1, s[44:47], s11 offen sc1
  buffer_load_dwordx4 v[196:199], v1, s[44:47], s11 offen offset:1024 sc1
  buffer_load_dwordx4 v[200:203], v2, s[44:47], s11 offen offset:2048 sc1
  s_waitcnt vmcnt(20)
  s_cmp_lg_u32 s56, 4
  s_cbranch_scc1 gated_mix__softmax_full_mha__geglu_ffn__prompt_kernel_c2s8
  v_readfirstlane_b32 s63, v254
  s_nop 0
  s_and_b32 s63, s63, 255
  s_cmp_lg_u32 s63, 255
  s_cbranch_scc1 gated_mix__softmax_full_mha__geglu_ffn__prompt_kernel_c2s8
  v_lshlrev_b32 v244, 9, v0
  v_mov_b32 v254, s0
  s_mov_b32 s63, 45088772
  buffer_store_dword v254, v244, s[44:47], s63 offen sc1
  s_mov_b32 s63, 45121540
  buffer_store_dword v254, v244, s[44:47], s63 offen sc1
  s_mov_b32 s63, 45154308
  buffer_store_dword v254, v244, s[44:47], s63 offen sc1
  s_mov_b32 s63, 45187076
  buffer_store_dword v254, v244, s[44:47], s63 offen sc1
  s_mov_b32 s63, 45219840
  s_mov_b64 exec, 1
  buffer_store_dword v254, v244, s[44:47], s63 offen sc1
  s_mov_b64 exec, -1
gated_mix__softmax_full_mha__geglu_ffn__prompt_kernel_c2s8:
  s_add_u32 s10, s88, 77824
  s_add_u32 s11, s89, 43776
  v_mfma_f32_32x32x16_bf16 v[4:19], v[220:223], v[204:207], v[4:19]
  v_mfma_f32_32x32x16_bf16 v[20:35], v[224:227], v[204:207], v[20:35]
  v_mfma_f32_16x16x32_bf16 v[36:39], v[228:231], v[204:207], v[36:39]
  buffer_load_dwordx4 v[204:207], v232, s[44:47], s10 offen offset:0 sc1
  v_mfma_f32_32x32x16_bf16 v[40:55], v[220:223], v[208:211], v[40:55]
  v_mfma_f32_32x32x16_bf16 v[56:71], v[224:227], v[208:211], v[56:71]
  v_mfma_f32_16x16x32_bf16 v[72:75], v[228:231], v[208:211], v[72:75]
  buffer_load_dwordx4 v[208:211], v232, s[44:47], s10 offen offset:1024 sc1
  v_mfma_f32_32x32x16_bf16 v[76:91], v[220:223], v[212:215], v[76:91]
  v_mfma_f32_32x32x16_bf16 v[92:107], v[224:227], v[212:215], v[92:107]
  v_mfma_f32_16x16x32_bf16 v[108:111], v[228:231], v[212:215], v[108:111]
  buffer_load_dwordx4 v[212:215], v233, s[44:47], s10 offen offset:0 sc1
  v_mfma_f32_32x32x16_bf16 v[112:127], v[220:223], v[216:219], v[112:127]
  v_mfma_f32_32x32x16_bf16 v[128:143], v[224:227], v[216:219], v[128:143]
  v_mfma_f32_16x16x32_bf16 v[144:147], v[228:231], v[216:219], v[144:147]
  buffer_load_dwordx4 v[216:219], v233, s[44:47], s10 offen offset:1024 sc1
  s_mov_b32 exec_hi, 0xffff
  s_add_u32 s64, s8, 229376
  s_add_u32 m0, s12, 130816
  s_nop 0
  buffer_load_dwordx4 v236, s[44:47], s64 offen sc1 lds
  s_add_u32 m0, s12, 131584
  s_nop 0
  buffer_load_dwordx4 v237, s[44:47], s64 offen sc1 lds
  s_add_u32 m0, s12, 132352
  s_nop 0
  buffer_load_dwordx4 v238, s[44:47], s64 offen sc1 lds
  s_mov_b32 exec_hi, -1
  buffer_load_dwordx4 v[220:223], v1, s[44:47], s11 offen sc1
  buffer_load_dwordx4 v[224:227], v1, s[44:47], s11 offen offset:1024 sc1
  buffer_load_dwordx4 v[228:231], v2, s[44:47], s11 offen offset:2048 sc1
  s_waitcnt vmcnt(20)
  s_add_u32 s10, s88, 98304
  s_add_u32 s11, s89, 55296
  v_mfma_f32_32x32x16_bf16 v[4:19], v[164:167], v[148:151], v[4:19]
  v_mfma_f32_32x32x16_bf16 v[20:35], v[168:171], v[148:151], v[20:35]
  v_mfma_f32_16x16x32_bf16 v[36:39], v[172:175], v[148:151], v[36:39]
  buffer_load_dwordx4 v[148:151], v232, s[44:47], s10 offen offset:0 sc1
  v_mfma_f32_32x32x16_bf16 v[40:55], v[164:167], v[152:155], v[40:55]
  v_mfma_f32_32x32x16_bf16 v[56:71], v[168:171], v[152:155], v[56:71]
  v_mfma_f32_16x16x32_bf16 v[72:75], v[172:175], v[152:155], v[72:75]
  buffer_load_dwordx4 v[152:155], v232, s[44:47], s10 offen offset:1024 sc1
  v_mfma_f32_32x32x16_bf16 v[76:91], v[164:167], v[156:159], v[76:91]
  v_mfma_f32_32x32x16_bf16 v[92:107], v[168:171], v[156:159], v[92:107]
  v_mfma_f32_16x16x32_bf16 v[108:111], v[172:175], v[156:159], v[108:111]
  buffer_load_dwordx4 v[156:159], v233, s[44:47], s10 offen offset:0 sc1
  v_mfma_f32_32x32x16_bf16 v[112:127], v[164:167], v[160:163], v[112:127]
  v_mfma_f32_32x32x16_bf16 v[128:143], v[168:171], v[160:163], v[128:143]
  v_mfma_f32_16x16x32_bf16 v[144:147], v[172:175], v[160:163], v[144:147]
  buffer_load_dwordx4 v[160:163], v233, s[44:47], s10 offen offset:1024 sc1
  s_mov_b32 exec_hi, 0xffff
  s_add_u32 s64, s8, 245760
  s_add_u32 m0, s12, 140160
  s_nop 0
  buffer_load_dwordx4 v236, s[44:47], s64 offen sc1 lds
  s_add_u32 m0, s12, 140928
  s_nop 0
  buffer_load_dwordx4 v237, s[44:47], s64 offen sc1 lds
  s_add_u32 m0, s12, 141696
  s_nop 0
  buffer_load_dwordx4 v238, s[44:47], s64 offen sc1 lds
  s_mov_b32 exec_hi, -1
  buffer_load_dwordx4 v[164:167], v1, s[44:47], s11 offen sc1
  buffer_load_dwordx4 v[168:171], v1, s[44:47], s11 offen offset:1024 sc1
  buffer_load_dwordx4 v[172:175], v2, s[44:47], s11 offen offset:2048 sc1
  s_waitcnt vmcnt(20)
  s_add_u32 s10, s88, 102400
  s_add_u32 s11, s89, 57600
  v_mfma_f32_32x32x16_bf16 v[4:19], v[192:195], v[176:179], v[4:19]
  v_mfma_f32_32x32x16_bf16 v[20:35], v[196:199], v[176:179], v[20:35]
  v_mfma_f32_16x16x32_bf16 v[36:39], v[200:203], v[176:179], v[36:39]
  buffer_load_dwordx4 v[176:179], v232, s[44:47], s10 offen offset:0 sc1
  v_mfma_f32_32x32x16_bf16 v[40:55], v[192:195], v[180:183], v[40:55]
  v_mfma_f32_32x32x16_bf16 v[56:71], v[196:199], v[180:183], v[56:71]
  v_mfma_f32_16x16x32_bf16 v[72:75], v[200:203], v[180:183], v[72:75]
  buffer_load_dwordx4 v[180:183], v232, s[44:47], s10 offen offset:1024 sc1
  v_mfma_f32_32x32x16_bf16 v[76:91], v[192:195], v[184:187], v[76:91]
  v_mfma_f32_32x32x16_bf16 v[92:107], v[196:199], v[184:187], v[92:107]
  v_mfma_f32_16x16x32_bf16 v[108:111], v[200:203], v[184:187], v[108:111]
  buffer_load_dwordx4 v[184:187], v233, s[44:47], s10 offen offset:0 sc1
  v_mfma_f32_32x32x16_bf16 v[112:127], v[192:195], v[188:191], v[112:127]
  v_mfma_f32_32x32x16_bf16 v[128:143], v[196:199], v[188:191], v[128:143]
  v_mfma_f32_16x16x32_bf16 v[144:147], v[200:203], v[188:191], v[144:147]
  buffer_load_dwordx4 v[188:191], v233, s[44:47], s10 offen offset:1024 sc1
  buffer_load_dwordx4 v[192:195], v1, s[44:47], s11 offen sc1
  buffer_load_dwordx4 v[196:199], v1, s[44:47], s11 offen offset:1024 sc1
  buffer_load_dwordx4 v[200:203], v2, s[44:47], s11 offen offset:2048 sc1
  s_waitcnt vmcnt(17)
  s_add_u32 s10, s88, 106496
  s_add_u32 s11, s89, 59904
  v_mfma_f32_32x32x16_bf16 v[4:19], v[220:223], v[204:207], v[4:19]
  v_mfma_f32_32x32x16_bf16 v[20:35], v[224:227], v[204:207], v[20:35]
  v_mfma_f32_16x16x32_bf16 v[36:39], v[228:231], v[204:207], v[36:39]
  buffer_load_dwordx4 v[204:207], v232, s[44:47], s10 offen offset:0 sc1
  v_mfma_f32_32x32x16_bf16 v[40:55], v[220:223], v[208:211], v[40:55]
  v_mfma_f32_32x32x16_bf16 v[56:71], v[224:227], v[208:211], v[56:71]
  v_mfma_f32_16x16x32_bf16 v[72:75], v[228:231], v[208:211], v[72:75]
  buffer_load_dwordx4 v[208:211], v232, s[44:47], s10 offen offset:1024 sc1
  v_mfma_f32_32x32x16_bf16 v[76:91], v[220:223], v[212:215], v[76:91]
  v_mfma_f32_32x32x16_bf16 v[92:107], v[224:227], v[212:215], v[92:107]
  v_mfma_f32_16x16x32_bf16 v[108:111], v[228:231], v[212:215], v[108:111]
  buffer_load_dwordx4 v[212:215], v233, s[44:47], s10 offen offset:0 sc1
  v_mfma_f32_32x32x16_bf16 v[112:127], v[220:223], v[216:219], v[112:127]
  v_mfma_f32_32x32x16_bf16 v[128:143], v[224:227], v[216:219], v[128:143]
  v_mfma_f32_16x16x32_bf16 v[144:147], v[228:231], v[216:219], v[144:147]
  buffer_load_dwordx4 v[216:219], v233, s[44:47], s10 offen offset:1024 sc1
  buffer_load_dwordx4 v[220:223], v1, s[44:47], s11 offen sc1
  buffer_load_dwordx4 v[224:227], v1, s[44:47], s11 offen offset:1024 sc1
  buffer_load_dwordx4 v[228:231], v2, s[44:47], s11 offen offset:2048 sc1
  s_waitcnt vmcnt(14)
  v_mov_b32 v244, 161804
  v_mov_b32 v245, 1
  s_mov_b64 exec, 1
  ds_add_u32 v244, v245
  s_mov_b64 exec, -1
  s_add_u32 s10, s88, 110592
  s_add_u32 s11, s89, 62208
  v_mfma_f32_32x32x16_bf16 v[4:19], v[164:167], v[148:151], v[4:19]
  v_mfma_f32_32x32x16_bf16 v[20:35], v[168:171], v[148:151], v[20:35]
  v_mfma_f32_16x16x32_bf16 v[36:39], v[172:175], v[148:151], v[36:39]
  buffer_load_dwordx4 v[148:151], v232, s[44:47], s10 offen offset:0 sc1
  v_mfma_f32_32x32x16_bf16 v[40:55], v[164:167], v[152:155], v[40:55]
  v_mfma_f32_32x32x16_bf16 v[56:71], v[168:171], v[152:155], v[56:71]
  v_mfma_f32_16x16x32_bf16 v[72:75], v[172:175], v[152:155], v[72:75]
  buffer_load_dwordx4 v[152:155], v232, s[44:47], s10 offen offset:1024 sc1
  v_mfma_f32_32x32x16_bf16 v[76:91], v[164:167], v[156:159], v[76:91]
  v_mfma_f32_32x32x16_bf16 v[92:107], v[168:171], v[156:159], v[92:107]
  v_mfma_f32_16x16x32_bf16 v[108:111], v[172:175], v[156:159], v[108:111]
  buffer_load_dwordx4 v[156:159], v233, s[44:47], s10 offen offset:0 sc1
  v_mfma_f32_32x32x16_bf16 v[112:127], v[164:167], v[160:163], v[112:127]
  v_mfma_f32_32x32x16_bf16 v[128:143], v[168:171], v[160:163], v[128:143]
  v_mfma_f32_16x16x32_bf16 v[144:147], v[172:175], v[160:163], v[144:147]
  buffer_load_dwordx4 v[160:163], v233, s[44:47], s10 offen offset:1024 sc1
  buffer_load_dwordx4 v[164:167], v1, s[44:47], s11 offen sc1
  buffer_load_dwordx4 v[168:171], v1, s[44:47], s11 offen offset:1024 sc1
  buffer_load_dwordx4 v[172:175], v2, s[44:47], s11 offen offset:2048 sc1
  s_waitcnt vmcnt(14)
  s_add_u32 s10, s88, 131072
  s_add_u32 s11, s89, 73728
  v_mfma_f32_32x32x16_bf16 v[4:19], v[192:195], v[176:179], v[4:19]
  v_mfma_f32_32x32x16_bf16 v[20:35], v[196:199], v[176:179], v[20:35]
  v_mfma_f32_16x16x32_bf16 v[36:39], v[200:203], v[176:179], v[36:39]
  buffer_load_dwordx4 v[176:179], v232, s[44:47], s10 offen offset:0 sc1
  v_mfma_f32_32x32x16_bf16 v[40:55], v[192:195], v[180:183], v[40:55]
  v_mfma_f32_32x32x16_bf16 v[56:71], v[196:199], v[180:183], v[56:71]
  v_mfma_f32_16x16x32_bf16 v[72:75], v[200:203], v[180:183], v[72:75]
  buffer_load_dwordx4 v[180:183], v232, s[44:47], s10 offen offset:1024 sc1
  v_mfma_f32_32x32x16_bf16 v[76:91], v[192:195], v[184:187], v[76:91]
  v_mfma_f32_32x32x16_bf16 v[92:107], v[196:199], v[184:187], v[92:107]
  v_mfma_f32_16x16x32_bf16 v[108:111], v[200:203], v[184:187], v[108:111]
  buffer_load_dwordx4 v[184:187], v233, s[44:47], s10 offen offset:0 sc1
  v_mfma_f32_32x32x16_bf16 v[112:127], v[192:195], v[188:191], v[112:127]
  v_mfma_f32_32x32x16_bf16 v[128:143], v[196:199], v[188:191], v[128:143]
  v_mfma_f32_16x16x32_bf16 v[144:147], v[200:203], v[188:191], v[144:147]
  buffer_load_dwordx4 v[188:191], v233, s[44:47], s10 offen offset:1024 sc1
  buffer_load_dwordx4 v[192:195], v1, s[44:47], s11 offen sc1
  buffer_load_dwordx4 v[196:199], v1, s[44:47], s11 offen offset:1024 sc1
  buffer_load_dwordx4 v[200:203], v2, s[44:47], s11 offen offset:2048 sc1
  s_waitcnt vmcnt(14)
  buffer_load_dword v253, v246, s[44:47], s99 offen offset:4 sc1
  s_add_u32 s10, s88, 135168
  s_add_u32 s11, s89, 76032
  v_mfma_f32_32x32x16_bf16 v[4:19], v[220:223], v[204:207], v[4:19]
  v_mfma_f32_32x32x16_bf16 v[20:35], v[224:227], v[204:207], v[20:35]
  v_mfma_f32_16x16x32_bf16 v[36:39], v[228:231], v[204:207], v[36:39]
  buffer_load_dwordx4 v[204:207], v232, s[44:47], s10 offen offset:0 sc1
  v_mfma_f32_32x32x16_bf16 v[40:55], v[220:223], v[208:211], v[40:55]
  v_mfma_f32_32x32x16_bf16 v[56:71], v[224:227], v[208:211], v[56:71]
  v_mfma_f32_16x16x32_bf16 v[72:75], v[228:231], v[208:211], v[72:75]
  buffer_load_dwordx4 v[208:211], v232, s[44:47], s10 offen offset:1024 sc1
  v_mfma_f32_32x32x16_bf16 v[76:91], v[220:223], v[212:215], v[76:91]
  v_mfma_f32_32x32x16_bf16 v[92:107], v[224:227], v[212:215], v[92:107]
  v_mfma_f32_16x16x32_bf16 v[108:111], v[228:231], v[212:215], v[108:111]
  buffer_load_dwordx4 v[212:215], v233, s[44:47], s10 offen offset:0 sc1
  v_mfma_f32_32x32x16_bf16 v[112:127], v[220:223], v[216:219], v[112:127]
  v_mfma_f32_32x32x16_bf16 v[128:143], v[224:227], v[216:219], v[128:143]
  v_mfma_f32_16x16x32_bf16 v[144:147], v[228:231], v[216:219], v[144:147]
  buffer_load_dwordx4 v[216:219], v233, s[44:47], s10 offen offset:1024 sc1
  buffer_load_dwordx4 v[220:223], v1, s[44:47], s11 offen sc1
  buffer_load_dwordx4 v[224:227], v1, s[44:47], s11 offen offset:1024 sc1
  buffer_load_dwordx4 v[228:231], v2, s[44:47], s11 offen offset:2048 sc1
  s_waitcnt vmcnt(15)
  s_add_u32 s10, s88, 139264
  s_add_u32 s11, s89, 78336
  v_mfma_f32_32x32x16_bf16 v[4:19], v[164:167], v[148:151], v[4:19]
  v_mfma_f32_32x32x16_bf16 v[20:35], v[168:171], v[148:151], v[20:35]
  v_mfma_f32_16x16x32_bf16 v[36:39], v[172:175], v[148:151], v[36:39]
  buffer_load_dwordx4 v[148:151], v232, s[44:47], s10 offen offset:0 sc1
  v_mfma_f32_32x32x16_bf16 v[40:55], v[164:167], v[152:155], v[40:55]
  v_mfma_f32_32x32x16_bf16 v[56:71], v[168:171], v[152:155], v[56:71]
  v_mfma_f32_16x16x32_bf16 v[72:75], v[172:175], v[152:155], v[72:75]
  buffer_load_dwordx4 v[152:155], v232, s[44:47], s10 offen offset:1024 sc1
  v_mfma_f32_32x32x16_bf16 v[76:91], v[164:167], v[156:159], v[76:91]
  v_mfma_f32_32x32x16_bf16 v[92:107], v[168:171], v[156:159], v[92:107]
  v_mfma_f32_16x16x32_bf16 v[108:111], v[172:175], v[156:159], v[108:111]
  buffer_load_dwordx4 v[156:159], v233, s[44:47], s10 offen offset:0 sc1
  v_mfma_f32_32x32x16_bf16 v[112:127], v[164:167], v[160:163], v[112:127]
  v_mfma_f32_32x32x16_bf16 v[128:143], v[168:171], v[160:163], v[128:143]
  v_mfma_f32_16x16x32_bf16 v[144:147], v[172:175], v[160:163], v[144:147]
  buffer_load_dwordx4 v[160:163], v233, s[44:47], s10 offen offset:1024 sc1
  buffer_load_dwordx4 v[164:167], v1, s[44:47], s11 offen sc1
  buffer_load_dwordx4 v[168:171], v1, s[44:47], s11 offen offset:1024 sc1
  buffer_load_dwordx4 v[172:175], v2, s[44:47], s11 offen offset:2048 sc1
  s_waitcnt vmcnt(15)
  s_add_u32 s10, s88, 143360
  s_add_u32 s11, s89, 80640
  v_mfma_f32_32x32x16_bf16 v[4:19], v[192:195], v[176:179], v[4:19]
  v_mfma_f32_32x32x16_bf16 v[20:35], v[196:199], v[176:179], v[20:35]
  v_mfma_f32_16x16x32_bf16 v[36:39], v[200:203], v[176:179], v[36:39]
  buffer_load_dwordx4 v[176:179], v232, s[44:47], s10 offen offset:0 sc1
  v_mfma_f32_32x32x16_bf16 v[40:55], v[192:195], v[180:183], v[40:55]
  v_mfma_f32_32x32x16_bf16 v[56:71], v[196:199], v[180:183], v[56:71]
  v_mfma_f32_16x16x32_bf16 v[72:75], v[200:203], v[180:183], v[72:75]
  buffer_load_dwordx4 v[180:183], v232, s[44:47], s10 offen offset:1024 sc1
  v_mfma_f32_32x32x16_bf16 v[76:91], v[192:195], v[184:187], v[76:91]
  v_mfma_f32_32x32x16_bf16 v[92:107], v[196:199], v[184:187], v[92:107]
  v_mfma_f32_16x16x32_bf16 v[108:111], v[200:203], v[184:187], v[108:111]
  buffer_load_dwordx4 v[184:187], v233, s[44:47], s10 offen offset:0 sc1
  v_mfma_f32_32x32x16_bf16 v[112:127], v[192:195], v[188:191], v[112:127]
  v_mfma_f32_32x32x16_bf16 v[128:143], v[196:199], v[188:191], v[128:143]
  v_mfma_f32_16x16x32_bf16 v[144:147], v[200:203], v[188:191], v[144:147]
  buffer_load_dwordx4 v[188:191], v233, s[44:47], s10 offen offset:1024 sc1
  buffer_load_dwordx4 v[192:195], v1, s[44:47], s11 offen sc1
  buffer_load_dwordx4 v[196:199], v1, s[44:47], s11 offen offset:1024 sc1
  buffer_load_dwordx4 v[200:203], v2, s[44:47], s11 offen offset:2048 sc1
  s_waitcnt vmcnt(14)
  v_cmp_ne_u32 vcc, s0, v253
  s_cbranch_vccz gated_mix__softmax_full_mha__geglu_ffn__prompt_kernel_c2ok
  s_mov_b32 s14, 0
gated_mix__softmax_full_mha__geglu_ffn__prompt_kernel_c2:
  buffer_load_dword v245, v246, s[44:47], s99 offen offset:4 sc1
  s_add_u32 s14, s14, 1
  s_waitcnt vmcnt(0)
  v_cmp_ne_u32 vcc, s0, v245
  s_and_b32 vcc_lo, vcc_lo, 1
  s_cbranch_scc0 gated_mix__softmax_full_mha__geglu_ffn__prompt_kernel_c2d
  s_cmp_ge_u32 s14, 0x8000
  s_cbranch_scc1 gated_mix__softmax_full_mha__geglu_ffn__prompt_kernel_c2d
  s_sleep 8
  s_branch gated_mix__softmax_full_mha__geglu_ffn__prompt_kernel_c2
gated_mix__softmax_full_mha__geglu_ffn__prompt_kernel_c2d:
gated_mix__softmax_full_mha__geglu_ffn__prompt_kernel_c2ok:
  v_mov_b32 v244, 161832
  v_mov_b32 v245, 1
  s_mov_b64 exec, 1
  ds_add_u32 v244, v245
  s_mov_b64 exec, -1
  s_lshl_b32 s9, s6, 1
  s_add_u32 s9, s9, s13
  s_lshl_b32 s63, s9, 8
  s_add_u32 s63, s63, 35594240
  s_lshr_b32 s65, s7, 1
  s_lshl_b32 s64, s65, 7
  s_add_u32 s64, s64, s63
  v_and_b32 v247, 31, v0
  v_lshlrev_b32 v247, 2, v247
  v_and_b32 v248, 15, v0
  v_lshrrev_b32 v249, 5, v0
  v_lshl_add_u32 v248, v249, 4, v248
  v_lshlrev_b32 v248, 2, v248
  buffer_load_dword v240, v247, s[44:47], s64 offen sc1
  buffer_load_dword v241, v248, s[44:47], s64 offen sc1
  s_add_u32 s10, s88, 16384
  s_add_u32 s11, s89, 9216
  v_mfma_f32_32x32x16_bf16 v[4:19], v[220:223], v[204:207], v[4:19]
  v_mfma_f32_32x32x16_bf16 v[20:35], v[224:227], v[204:207], v[20:35]
  v_mfma_f32_16x16x32_bf16 v[36:39], v[228:231], v[204:207], v[36:39]
  buffer_load_dwordx4 v[204:207], v232, s[44:47], s10 offen offset:0 sc1
  v_mfma_f32_32x32x16_bf16 v[40:55], v[220:223], v[208:211], v[40:55]
  v_mfma_f32_32x32x16_bf16 v[56:71], v[224:227], v[208:211], v[56:71]
  v_mfma_f32_16x16x32_bf16 v[72:75], v[228:231], v[208:211], v[72:75]
  buffer_load_dwordx4 v[208:211], v232, s[44:47], s10 offen offset:1024 sc1
  v_mfma_f32_32x32x16_bf16 v[76:91], v[220:223], v[212:215], v[76:91]
  v_mfma_f32_32x32x16_bf16 v[92:107], v[224:227], v[212:215], v[92:107]
  v_mfma_f32_16x16x32_bf16 v[108:111], v[228:231], v[212:215], v[108:111]
  buffer_load_dwordx4 v[212:215], v233, s[44:47], s10 offen offset:0 sc1
  v_mfma_f32_32x32x16_bf16 v[112:127], v[220:223], v[216:219], v[112:127]
  v_mfma_f32_32x32x16_bf16 v[128:143], v[224:227], v[216:219], v[128:143]
  v_mfma_f32_16x16x32_bf16 v[144:147], v[228:231], v[216:219], v[144:147]
  buffer_load_dwordx4 v[216:219], v233, s[44:47], s10 offen offset:1024 sc1
  buffer_load_dwordx4 v[220:223], v1, s[44:47], s11 offen sc1
  buffer_load_dwordx4 v[224:227], v1, s[44:47], s11 offen offset:1024 sc1
  buffer_load_dwordx4 v[228:231], v2, s[44:47], s11 offen offset:2048 sc1
  s_waitcnt vmcnt(16)
  s_add_u32 s10, s88, 20480
  s_add_u32 s11, s89, 11520
  v_mfma_f32_32x32x16_bf16 v[4:19], v[164:167], v[148:151], v[4:19]
  v_mfma_f32_32x32x16_bf16 v[20:35], v[168:171], v[148:151], v[20:35]
  v_mfma_f32_16x16x32_bf16 v[36:39], v[172:175], v[148:151], v[36:39]
  buffer_load_dwordx4 v[148:151], v232, s[44:47], s10 offen offset:0 sc1
  v_mfma_f32_32x32x16_bf16 v[40:55], v[164:167], v[152:155], v[40:55]
  v_mfma_f32_32x32x16_bf16 v[56:71], v[168:171], v[152:155], v[56:71]
  v_mfma_f32_16x16x32_bf16 v[72:75], v[172:175], v[152:155], v[72:75]
  buffer_load_dwordx4 v[152:155], v232, s[44:47], s10 offen offset:1024 sc1
  v_mfma_f32_32x32x16_bf16 v[76:91], v[164:167], v[156:159], v[76:91]
  v_mfma_f32_32x32x16_bf16 v[92:107], v[168:171], v[156:159], v[92:107]
  v_mfma_f32_16x16x32_bf16 v[108:111], v[172:175], v[156:159], v[108:111]
  buffer_load_dwordx4 v[156:159], v233, s[44:47], s10 offen offset:0 sc1
  v_mfma_f32_32x32x16_bf16 v[112:127], v[164:167], v[160:163], v[112:127]
  v_mfma_f32_32x32x16_bf16 v[128:143], v[168:171], v[160:163], v[128:143]
  v_mfma_f32_16x16x32_bf16 v[144:147], v[172:175], v[160:163], v[144:147]
  buffer_load_dwordx4 v[160:163], v233, s[44:47], s10 offen offset:1024 sc1
  buffer_load_dwordx4 v[164:167], v1, s[44:47], s11 offen sc1
  buffer_load_dwordx4 v[168:171], v1, s[44:47], s11 offen offset:1024 sc1
  buffer_load_dwordx4 v[172:175], v2, s[44:47], s11 offen offset:2048 sc1
  s_waitcnt vmcnt(16)
  s_add_u32 s10, s88, 24576
  s_add_u32 s11, s89, 13824
  v_mfma_f32_32x32x16_bf16 v[4:19], v[192:195], v[176:179], v[4:19]
  v_mfma_f32_32x32x16_bf16 v[20:35], v[196:199], v[176:179], v[20:35]
  v_mfma_f32_16x16x32_bf16 v[36:39], v[200:203], v[176:179], v[36:39]
  buffer_load_dwordx4 v[176:179], v232, s[44:47], s10 offen offset:0 sc1
  v_mfma_f32_32x32x16_bf16 v[40:55], v[192:195], v[180:183], v[40:55]
  v_mfma_f32_32x32x16_bf16 v[56:71], v[196:199], v[180:183], v[56:71]
  v_mfma_f32_16x16x32_bf16 v[72:75], v[200:203], v[180:183], v[72:75]
  buffer_load_dwordx4 v[180:183], v232, s[44:47], s10 offen offset:1024 sc1
  v_mfma_f32_32x32x16_bf16 v[76:91], v[192:195], v[184:187], v[76:91]
  v_mfma_f32_32x32x16_bf16 v[92:107], v[196:199], v[184:187], v[92:107]
  v_mfma_f32_16x16x32_bf16 v[108:111], v[200:203], v[184:187], v[108:111]
  buffer_load_dwordx4 v[184:187], v233, s[44:47], s10 offen offset:0 sc1
  v_mfma_f32_32x32x16_bf16 v[112:127], v[192:195], v[188:191], v[112:127]
  v_mfma_f32_32x32x16_bf16 v[128:143], v[196:199], v[188:191], v[128:143]
  v_mfma_f32_16x16x32_bf16 v[144:147], v[200:203], v[188:191], v[144:147]
  buffer_load_dwordx4 v[188:191], v233, s[44:47], s10 offen offset:1024 sc1
  buffer_load_dwordx4 v[192:195], v1, s[44:47], s11 offen sc1
  buffer_load_dwordx4 v[196:199], v1, s[44:47], s11 offen offset:1024 sc1
  buffer_load_dwordx4 v[200:203], v2, s[44:47], s11 offen offset:2048 sc1
  s_waitcnt vmcnt(14)
  s_add_u32 s10, s88, 28672
  s_add_u32 s11, s89, 16128
  v_mfma_f32_32x32x16_bf16 v[4:19], v[220:223], v[204:207], v[4:19]
  v_mfma_f32_32x32x16_bf16 v[20:35], v[224:227], v[204:207], v[20:35]
  v_mfma_f32_16x16x32_bf16 v[36:39], v[228:231], v[204:207], v[36:39]
  buffer_load_dwordx4 v[204:207], v232, s[44:47], s10 offen offset:0 sc1
  v_mfma_f32_32x32x16_bf16 v[40:55], v[220:223], v[208:211], v[40:55]
  v_mfma_f32_32x32x16_bf16 v[56:71], v[224:227], v[208:211], v[56:71]
  v_mfma_f32_16x16x32_bf16 v[72:75], v[228:231], v[208:211], v[72:75]
  buffer_load_dwordx4 v[208:211], v232, s[44:47], s10 offen offset:1024 sc1
  v_mfma_f32_32x32x16_bf16 v[76:91], v[220:223], v[212:215], v[76:91]
  v_mfma_f32_32x32x16_bf16 v[92:107], v[224:227], v[212:215], v[92:107]
  v_mfma_f32_16x16x32_bf16 v[108:111], v[228:231], v[212:215], v[108:111]
  buffer_load_dwordx4 v[212:215], v233, s[44:47], s10 offen offset:0 sc1
  v_mfma_f32_32x32x16_bf16 v[112:127], v[220:223], v[216:219], v[112:127]
  v_mfma_f32_32x32x16_bf16 v[128:143], v[224:227], v[216:219], v[128:143]
  v_mfma_f32_16x16x32_bf16 v[144:147], v[228:231], v[216:219], v[144:147]
  buffer_load_dwordx4 v[216:219], v233, s[44:47], s10 offen offset:1024 sc1
  buffer_load_dwordx4 v[220:223], v1, s[44:47], s11 offen sc1
  buffer_load_dwordx4 v[224:227], v1, s[44:47], s11 offen offset:1024 sc1
  buffer_load_dwordx4 v[228:231], v2, s[44:47], s11 offen offset:2048 sc1
  s_waitcnt vmcnt(14)
  s_add_u32 s10, s88, 49152
  s_add_u32 s11, s89, 27648
  v_mfma_f32_32x32x16_bf16 v[4:19], v[164:167], v[148:151], v[4:19]
  v_mfma_f32_32x32x16_bf16 v[20:35], v[168:171], v[148:151], v[20:35]
  v_mfma_f32_16x16x32_bf16 v[36:39], v[172:175], v[148:151], v[36:39]
  buffer_load_dwordx4 v[148:151], v232, s[44:47], s10 offen offset:0 sc1
  v_mfma_f32_32x32x16_bf16 v[40:55], v[164:167], v[152:155], v[40:55]
  v_mfma_f32_32x32x16_bf16 v[56:71], v[168:171], v[152:155], v[56:71]
  v_mfma_f32_16x16x32_bf16 v[72:75], v[172:175], v[152:155], v[72:75]
  buffer_load_dwordx4 v[152:155], v232, s[44:47], s10 offen offset:1024 sc1
  v_mfma_f32_32x32x16_bf16 v[76:91], v[164:167], v[156:159], v[76:91]
  v_mfma_f32_32x32x16_bf16 v[92:107], v[168:171], v[156:159], v[92:107]
  v_mfma_f32_16x16x32_bf16 v[108:111], v[172:175], v[156:159], v[108:111]
  buffer_load_dwordx4 v[156:159], v233, s[44:47], s10 offen offset:0 sc1
  v_mfma_f32_32x32x16_bf16 v[112:127], v[164:167], v[160:163], v[112:127]
  v_mfma_f32_32x32x16_bf16 v[128:143], v[168:171], v[160:163], v[128:143]
  v_mfma_f32_16x16x32_bf16 v[144:147], v[172:175], v[160:163], v[144:147]
  buffer_load_dwordx4 v[160:163], v233, s[44:47], s10 offen offset:1024 sc1
  buffer_load_dwordx4 v[164:167], v1, s[44:47], s11 offen sc1
  buffer_load_dwordx4 v[168:171], v1, s[44:47], s11 offen offset:1024 sc1
  buffer_load_dwordx4 v[172:175], v2, s[44:47], s11 offen offset:2048 sc1
  s_waitcnt vmcnt(14)
  s_add_u32 s10, s88, 53248
  s_add_u32 s11, s89, 29952
  v_mfma_f32_32x32x16_bf16 v[4:19], v[192:195], v[176:179], v[4:19]
  v_mfma_f32_32x32x16_bf16 v[20:35], v[196:199], v[176:179], v[20:35]
  v_mfma_f32_16x16x32_bf16 v[36:39], v[200:203], v[176:179], v[36:39]
  buffer_load_dwordx4 v[176:179], v232, s[44:47], s10 offen offset:0 sc1
  v_mfma_f32_32x32x16_bf16 v[40:55], v[192:195], v[180:183], v[40:55]
  v_mfma_f32_32x32x16_bf16 v[56:71], v[196:199], v[180:183], v[56:71]
  v_mfma_f32_16x16x32_bf16 v[72:75], v[200:203], v[180:183], v[72:75]
  buffer_load_dwordx4 v[180:183], v232, s[44:47], s10 offen offset:1024 sc1
  v_mfma_f32_32x32x16_bf16 v[76:91], v[192:195], v[184:187], v[76:91]
  v_mfma_f32_32x32x16_bf16 v[92:107], v[196:199], v[184:187], v[92:107]
  v_mfma_f32_16x16x32_bf16 v[108:111], v[200:203], v[184:187], v[108:111]
  buffer_load_dwordx4 v[184:187], v233, s[44:47], s10 offen offset:0 sc1
  v_mfma_f32_32x32x16_bf16 v[112:127], v[192:195], v[188:191], v[112:127]
  v_mfma_f32_32x32x16_bf16 v[128:143], v[196:199], v[188:191], v[128:143]
  v_mfma_f32_16x16x32_bf16 v[144:147], v[200:203], v[188:191], v[144:147]
  buffer_load_dwordx4 v[188:191], v233, s[44:47], s10 offen offset:1024 sc1
  buffer_load_dwordx4 v[192:195], v1, s[44:47], s11 offen sc1
  buffer_load_dwordx4 v[196:199], v1, s[44:47], s11 offen offset:1024 sc1
  buffer_load_dwordx4 v[200:203], v2, s[44:47], s11 offen offset:2048 sc1
  s_waitcnt vmcnt(14)
  s_add_u32 s10, s88, 57344
  s_add_u32 s11, s89, 32256
  v_mfma_f32_32x32x16_bf16 v[4:19], v[220:223], v[204:207], v[4:19]
  v_mfma_f32_32x32x16_bf16 v[20:35], v[224:227], v[204:207], v[20:35]
  v_mfma_f32_16x16x32_bf16 v[36:39], v[228:231], v[204:207], v[36:39]
  buffer_load_dwordx4 v[204:207], v232, s[44:47], s10 offen offset:0 sc1
  v_mfma_f32_32x32x16_bf16 v[40:55], v[220:223], v[208:211], v[40:55]
  v_mfma_f32_32x32x16_bf16 v[56:71], v[224:227], v[208:211], v[56:71]
  v_mfma_f32_16x16x32_bf16 v[72:75], v[228:231], v[208:211], v[72:75]
  buffer_load_dwordx4 v[208:211], v232, s[44:47], s10 offen offset:1024 sc1
  v_mfma_f32_32x32x16_bf16 v[76:91], v[220:223], v[212:215], v[76:91]
  v_mfma_f32_32x32x16_bf16 v[92:107], v[224:227], v[212:215], v[92:107]
  v_mfma_f32_16x16x32_bf16 v[108:111], v[228:231], v[212:215], v[108:111]
  buffer_load_dwordx4 v[212:215], v233, s[44:47], s10 offen offset:0 sc1
  v_mfma_f32_32x32x16_bf16 v[112:127], v[220:223], v[216:219], v[112:127]
  v_mfma_f32_32x32x16_bf16 v[128:143], v[224:227], v[216:219], v[128:143]
  v_mfma_f32_16x16x32_bf16 v[144:147], v[228:231], v[216:219], v[144:147]
  buffer_load_dwordx4 v[216:219], v233, s[44:47], s10 offen offset:1024 sc1
  buffer_load_dwordx4 v[220:223], v1, s[44:47], s11 offen sc1
  buffer_load_dwordx4 v[224:227], v1, s[44:47], s11 offen offset:1024 sc1
  buffer_load_dwordx4 v[228:231], v2, s[44:47], s11 offen offset:2048 sc1
  s_waitcnt vmcnt(14)
  s_add_u32 s10, s88, 61440
  s_add_u32 s11, s89, 34560
  v_mfma_f32_32x32x16_bf16 v[4:19], v[164:167], v[148:151], v[4:19]
  v_mfma_f32_32x32x16_bf16 v[20:35], v[168:171], v[148:151], v[20:35]
  v_mfma_f32_16x16x32_bf16 v[36:39], v[172:175], v[148:151], v[36:39]
  buffer_load_dwordx4 v[148:151], v232, s[44:47], s10 offen offset:0 sc1
  v_mfma_f32_32x32x16_bf16 v[40:55], v[164:167], v[152:155], v[40:55]
  v_mfma_f32_32x32x16_bf16 v[56:71], v[168:171], v[152:155], v[56:71]
  v_mfma_f32_16x16x32_bf16 v[72:75], v[172:175], v[152:155], v[72:75]
  buffer_load_dwordx4 v[152:155], v232, s[44:47], s10 offen offset:1024 sc1
  v_mfma_f32_32x32x16_bf16 v[76:91], v[164:167], v[156:159], v[76:91]
  v_mfma_f32_32x32x16_bf16 v[92:107], v[168:171], v[156:159], v[92:107]
  v_mfma_f32_16x16x32_bf16 v[108:111], v[172:175], v[156:159], v[108:111]
  buffer_load_dwordx4 v[156:159], v233, s[44:47], s10 offen offset:0 sc1
  v_mfma_f32_32x32x16_bf16 v[112:127], v[164:167], v[160:163], v[112:127]
  v_mfma_f32_32x32x16_bf16 v[128:143], v[168:171], v[160:163], v[128:143]
  v_mfma_f32_16x16x32_bf16 v[144:147], v[172:175], v[160:163], v[144:147]
  buffer_load_dwordx4 v[160:163], v233, s[44:47], s10 offen offset:1024 sc1
  buffer_load_dwordx4 v[164:167], v1, s[44:47], s11 offen sc1
  buffer_load_dwordx4 v[168:171], v1, s[44:47], s11 offen offset:1024 sc1
  buffer_load_dwordx4 v[172:175], v2, s[44:47], s11 offen offset:2048 sc1
  s_waitcnt vmcnt(14)
  s_add_u32 s10, s88, 81920
  s_add_u32 s11, s89, 46080
  v_mfma_f32_32x32x16_bf16 v[4:19], v[192:195], v[176:179], v[4:19]
  v_mfma_f32_32x32x16_bf16 v[20:35], v[196:199], v[176:179], v[20:35]
  v_mfma_f32_16x16x32_bf16 v[36:39], v[200:203], v[176:179], v[36:39]
  buffer_load_dwordx4 v[176:179], v232, s[44:47], s10 offen offset:0 sc1
  v_mfma_f32_32x32x16_bf16 v[40:55], v[192:195], v[180:183], v[40:55]
  v_mfma_f32_32x32x16_bf16 v[56:71], v[196:199], v[180:183], v[56:71]
  v_mfma_f32_16x16x32_bf16 v[72:75], v[200:203], v[180:183], v[72:75]
  buffer_load_dwordx4 v[180:183], v232, s[44:47], s10 offen offset:1024 sc1
  v_mfma_f32_32x32x16_bf16 v[76:91], v[192:195], v[184:187], v[76:91]
  v_mfma_f32_32x32x16_bf16 v[92:107], v[196:199], v[184:187], v[92:107]
  v_mfma_f32_16x16x32_bf16 v[108:111], v[200:203], v[184:187], v[108:111]
  buffer_load_dwordx4 v[184:187], v233, s[44:47], s10 offen offset:0 sc1
  v_mfma_f32_32x32x16_bf16 v[112:127], v[192:195], v[188:191], v[112:127]
  v_mfma_f32_32x32x16_bf16 v[128:143], v[196:199], v[188:191], v[128:143]
  v_mfma_f32_16x16x32_bf16 v[144:147], v[200:203], v[188:191], v[144:147]
  buffer_load_dwordx4 v[188:191], v233, s[44:47], s10 offen offset:1024 sc1
  buffer_load_dwordx4 v[192:195], v1, s[44:47], s11 offen sc1
  buffer_load_dwordx4 v[196:199], v1, s[44:47], s11 offen offset:1024 sc1
  buffer_load_dwordx4 v[200:203], v2, s[44:47], s11 offen offset:2048 sc1
  s_waitcnt vmcnt(14)
  s_add_u32 s10, s88, 86016
  s_add_u32 s11, s89, 48384
  v_mfma_f32_32x32x16_bf16 v[4:19], v[220:223], v[204:207], v[4:19]
  v_mfma_f32_32x32x16_bf16 v[20:35], v[224:227], v[204:207], v[20:35]
  v_mfma_f32_16x16x32_bf16 v[36:39], v[228:231], v[204:207], v[36:39]
  buffer_load_dwordx4 v[204:207], v232, s[44:47], s10 offen offset:0 sc1
  v_mfma_f32_32x32x16_bf16 v[40:55], v[220:223], v[208:211], v[40:55]
  v_mfma_f32_32x32x16_bf16 v[56:71], v[224:227], v[208:211], v[56:71]
  v_mfma_f32_16x16x32_bf16 v[72:75], v[228:231], v[208:211], v[72:75]
  buffer_load_dwordx4 v[208:211], v232, s[44:47], s10 offen offset:1024 sc1
  v_mfma_f32_32x32x16_bf16 v[76:91], v[220:223], v[212:215], v[76:91]
  v_mfma_f32_32x32x16_bf16 v[92:107], v[224:227], v[212:215], v[92:107]
  v_mfma_f32_16x16x32_bf16 v[108:111], v[228:231], v[212:215], v[108:111]
  buffer_load_dwordx4 v[212:215], v233, s[44:47], s10 offen offset:0 sc1
  v_mfma_f32_32x32x16_bf16 v[112:127], v[220:223], v[216:219], v[112:127]
  v_mfma_f32_32x32x16_bf16 v[128:143], v[224:227], v[216:219], v[128:143]
  v_mfma_f32_16x16x32_bf16 v[144:147], v[228:231], v[216:219], v[144:147]
  buffer_load_dwordx4 v[216:219], v233, s[44:47], s10 offen offset:1024 sc1
  buffer_load_dwordx4 v[220:223], v1, s[44:47], s11 offen sc1
  buffer_load_dwordx4 v[224:227], v1, s[44:47], s11 offen offset:1024 sc1
  buffer_load_dwordx4 v[228:231], v2, s[44:47], s11 offen offset:2048 sc1
  s_waitcnt vmcnt(14)
  s_add_u32 s10, s88, 90112
  s_add_u32 s11, s89, 50688
  v_mfma_f32_32x32x16_bf16 v[4:19], v[164:167], v[148:151], v[4:19]
  v_mfma_f32_32x32x16_bf16 v[20:35], v[168:171], v[148:151], v[20:35]
  v_mfma_f32_16x16x32_bf16 v[36:39], v[172:175], v[148:151], v[36:39]
  buffer_load_dwordx4 v[148:151], v232, s[44:47], s10 offen offset:0 sc1
  v_mfma_f32_32x32x16_bf16 v[40:55], v[164:167], v[152:155], v[40:55]
  v_mfma_f32_32x32x16_bf16 v[56:71], v[168:171], v[152:155], v[56:71]
  v_mfma_f32_16x16x32_bf16 v[72:75], v[172:175], v[152:155], v[72:75]
  buffer_load_dwordx4 v[152:155], v232, s[44:47], s10 offen offset:1024 sc1
  v_mfma_f32_32x32x16_bf16 v[76:91], v[164:167], v[156:159], v[76:91]
  v_mfma_f32_32x32x16_bf16 v[92:107], v[168:171], v[156:159], v[92:107]
  v_mfma_f32_16x16x32_bf16 v[108:111], v[172:175], v[156:159], v[108:111]
  buffer_load_dwordx4 v[156:159], v233, s[44:47], s10 offen offset:0 sc1
  v_mfma_f32_32x32x16_bf16 v[112:127], v[164:167], v[160:163], v[112:127]
  v_mfma_f32_32x32x16_bf16 v[128:143], v[168:171], v[160:163], v[128:143]
  v_mfma_f32_16x16x32_bf16 v[144:147], v[172:175], v[160:163], v[144:147]
  buffer_load_dwordx4 v[160:163], v233, s[44:47], s10 offen offset:1024 sc1
  buffer_load_dwordx4 v[164:167], v1, s[44:47], s11 offen sc1
  buffer_load_dwordx4 v[168:171], v1, s[44:47], s11 offen offset:1024 sc1
  buffer_load_dwordx4 v[172:175], v2, s[44:47], s11 offen offset:2048 sc1
  s_waitcnt vmcnt(14)
  v_add_f32 v240, 1.0, v240
  v_add_f32 v241, 1.0, v241
  v_rcp_f32 v240, v240
  v_rcp_f32 v241, v241
  v_and_b32 v254, 7, v0
  v_mul_u32_u24 v254, 2304, v254
  v_mul_u32_u24 v250, 9216, v249
  v_add_u32 v250, v250, v247
  v_mul_u32_u24 v251, 288, v247
  v_lshl_add_u32 v251, v249, 5, v251
  v_mul_u32_u24 v252, 288, v248
  v_bfe_u32 v253, v0, 4, 1
  v_lshl_add_u32 v252, v253, 3, v252
  s_mul_i32 s63, s7, 18432
  v_add_u32 v247, s63, v1
  s_lshr_b32 s64, s7, 1
  s_mul_i32 s63, s64, 9216
  s_add_u32 s63, s63, 73728
  v_add_u32 v248, s63, v1
  s_and_b32 s65, s7, 1
  s_lshl_b32 s63, s65, 12
  v_add_u32 v249, s63, v248
  s_lshl_b32 s63, s7, 3
  s_lshl_b32 s15, s9, 5
  s_add_u32 s15, s15, s63
  s_mul_i32 s15, s15, 2304
  s_add_u32 s15, s15, 33234944
  s_mul_i32 s8, s5, 36
  s_add_u32 s12, s8, s7
  s_mul_i32 s12, s12, 2304
  s_add_u32 s12, s12, 24256512
  s_add_u32 s8, s8, s63
  s_mul_i32 s8, s8, 2304
  s_add_u32 s8, s8, 24182784
  s_lshl_b32 s63, s9, 1
  s_add_u32 s63, s63, s64
  s_mul_i32 s16, s63, 36864
  s_mul_i32 s63, s5, 144
  s_add_u32 s16, s16, s63
  s_lshl_b32 s63, s65, 6
  s_add_u32 s17, s16, s63
  s_lshl_b32 s4, s2, 2
  s_add_u32 s4, s4, s7
  s_xor_b32 s63, s4, 4
  s_lshl_b32 s18, s63, 5
  s_add_u32 s18, s18, 45056000
  s_mul_i32 s4, s63, 5120
  s_add_u32 s4, s4, 35602432
  s_add_u32 s10, s88, 94208
  s_add_u32 s11, s89, 52992
  v_mfma_f32_32x32x16_bf16 v[4:19], v[192:195], v[176:179], v[4:19]
  v_mfma_f32_32x32x16_bf16 v[20:35], v[196:199], v[176:179], v[20:35]
  v_mfma_f32_16x16x32_bf16 v[36:39], v[200:203], v[176:179], v[36:39]
  buffer_load_dwordx4 v[176:179], v232, s[44:47], s10 offen offset:0 sc1
  v_mfma_f32_32x32x16_bf16 v[40:55], v[192:195], v[180:183], v[40:55]
  v_mfma_f32_32x32x16_bf16 v[56:71], v[196:199], v[180:183], v[56:71]
  v_mfma_f32_16x16x32_bf16 v[72:75], v[200:203], v[180:183], v[72:75]
  buffer_load_dwordx4 v[180:183], v232, s[44:47], s10 offen offset:1024 sc1
  v_mfma_f32_32x32x16_bf16 v[76:91], v[192:195], v[184:187], v[76:91]
  v_mfma_f32_32x32x16_bf16 v[92:107], v[196:199], v[184:187], v[92:107]
  v_mfma_f32_16x16x32_bf16 v[108:111], v[200:203], v[184:187], v[108:111]
  buffer_load_dwordx4 v[184:187], v233, s[44:47], s10 offen offset:0 sc1
  v_mfma_f32_32x32x16_bf16 v[112:127], v[192:195], v[188:191], v[112:127]
  v_mfma_f32_32x32x16_bf16 v[128:143], v[196:199], v[188:191], v[128:143]
  v_mfma_f32_16x16x32_bf16 v[144:147], v[200:203], v[188:191], v[144:147]
  buffer_load_dwordx4 v[188:191], v233, s[44:47], s10 offen offset:1024 sc1
  buffer_load_dwordx4 v[192:195], v1, s[44:47], s11 offen sc1
  buffer_load_dwordx4 v[196:199], v1, s[44:47], s11 offen offset:1024 sc1
  buffer_load_dwordx4 v[200:203], v2, s[44:47], s11 offen offset:2048 sc1
  s_waitcnt vmcnt(14)
  s_add_u32 s10, s88, 114688
  s_add_u32 s11, s89, 64512
  v_mfma_f32_32x32x16_bf16 v[4:19], v[220:223], v[204:207], v[4:19]
  v_mfma_f32_32x32x16_bf16 v[20:35], v[224:227], v[204:207], v[20:35]
  v_mfma_f32_16x16x32_bf16 v[36:39], v[228:231], v[204:207], v[36:39]
  buffer_load_dwordx4 v[204:207], v232, s[44:47], s10 offen offset:0 sc1
  v_mfma_f32_32x32x16_bf16 v[40:55], v[220:223], v[208:211], v[40:55]
  v_mfma_f32_32x32x16_bf16 v[56:71], v[224:227], v[208:211], v[56:71]
  v_mfma_f32_16x16x32_bf16 v[72:75], v[228:231], v[208:211], v[72:75]
  buffer_load_dwordx4 v[208:211], v232, s[44:47], s10 offen offset:1024 sc1
  v_mfma_f32_32x32x16_bf16 v[76:91], v[220:223], v[212:215], v[76:91]
  v_mfma_f32_32x32x16_bf16 v[92:107], v[224:227], v[212:215], v[92:107]
  v_mfma_f32_16x16x32_bf16 v[108:111], v[228:231], v[212:215], v[108:111]
  buffer_load_dwordx4 v[212:215], v233, s[44:47], s10 offen offset:0 sc1
  v_mfma_f32_32x32x16_bf16 v[112:127], v[220:223], v[216:219], v[112:127]
  v_mfma_f32_32x32x16_bf16 v[128:143], v[224:227], v[216:219], v[128:143]
  v_mfma_f32_16x16x32_bf16 v[144:147], v[228:231], v[216:219], v[144:147]
  buffer_load_dwordx4 v[216:219], v233, s[44:47], s10 offen offset:1024 sc1
  buffer_load_dwordx4 v[220:223], v1, s[44:47], s11 offen sc1
  buffer_load_dwordx4 v[224:227], v1, s[44:47], s11 offen offset:1024 sc1
  buffer_load_dwordx4 v[228:231], v2, s[44:47], s11 offen offset:2048 sc1
  s_waitcnt vmcnt(14)
  s_add_u32 s10, s88, 118784
  s_add_u32 s11, s89, 66816
  v_mfma_f32_32x32x16_bf16 v[4:19], v[164:167], v[148:151], v[4:19]
  v_mfma_f32_32x32x16_bf16 v[20:35], v[168:171], v[148:151], v[20:35]
  v_mfma_f32_16x16x32_bf16 v[36:39], v[172:175], v[148:151], v[36:39]
  buffer_load_dwordx4 v[148:151], v232, s[44:47], s10 offen offset:0 sc1
  v_mfma_f32_32x32x16_bf16 v[40:55], v[164:167], v[152:155], v[40:55]
  v_mfma_f32_32x32x16_bf16 v[56:71], v[168:171], v[152:155], v[56:71]
  v_mfma_f32_16x16x32_bf16 v[72:75], v[172:175], v[152:155], v[72:75]
  buffer_load_dwordx4 v[152:155], v232, s[44:47], s10 offen offset:1024 sc1
  v_mfma_f32_32x32x16_bf16 v[76:91], v[164:167], v[156:159], v[76:91]
  v_mfma_f32_32x32x16_bf16 v[92:107], v[168:171], v[156:159], v[92:107]
  v_mfma_f32_16x16x32_bf16 v[108:111], v[172:175], v[156:159], v[108:111]
  buffer_load_dwordx4 v[156:159], v233, s[44:47], s10 offen offset:0 sc1
  v_mfma_f32_32x32x16_bf16 v[112:127], v[164:167], v[160:163], v[112:127]
  v_mfma_f32_32x32x16_bf16 v[128:143], v[168:171], v[160:163], v[128:143]
  v_mfma_f32_16x16x32_bf16 v[144:147], v[172:175], v[160:163], v[144:147]
  buffer_load_dwordx4 v[160:163], v233, s[44:47], s10 offen offset:1024 sc1
  buffer_load_dwordx4 v[164:167], v1, s[44:47], s11 offen sc1
  buffer_load_dwordx4 v[168:171], v1, s[44:47], s11 offen offset:1024 sc1
  buffer_load_dwordx4 v[172:175], v2, s[44:47], s11 offen offset:2048 sc1
  s_waitcnt vmcnt(14)
  s_add_u32 s10, s88, 122880
  s_add_u32 s11, s89, 69120
  v_mfma_f32_32x32x16_bf16 v[4:19], v[192:195], v[176:179], v[4:19]
  v_mfma_f32_32x32x16_bf16 v[20:35], v[196:199], v[176:179], v[20:35]
  v_mfma_f32_16x16x32_bf16 v[36:39], v[200:203], v[176:179], v[36:39]
  buffer_load_dwordx4 v[176:179], v232, s[44:47], s10 offen offset:0 sc1
  v_mfma_f32_32x32x16_bf16 v[40:55], v[192:195], v[180:183], v[40:55]
  v_mfma_f32_32x32x16_bf16 v[56:71], v[196:199], v[180:183], v[56:71]
  v_mfma_f32_16x16x32_bf16 v[72:75], v[200:203], v[180:183], v[72:75]
  buffer_load_dwordx4 v[180:183], v232, s[44:47], s10 offen offset:1024 sc1
  v_mfma_f32_32x32x16_bf16 v[76:91], v[192:195], v[184:187], v[76:91]
  v_mfma_f32_32x32x16_bf16 v[92:107], v[196:199], v[184:187], v[92:107]
  v_mfma_f32_16x16x32_bf16 v[108:111], v[200:203], v[184:187], v[108:111]
  buffer_load_dwordx4 v[184:187], v233, s[44:47], s10 offen offset:0 sc1
  v_mfma_f32_32x32x16_bf16 v[112:127], v[192:195], v[188:191], v[112:127]
  v_mfma_f32_32x32x16_bf16 v[128:143], v[196:199], v[188:191], v[128:143]
  v_mfma_f32_16x16x32_bf16 v[144:147], v[200:203], v[188:191], v[144:147]
  buffer_load_dwordx4 v[188:191], v233, s[44:47], s10 offen offset:1024 sc1
  buffer_load_dwordx4 v[192:195], v1, s[44:47], s11 offen sc1
  buffer_load_dwordx4 v[196:199], v1, s[44:47], s11 offen offset:1024 sc1
  buffer_load_dwordx4 v[200:203], v2, s[44:47], s11 offen offset:2048 sc1
  s_waitcnt vmcnt(14)
  s_add_u32 s10, s88, 126976
  s_add_u32 s11, s89, 71424
  v_mfma_f32_32x32x16_bf16 v[4:19], v[220:223], v[204:207], v[4:19]
  v_mfma_f32_32x32x16_bf16 v[20:35], v[224:227], v[204:207], v[20:35]
  v_mfma_f32_16x16x32_bf16 v[36:39], v[228:231], v[204:207], v[36:39]
  buffer_load_dwordx4 v[204:207], v232, s[44:47], s10 offen offset:0 sc1
  v_mfma_f32_32x32x16_bf16 v[40:55], v[220:223], v[208:211], v[40:55]
  v_mfma_f32_32x32x16_bf16 v[56:71], v[224:227], v[208:211], v[56:71]
  v_mfma_f32_16x16x32_bf16 v[72:75], v[228:231], v[208:211], v[72:75]
  buffer_load_dwordx4 v[208:211], v232, s[44:47], s10 offen offset:1024 sc1
  v_mfma_f32_32x32x16_bf16 v[76:91], v[220:223], v[212:215], v[76:91]
  v_mfma_f32_32x32x16_bf16 v[92:107], v[224:227], v[212:215], v[92:107]
  v_mfma_f32_16x16x32_bf16 v[108:111], v[228:231], v[212:215], v[108:111]
  buffer_load_dwordx4 v[212:215], v233, s[44:47], s10 offen offset:0 sc1
  v_mfma_f32_32x32x16_bf16 v[112:127], v[220:223], v[216:219], v[112:127]
  v_mfma_f32_32x32x16_bf16 v[128:143], v[224:227], v[216:219], v[128:143]
  v_mfma_f32_16x16x32_bf16 v[144:147], v[228:231], v[216:219], v[144:147]
  buffer_load_dwordx4 v[216:219], v233, s[44:47], s10 offen offset:1024 sc1
  buffer_load_dwordx4 v[220:223], v1, s[44:47], s11 offen sc1
  buffer_load_dwordx4 v[224:227], v1, s[44:47], s11 offen offset:1024 sc1
  buffer_load_dwordx4 v[228:231], v2, s[44:47], s11 offen offset:2048 sc1
  s_waitcnt vmcnt(14)
  v_mfma_f32_32x32x16_bf16 v[4:19], v[164:167], v[148:151], v[4:19]
  v_mfma_f32_32x32x16_bf16 v[20:35], v[168:171], v[148:151], v[20:35]
  v_mfma_f32_16x16x32_bf16 v[36:39], v[172:175], v[148:151], v[36:39]
  v_mfma_f32_32x32x16_bf16 v[40:55], v[164:167], v[152:155], v[40:55]
  v_mfma_f32_32x32x16_bf16 v[56:71], v[168:171], v[152:155], v[56:71]
  v_mfma_f32_16x16x32_bf16 v[72:75], v[172:175], v[152:155], v[72:75]
  v_mfma_f32_32x32x16_bf16 v[76:91], v[164:167], v[156:159], v[76:91]
  v_mfma_f32_32x32x16_bf16 v[92:107], v[168:171], v[156:159], v[92:107]
  v_mfma_f32_16x16x32_bf16 v[108:111], v[172:175], v[156:159], v[108:111]
  v_mfma_f32_32x32x16_bf16 v[112:127], v[164:167], v[160:163], v[112:127]
  v_mfma_f32_32x32x16_bf16 v[128:143], v[168:171], v[160:163], v[128:143]
  v_mfma_f32_16x16x32_bf16 v[144:147], v[172:175], v[160:163], v[144:147]
  s_add_u32 s11, s8, 0
  buffer_load_dwordx4 v[148:151], v1, s[44:47], s11 offen sc1
  buffer_load_dwordx4 v[152:155], v1, s[44:47], s11 offen offset:1024 sc1
  buffer_load_dwordx4 v[156:159], v2, s[44:47], s11 offen offset:2048 sc1
  s_add_u32 s11, s8, 2304
  buffer_load_dwordx4 v[160:163], v1, s[44:47], s11 offen sc1
  buffer_load_dwordx4 v[164:167], v1, s[44:47], s11 offen offset:1024 sc1
  buffer_load_dwordx4 v[168:171], v2, s[44:47], s11 offen offset:2048 sc1
  s_waitcnt vmcnt(13)
  v_mfma_f32_32x32x16_bf16 v[4:19], v[192:195], v[176:179], v[4:19]
  v_mfma_f32_32x32x16_bf16 v[20:35], v[196:199], v[176:179], v[20:35]
  v_mfma_f32_16x16x32_bf16 v[36:39], v[200:203], v[176:179], v[36:39]
  v_mfma_f32_32x32x16_bf16 v[40:55], v[192:195], v[180:183], v[40:55]
  v_mfma_f32_32x32x16_bf16 v[56:71], v[196:199], v[180:183], v[56:71]
  v_mfma_f32_16x16x32_bf16 v[72:75], v[200:203], v[180:183], v[72:75]
  v_mfma_f32_32x32x16_bf16 v[76:91], v[192:195], v[184:187], v[76:91]
  v_mfma_f32_32x32x16_bf16 v[92:107], v[196:199], v[184:187], v[92:107]
  v_mfma_f32_16x16x32_bf16 v[108:111], v[200:203], v[184:187], v[108:111]
  v_mfma_f32_32x32x16_bf16 v[112:127], v[192:195], v[188:191], v[112:127]
  v_mfma_f32_32x32x16_bf16 v[128:143], v[196:199], v[188:191], v[128:143]
  v_mfma_f32_16x16x32_bf16 v[144:147], v[200:203], v[188:191], v[144:147]
  s_add_u32 s11, s8, 4608
  buffer_load_dwordx4 v[172:175], v1, s[44:47], s11 offen sc1
  buffer_load_dwordx4 v[176:179], v1, s[44:47], s11 offen offset:1024 sc1
  buffer_load_dwordx4 v[180:183], v2, s[44:47], s11 offen offset:2048 sc1
  s_add_u32 s11, s8, 6912
  buffer_load_dwordx4 v[184:187], v1, s[44:47], s11 offen sc1
  buffer_load_dwordx4 v[188:191], v1, s[44:47], s11 offen offset:1024 sc1
  buffer_load_dwordx4 v[192:195], v2, s[44:47], s11 offen offset:2048 sc1
  s_waitcnt vmcnt(12)
  v_mfma_f32_32x32x16_bf16 v[76:91], v[220:223], v[212:215], v[76:91]
  v_mfma_f32_32x32x16_bf16 v[92:107], v[224:227], v[212:215], v[92:107]
  v_mfma_f32_16x16x32_bf16 v[108:111], v[228:231], v[212:215], v[108:111]
  v_mfma_f32_32x32x16_bf16 v[112:127], v[220:223], v[216:219], v[112:127]
  v_mfma_f32_32x32x16_bf16 v[128:143], v[224:227], v[216:219], v[128:143]
  v_mfma_f32_16x16x32_bf16 v[144:147], v[228:231], v[216:219], v[144:147]
  v_mov_b32 v244, 161792
gated_mix__softmax_full_mha__geglu_ffn__prompt_kernel_gw1:
  ds_read_b32 v245, v244
  s_waitcnt lgkmcnt(0)
  v_readfirstlane_b32 s63, v245
  s_nop 0
  s_cmp_ge_u32 s63, 4
  s_cbranch_scc1 gated_mix__softmax_full_mha__geglu_ffn__prompt_kernel_gw1d
  s_sleep 8
  s_branch gated_mix__softmax_full_mha__geglu_ffn__prompt_kernel_gw1
gated_mix__softmax_full_mha__geglu_ffn__prompt_kernel_gw1d:
  v_mfma_f32_32x32x16_bf16 v[4:19], v[220:223], v[204:207], v[4:19]
  v_mfma_f32_32x32x16_bf16 v[20:35], v[224:227], v[204:207], v[20:35]
  v_mfma_f32_16x16x32_bf16 v[36:39], v[228:231], v[204:207], v[36:39]
  ds_write_b128 v247, v[76:79] offset:0
  ds_write_b128 v247, v[80:83] offset:1024
  ds_write_b128 v247, v[84:87] offset:2048
  ds_write_b128 v247, v[88:91] offset:3072
  ds_write_b128 v247, v[92:95] offset:4096
  ds_write_b128 v247, v[96:99] offset:5120
  ds_write_b128 v247, v[100:103] offset:6144
  ds_write_b128 v247, v[104:107] offset:7168
  ds_write_b128 v247, v[108:111] offset:8192
  v_mfma_f32_32x32x16_bf16 v[40:55], v[220:223], v[208:211], v[40:55]
  v_mfma_f32_32x32x16_bf16 v[56:71], v[224:227], v[208:211], v[56:71]
  v_mfma_f32_16x16x32_bf16 v[72:75], v[228:231], v[208:211], v[72:75]
  s_setprio 2
  ds_write_b128 v247, v[112:115] offset:9216
  ds_write_b128 v247, v[116:119] offset:10240
  ds_write_b128 v247, v[120:123] offset:11264
  ds_write_b128 v247, v[124:127] offset:12288
  ds_write_b128 v247, v[128:131] offset:13312
  ds_write_b128 v247, v[132:135] offset:14336
  ds_write_b128 v247, v[136:139] offset:15360
  ds_write_b128 v247, v[140:143] offset:16384
  ds_write_b128 v247, v[144:147] offset:17408
  v_mov_b32 v244, 161796
  v_mov_b32 v245, 1
  s_mov_b64 exec, 1
  ds_add_u32 v244, v245
  s_mov_b64 exec, -1
  s_add_u32 s11, s8, 9216
  buffer_load_dwordx4 v[196:199], v1, s[44:47], s11 offen sc1
  buffer_load_dwordx4 v[200:203], v1, s[44:47], s11 offen offset:1024 sc1
  buffer_load_dwordx4 v[204:207], v2, s[44:47], s11 offen offset:2048 sc1
  s_add_u32 s11, s8, 11520
  buffer_load_dwordx4 v[208:211], v1, s[44:47], s11 offen sc1
  buffer_load_dwordx4 v[212:215], v1, s[44:47], s11 offen offset:1024 sc1
  buffer_load_dwordx4 v[216:219], v2, s[44:47], s11 offen offset:2048 sc1
  s_add_u32 s11, s8, 13824
  buffer_load_dwordx4 v[220:223], v1, s[44:47], s11 offen sc1
  buffer_load_dwordx4 v[224:227], v1, s[44:47], s11 offen offset:1024 sc1
  buffer_load_dwordx4 v[228:231], v2, s[44:47], s11 offen offset:2048 sc1
  s_setprio 0
  v_mov_b32 v244, 161816
gated_mix__softmax_full_mha__geglu_ffn__prompt_kernel_gw6:
  ds_read_b32 v245, v244
  s_waitcnt lgkmcnt(0)
  v_readfirstlane_b32 s63, v245
  s_nop 0
  s_cmp_ge_u32 s63, 4
  s_cbranch_scc1 gated_mix__softmax_full_mha__geglu_ffn__prompt_kernel_gw6d
  s_sleep 2
  s_branch gated_mix__softmax_full_mha__geglu_ffn__prompt_kernel_gw6
gated_mix__softmax_full_mha__geglu_ffn__prompt_kernel_gw6d:
  s_setprio 2
  s_add_u32 s64, s15, 0
  buffer_load_dwordx4 v[76:79], v1, s[44:47], s64 offen sc1
  buffer_load_dwordx4 v[80:83], v1, s[44:47], s64 offen offset:1152 sc1
  s_add_u32 s64, s15, 2304
  buffer_load_dwordx4 v[84:87], v1, s[44:47], s64 offen sc1
  buffer_load_dwordx4 v[88:91], v1, s[44:47], s64 offen offset:1152 sc1
  s_add_u32 s64, s15, 4608
  buffer_load_dwordx4 v[92:95], v1, s[44:47], s64 offen sc1
  buffer_load_dwordx4 v[96:99], v1, s[44:47], s64 offen offset:1152 sc1
  s_add_u32 s64, s15, 6912
  buffer_load_dwordx4 v[100:103], v1, s[44:47], s64 offen sc1
  buffer_load_dwordx4 v[104:107], v1, s[44:47], s64 offen offset:1152 sc1
  s_add_u32 s64, s15, 9216
  buffer_load_dwordx4 v[108:111], v1, s[44:47], s64 offen sc1
  buffer_load_dwordx4 v[112:115], v1, s[44:47], s64 offen offset:1152 sc1
  s_add_u32 s64, s15, 11520
  buffer_load_dwordx4 v[116:119], v1, s[44:47], s64 offen sc1
  buffer_load_dwordx4 v[120:123], v1, s[44:47], s64 offen offset:1152 sc1
  s_add_u32 s64, s15, 13824
  buffer_load_dwordx4 v[124:127], v1, s[44:47], s64 offen sc1
  buffer_load_dwordx4 v[128:131], v1, s[44:47], s64 offen offset:1152 sc1
  s_add_u32 s64, s15, 16128
  buffer_load_dwordx4 v[132:135], v1, s[44:47], s64 offen sc1
  buffer_load_dwordx4 v[136:139], v1, s[44:47], s64 offen offset:1152 sc1
  s_add_u32 s64, s15, 0
  buffer_load_dword v140, v250, s[44:47], s64 offen offset:1024 sc1
  buffer_load_dword v144, v250, s[44:47], s64 offen offset:2176 sc1
  s_add_u32 s64, s15, 2304
  buffer_load_dword v141, v250, s[44:47], s64 offen offset:1024 sc1
  buffer_load_dword v145, v250, s[44:47], s64 offen offset:2176 sc1
  s_add_u32 s64, s15, 4608
  buffer_load_dword v142, v250, s[44:47], s64 offen offset:1024 sc1
  buffer_load_dword v146, v250, s[44:47], s64 offen offset:2176 sc1
  s_add_u32 s64, s15, 6912
  buffer_load_dword v143, v250, s[44:47], s64 offen offset:1024 sc1
  buffer_load_dword v147, v250, s[44:47], s64 offen offset:2176 sc1
  v_add_u32 v247, 73728, v247
  s_mov_b32 s14, 0
  s_waitcnt vmcnt(22)
gated_mix__softmax_full_mha__geglu_ffn__prompt_kernel_ock0:
  v_max3_u32 v244, v76, v77, v78
  v_max3_u32 v245, v79, v80, v81
  v_max3_u32 v244, v244, v82, v83
  v_max_u32 v244, v244, v245
  v_cmp_eq_u32 vcc, -1, v244
  s_cbranch_vccnz gated_mix__softmax_full_mha__geglu_ffn__prompt_kernel_ort0
gated_mix__softmax_full_mha__geglu_ffn__prompt_kernel_ogo0:
  v_mfma_f32_32x32x16_bf16 v[4:19], v[148:151], v[76:79], v[4:19]
  v_mfma_f32_32x32x16_bf16 v[20:35], v[152:155], v[76:79], v[20:35]
  v_mfma_f32_16x16x32_bf16 v[36:39], v[156:159], v[76:79], v[36:39]
  v_mfma_f32_32x32x16_bf16 v[40:55], v[148:151], v[80:83], v[40:55]
  v_mfma_f32_32x32x16_bf16 v[56:71], v[152:155], v[80:83], v[56:71]
  v_mfma_f32_16x16x32_bf16 v[72:75], v[156:159], v[80:83], v[72:75]
  s_add_u32 s11, s8, 16128
  buffer_load_dwordx4 v[148:151], v1, s[44:47], s11 offen sc1
  buffer_load_dwordx4 v[152:155], v1, s[44:47], s11 offen offset:1024 sc1
  buffer_load_dwordx4 v[156:159], v2, s[44:47], s11 offen offset:2048 sc1
  s_waitcnt vmcnt(23)
gated_mix__softmax_full_mha__geglu_ffn__prompt_kernel_ock1:
  v_max3_u32 v244, v84, v85, v86
  v_max3_u32 v245, v87, v88, v89
  v_max3_u32 v244, v244, v90, v91
  v_max_u32 v244, v244, v245
  v_cmp_eq_u32 vcc, -1, v244
  s_cbranch_vccnz gated_mix__softmax_full_mha__geglu_ffn__prompt_kernel_ort1
gated_mix__softmax_full_mha__geglu_ffn__prompt_kernel_ogo1:
  v_mfma_f32_32x32x16_bf16 v[4:19], v[160:163], v[84:87], v[4:19]
  v_mfma_f32_32x32x16_bf16 v[20:35], v[164:167], v[84:87], v[20:35]
  v_mfma_f32_16x16x32_bf16 v[36:39], v[168:171], v[84:87], v[36:39]
  v_mfma_f32_32x32x16_bf16 v[40:55], v[160:163], v[88:91], v[40:55]
  v_mfma_f32_32x32x16_bf16 v[56:71], v[164:167], v[88:91], v[56:71]
  v_mfma_f32_16x16x32_bf16 v[72:75], v[168:171], v[88:91], v[72:75]
  s_mov_b32 s11, s12
  buffer_load_dwordx4 v[160:163], v1, s[44:47], s11 offen sc1
  buffer_load_dwordx4 v[164:167], v1, s[44:47], s11 offen offset:1024 sc1
  buffer_load_dwordx4 v[168:171], v2, s[44:47], s11 offen offset:2048 sc1
  s_waitcnt vmcnt(24)
gated_mix__softmax_full_mha__geglu_ffn__prompt_kernel_ock2:
  v_max3_u32 v244, v92, v93, v94
  v_max3_u32 v245, v95, v96, v97
  v_max3_u32 v244, v244, v98, v99
  v_max_u32 v244, v244, v245
  v_cmp_eq_u32 vcc, -1, v244
  s_cbranch_vccnz gated_mix__softmax_full_mha__geglu_ffn__prompt_kernel_ort2
gated_mix__softmax_full_mha__geglu_ffn__prompt_kernel_ogo2:
  v_mfma_f32_32x32x16_bf16 v[4:19], v[172:175], v[92:95], v[4:19]
  v_mfma_f32_32x32x16_bf16 v[20:35], v[176:179], v[92:95], v[20:35]
  v_mfma_f32_16x16x32_bf16 v[36:39], v[180:183], v[92:95], v[36:39]
  v_mfma_f32_32x32x16_bf16 v[40:55], v[172:175], v[96:99], v[40:55]
  v_mfma_f32_32x32x16_bf16 v[56:71], v[176:179], v[96:99], v[56:71]
  v_mfma_f32_16x16x32_bf16 v[72:75], v[180:183], v[96:99], v[72:75]
  s_waitcnt vmcnt(22)
gated_mix__softmax_full_mha__geglu_ffn__prompt_kernel_ock3:
  v_max3_u32 v244, v100, v101, v102
  v_max3_u32 v245, v103, v104, v105
  v_max3_u32 v244, v244, v106, v107
  v_max_u32 v244, v244, v245
  v_cmp_eq_u32 vcc, -1, v244
  s_cbranch_vccnz gated_mix__softmax_full_mha__geglu_ffn__prompt_kernel_ort3
gated_mix__softmax_full_mha__geglu_ffn__prompt_kernel_ogo3:
  v_mfma_f32_32x32x16_bf16 v[4:19], v[184:187], v[100:103], v[4:19]
  v_mfma_f32_32x32x16_bf16 v[20:35], v[188:191], v[100:103], v[20:35]
  v_mfma_f32_16x16x32_bf16 v[36:39], v[192:195], v[100:103], v[36:39]
  v_mfma_f32_32x32x16_bf16 v[40:55], v[184:187], v[104:107], v[40:55]
  v_mfma_f32_32x32x16_bf16 v[56:71], v[188:191], v[104:107], v[56:71]
  v_mfma_f32_16x16x32_bf16 v[72:75], v[192:195], v[104:107], v[72:75]
  s_waitcnt vmcnt(20)
gated_mix__softmax_full_mha__geglu_ffn__prompt_kernel_ock4:
  v_max3_u32 v244, v108, v109, v110
  v_max3_u32 v245, v111, v112, v113
  v_max3_u32 v244, v244, v114, v115
  v_max_u32 v244, v244, v245
  v_cmp_eq_u32 vcc, -1, v244
  s_cbranch_vccnz gated_mix__softmax_full_mha__geglu_ffn__prompt_kernel_ort4
gated_mix__softmax_full_mha__geglu_ffn__prompt_kernel_ogo4:
  v_mfma_f32_32x32x16_bf16 v[4:19], v[196:199], v[108:111], v[4:19]
  v_mfma_f32_32x32x16_bf16 v[20:35], v[200:203], v[108:111], v[20:35]
  v_mfma_f32_16x16x32_bf16 v[36:39], v[204:207], v[108:111], v[36:39]
  v_mfma_f32_32x32x16_bf16 v[40:55], v[196:199], v[112:115], v[40:55]
  v_mfma_f32_32x32x16_bf16 v[56:71], v[200:203], v[112:115], v[56:71]
  v_mfma_f32_16x16x32_bf16 v[72:75], v[204:207], v[112:115], v[72:75]
  s_waitcnt vmcnt(18)
gated_mix__softmax_full_mha__geglu_ffn__prompt_kernel_ock5:
  v_max3_u32 v244, v116, v117, v118
  v_max3_u32 v245, v119, v120, v121
  v_max3_u32 v244, v244, v122, v123
  v_max_u32 v244, v244, v245
  v_cmp_eq_u32 vcc, -1, v244
  s_cbranch_vccnz gated_mix__softmax_full_mha__geglu_ffn__prompt_kernel_ort5
gated_mix__softmax_full_mha__geglu_ffn__prompt_kernel_ogo5:
  v_mfma_f32_32x32x16_bf16 v[4:19], v[208:211], v[116:119], v[4:19]
  v_mfma_f32_32x32x16_bf16 v[20:35], v[212:215], v[116:119], v[20:35]
  v_mfma_f32_16x16x32_bf16 v[36:39], v[216:219], v[116:119], v[36:39]
  v_mfma_f32_32x32x16_bf16 v[40:55], v[208:211], v[120:123], v[40:55]
  v_mfma_f32_32x32x16_bf16 v[56:71], v[212:215], v[120:123], v[56:71]
  v_mfma_f32_16x16x32_bf16 v[72:75], v[216:219], v[120:123], v[72:75]
  s_waitcnt vmcnt(16)
gated_mix__softmax_full_mha__geglu_ffn__prompt_kernel_ock6:
  v_max3_u32 v244, v124, v125, v126
  v_max3_u32 v245, v127, v128, v129
  v_max3_u32 v244, v244, v130, v131
  v_max_u32 v244, v244, v245
  v_cmp_eq_u32 vcc, -1, v244
  s_cbranch_vccnz gated_mix__softmax_full_mha__geglu_ffn__prompt_kernel_ort6
gated_mix__softmax_full_mha__geglu_ffn__prompt_kernel_ogo6:
  v_mfma_f32_32x32x16_bf16 v[4:19], v[220:223], v[124:127], v[4:19]
  v_mfma_f32_32x32x16_bf16 v[20:35], v[224:227], v[124:127], v[20:35]
  v_mfma_f32_16x16x32_bf16 v[36:39], v[228:231], v[124:127], v[36:39]
  v_mfma_f32_32x32x16_bf16 v[40:55], v[220:223], v[128:131], v[40:55]
  v_mfma_f32_32x32x16_bf16 v[56:71], v[224:227], v[128:131], v[56:71]
  v_mfma_f32_16x16x32_bf16 v[72:75], v[228:231], v[128:131], v[72:75]
  buffer_load_dword v253, v246, s[44:47], s18 offen sc1
  s_waitcnt vmcnt(4)
gated_mix__softmax_full_mha__geglu_ffn__prompt_kernel_ock7:
  v_max3_u32 v244, v132, v133, v134
  v_max3_u32 v245, v135, v136, v137
  v_max3_u32 v244, v244, v138, v139
  v_max_u32 v244, v244, v245
  v_cmp_eq_u32 vcc, -1, v244
  s_cbranch_vccnz gated_mix__softmax_full_mha__geglu_ffn__prompt_kernel_ort7
gated_mix__softmax_full_mha__geglu_ffn__prompt_kernel_ogo7:
  v_mfma_f32_32x32x16_bf16 v[4:19], v[148:151], v[132:135], v[4:19]
  v_mfma_f32_32x32x16_bf16 v[20:35], v[152:155], v[132:135], v[20:35]
  v_mfma_f32_16x16x32_bf16 v[36:39], v[156:159], v[132:135], v[36:39]
  v_mfma_f32_32x32x16_bf16 v[40:55], v[148:151], v[136:139], v[40:55]
  v_mfma_f32_32x32x16_bf16 v[56:71], v[152:155], v[136:139], v[56:71]
  v_mfma_f32_16x16x32_bf16 v[72:75], v[156:159], v[136:139], v[72:75]
  s_waitcnt vmcnt(1)
gated_mix__softmax_full_mha__geglu_ffn__prompt_kernel_ock8:
  v_max3_u32 v244, v140, v141, v142
  v_max3_u32 v245, v143, v144, v145
  v_max3_u32 v244, v244, v146, v147
  v_max_u32 v244, v244, v245
  v_cmp_eq_u32 vcc, -1, v244
  s_cbranch_vccnz gated_mix__softmax_full_mha__geglu_ffn__prompt_kernel_ort8
gated_mix__softmax_full_mha__geglu_ffn__prompt_kernel_ogo8:
  v_mfma_f32_32x32x16_bf16 v[4:19], v[160:163], v[140:143], v[4:19]
  v_mfma_f32_32x32x16_bf16 v[20:35], v[164:167], v[140:143], v[20:35]
  v_mfma_f32_16x16x32_bf16 v[36:39], v[168:171], v[140:143], v[36:39]
  v_mfma_f32_32x32x16_bf16 v[40:55], v[160:163], v[144:147], v[40:55]
  v_mfma_f32_32x32x16_bf16 v[56:71], v[164:167], v[144:147], v[56:71]
  v_mfma_f32_16x16x32_bf16 v[72:75], v[168:171], v[144:147], v[72:75]
  s_nop 6
  ds_write_b128 v247, v[4:7] offset:0
  ds_write_b128 v247, v[8:11] offset:1024
  ds_write_b128 v247, v[12:15] offset:2048
  ds_write_b128 v247, v[16:19] offset:3072
  ds_write_b128 v247, v[20:23] offset:4096
  ds_write_b128 v247, v[24:27] offset:5120
  ds_write_b128 v247, v[28:31] offset:6144
  ds_write_b128 v247, v[32:35] offset:7168
  ds_write_b128 v247, v[36:39] offset:8192
  ds_write_b128 v247, v[40:43] offset:9216
  ds_write_b128 v247, v[44:47] offset:10240
  ds_write_b128 v247, v[48:51] offset:11264
  ds_write_b128 v247, v[52:55] offset:12288
  ds_write_b128 v247, v[56:59] offset:13312
  ds_write_b128 v247, v[60:63] offset:14336
  ds_write_b128 v247, v[64:67] offset:15360
  ds_write_b128 v247, v[68:71] offset:16384
  ds_write_b128 v247, v[72:75] offset:17408
  v_mov_b32 v244, 161812
  v_mov_b32 v245, 1
  s_mov_b64 exec, 1
  ds_add_u32 v244, v245
  s_mov_b64 exec, -1
  s_waitcnt vmcnt(0)
  v_cmp_ne_u32 vcc, s0, v253
  s_cbranch_vccz gated_mix__softmax_full_mha__geglu_ffn__prompt_kernel_ppok
  s_mov_b32 s14, 0
gated_mix__softmax_full_mha__geglu_ffn__prompt_kernel_pp:
  buffer_load_dword v253, v246, s[44:47], s18 offen offset:0 sc1
  s_add_u32 s14, s14, 1
  s_waitcnt vmcnt(0)
  v_cmp_ne_u32 vcc, s0, v253
  s_and_b32 vcc_lo, vcc_lo, 1
  s_cbranch_scc0 gated_mix__softmax_full_mha__geglu_ffn__prompt_kernel_ppd
  s_cmp_ge_u32 s14, 0x8000
  s_cbranch_scc1 gated_mix__softmax_full_mha__geglu_ffn__prompt_kernel_ppd
  s_sleep 1
  s_branch gated_mix__softmax_full_mha__geglu_ffn__prompt_kernel_pp
gated_mix__softmax_full_mha__geglu_ffn__prompt_kernel_ppd:
gated_mix__softmax_full_mha__geglu_ffn__prompt_kernel_ppok:
  buffer_load_dwordx4 v[172:175], v1, s[44:47], s4 offen offset:0 sc1
  buffer_load_dwordx4 v[176:179], v1, s[44:47], s4 offen offset:1024 sc1
  buffer_load_dwordx4 v[180:183], v1, s[44:47], s4 offen offset:2048 sc1
  buffer_load_dwordx4 v[184:187], v1, s[44:47], s4 offen offset:3072 sc1
  s_add_u32 s64, s4, 4096
  buffer_load_dwordx4 v[188:191], v1, s[44:47], s64 offen sc1
  v_mov_b32 v244, 161812
gated_mix__softmax_full_mha__geglu_ffn__prompt_kernel_gw5:
  ds_read_b32 v245, v244
  s_waitcnt lgkmcnt(0)
  v_readfirstlane_b32 s63, v245
  s_nop 0
  s_cmp_ge_u32 s63, 4
  s_cbranch_scc1 gated_mix__softmax_full_mha__geglu_ffn__prompt_kernel_gw5d
  s_sleep 0
  s_branch gated_mix__softmax_full_mha__geglu_ffn__prompt_kernel_gw5
gated_mix__softmax_full_mha__geglu_ffn__prompt_kernel_gw5d:
  ds_read_b128 v[4:7], v249 offset:0
  ds_read_b128 v[8:11], v249 offset:1024
  ds_read_b128 v[12:15], v249 offset:2048
  ds_read_b128 v[16:19], v249 offset:3072
  ds_read_b128 v[20:23], v248 offset:8192
  ds_read_b128 v[24:27], v249 offset:18432
  ds_read_b128 v[28:31], v249 offset:19456
  ds_read_b128 v[32:35], v249 offset:20480
  ds_read_b128 v[36:39], v249 offset:21504
  ds_read_b128 v[40:43], v248 offset:26624
  ds_read_b128 v[44:47], v249 offset:36864
  ds_read_b128 v[48:51], v249 offset:37888
  ds_read_b128 v[52:55], v249 offset:38912
  ds_read_b128 v[56:59], v249 offset:39936
  ds_read_b128 v[60:63], v248 offset:45056
  s_waitcnt lgkmcnt(5)
  v_add_f32 v4, v4, v24
  v_add_f32 v5, v5, v25
  v_add_f32 v6, v6, v26
  v_add_f32 v7, v7, v27
  v_add_f32 v8, v8, v28
  v_add_f32 v9, v9, v29
  v_add_f32 v10, v10, v30
  v_add_f32 v11, v11, v31
  v_add_f32 v12, v12, v32
  v_add_f32 v13, v13, v33
  v_add_f32 v14, v14, v34
  v_add_f32 v15, v15, v35
  v_add_f32 v16, v16, v36
  v_add_f32 v17, v17, v37
  v_add_f32 v18, v18, v38
  v_add_f32 v19, v19, v39
  v_add_f32 v20, v20, v40
  v_add_f32 v21, v21, v41
  v_add_f32 v22, v22, v42
  v_add_f32 v23, v23, v43
  ds_read_b128 v[24:27], v249 offset:55296
  ds_read_b128 v[28:31], v249 offset:56320
  ds_read_b128 v[32:35], v249 offset:57344
  ds_read_b128 v[36:39], v249 offset:58368
  ds_read_b128 v[40:43], v248 offset:63488
  s_waitcnt lgkmcnt(5)
  v_add_f32 v4, v4, v44
  v_add_f32 v5, v5, v45
  v_add_f32 v6, v6, v46
  v_add_f32 v7, v7, v47
  v_add_f32 v8, v8, v48
  v_add_f32 v9, v9, v49
  v_add_f32 v10, v10, v50
  v_add_f32 v11, v11, v51
  v_add_f32 v12, v12, v52
  v_add_f32 v13, v13, v53
  v_add_f32 v14, v14, v54
  v_add_f32 v15, v15, v55
  v_add_f32 v16, v16, v56
  v_add_f32 v17, v17, v57
  v_add_f32 v18, v18, v58
  v_add_f32 v19, v19, v59
  v_add_f32 v20, v20, v60
  v_add_f32 v21, v21, v61
  v_add_f32 v22, v22, v62
  v_add_f32 v23, v23, v63
  s_waitcnt lgkmcnt(0)
  v_add_f32 v4, v4, v24
  v_add_f32 v5, v5, v25
  v_add_f32 v6, v6, v26
  v_add_f32 v7, v7, v27
  v_add_f32 v8, v8, v28
  v_add_f32 v9, v9, v29
  v_add_f32 v10, v10, v30
  v_add_f32 v11, v11, v31
  v_add_f32 v12, v12, v32
  v_add_f32 v13, v13, v33
  v_add_f32 v14, v14, v34
  v_add_f32 v15, v15, v35
  v_add_f32 v16, v16, v36
  v_add_f32 v17, v17, v37
  v_add_f32 v18, v18, v38
  v_add_f32 v19, v19, v39
  v_add_f32 v20, v20, v40
  v_add_f32 v21, v21, v41
  v_add_f32 v22, v22, v42
  v_add_f32 v23, v23, v43
  s_waitcnt vmcnt(0)
  v_add_f32 v4, v4, v172
  v_add_f32 v5, v5, v173
  v_add_f32 v6, v6, v174
  v_add_f32 v7, v7, v175
  v_add_f32 v8, v8, v176
  v_add_f32 v9, v9, v177
  v_add_f32 v10, v10, v178
  v_add_f32 v11, v11, v179
  v_add_f32 v12, v12, v180
  v_add_f32 v13, v13, v181
  v_add_f32 v14, v14, v182
  v_add_f32 v15, v15, v183
  v_add_f32 v16, v16, v184
  v_add_f32 v17, v17, v185
  v_add_f32 v18, v18, v186
  v_add_f32 v19, v19, v187
  v_add_f32 v20, v20, v188
  v_add_f32 v21, v21, v189
  v_add_f32 v22, v22, v190
  v_add_f32 v23, v23, v191
  v_mul_f32 v4, v4, v240
  v_mul_f32 v5, v5, v240
  v_mul_f32 v6, v6, v240
  v_mul_f32 v7, v7, v240
  v_mul_f32 v8, v8, v240
  v_mul_f32 v9, v9, v240
  v_mul_f32 v10, v10, v240
  v_mul_f32 v11, v11, v240
  v_mul_f32 v12, v12, v240
  v_mul_f32 v13, v13, v240
  v_mul_f32 v14, v14, v240
  v_mul_f32 v15, v15, v240
  v_mul_f32 v16, v16, v240
  v_mul_f32 v17, v17, v240
  v_mul_f32 v18, v18, v240
  v_mul_f32 v19, v19, v240
  v_mul_f32 v20, v20, v241
  v_mul_f32 v21, v21, v241
  v_mul_f32 v22, v22, v241
  v_mul_f32 v23, v23, v241
  v_cvt_pk_bf16_f32 v88, v4, v5
  v_cvt_pk_bf16_f32 v89, v6, v7
  v_cvt_pk_bf16_f32 v90, v8, v9
  v_cvt_pk_bf16_f32 v91, v10, v11
  v_cvt_pk_bf16_f32 v92, v12, v13
  v_cvt_pk_bf16_f32 v93, v14, v15
  v_cvt_pk_bf16_f32 v94, v16, v17
  v_cvt_pk_bf16_f32 v95, v18, v19
  v_cvt_pk_bf16_f32 v96, v20, v21
  v_cvt_pk_bf16_f32 v97, v22, v23
  buffer_store_dwordx4 v[88:91], v251, s[40:43], s17 offen
  buffer_store_dwordx4 v[92:95], v251, s[40:43], s17 offen offset:16
  s_bitcmp1_b32 s7, 0
  s_cbranch_scc1 gated_mix__softmax_full_mha__geglu_ffn__prompt_kernel_fin2
  buffer_store_dwordx2 v[96:97], v252, s[40:43], s16 offen offset:128
gated_mix__softmax_full_mha__geglu_ffn__prompt_kernel_fin2:
  s_endpgm
gated_mix__softmax_full_mha__geglu_ffn__prompt_kernel_ort0:
  s_setprio 0
  s_sleep 4
  buffer_load_dword v244, v254, s[44:47], s15 offen offset:2176 sc1
  s_mov_b32 s13, 0
  s_add_u32 s14, s14, 1
  s_cmp_ge_u32 s14, 0x8000
  s_cbranch_scc1 gated_mix__softmax_full_mha__geglu_ffn__prompt_kernel_ogo0
  s_waitcnt vmcnt(0)
  v_cmp_eq_u32 vcc, -1, v244
  s_and_b32 vcc_lo, vcc_lo, 1
  s_cbranch_scc1 gated_mix__softmax_full_mha__geglu_ffn__prompt_kernel_ort0
  s_branch gated_mix__softmax_full_mha__geglu_ffn__prompt_kernel_orl0
gated_mix__softmax_full_mha__geglu_ffn__prompt_kernel_ort1:
  s_setprio 0
  s_sleep 4
  buffer_load_dword v244, v254, s[44:47], s15 offen offset:2176 sc1
  s_mov_b32 s13, 1
  s_add_u32 s14, s14, 1
  s_cmp_ge_u32 s14, 0x8000
  s_cbranch_scc1 gated_mix__softmax_full_mha__geglu_ffn__prompt_kernel_ogo1
  s_waitcnt vmcnt(0)
  v_cmp_eq_u32 vcc, -1, v244
  s_and_b32 vcc_lo, vcc_lo, 2
  s_cbranch_scc1 gated_mix__softmax_full_mha__geglu_ffn__prompt_kernel_ort1
  s_branch gated_mix__softmax_full_mha__geglu_ffn__prompt_kernel_orl1
gated_mix__softmax_full_mha__geglu_ffn__prompt_kernel_ort2:
  s_setprio 0
  s_sleep 4
  buffer_load_dword v244, v254, s[44:47], s15 offen offset:2176 sc1
  s_mov_b32 s13, 2
  s_add_u32 s14, s14, 1
  s_cmp_ge_u32 s14, 0x8000
  s_cbranch_scc1 gated_mix__softmax_full_mha__geglu_ffn__prompt_kernel_ogo2
  s_waitcnt vmcnt(0)
  v_cmp_eq_u32 vcc, -1, v244
  s_and_b32 vcc_lo, vcc_lo, 4
  s_cbranch_scc1 gated_mix__softmax_full_mha__geglu_ffn__prompt_kernel_ort2
  s_branch gated_mix__softmax_full_mha__geglu_ffn__prompt_kernel_orl2
gated_mix__softmax_full_mha__geglu_ffn__prompt_kernel_ort3:
  s_setprio 0
  s_sleep 4
  buffer_load_dword v244, v254, s[44:47], s15 offen offset:2176 sc1
  s_mov_b32 s13, 3
  s_add_u32 s14, s14, 1
  s_cmp_ge_u32 s14, 0x8000
  s_cbranch_scc1 gated_mix__softmax_full_mha__geglu_ffn__prompt_kernel_ogo3
  s_waitcnt vmcnt(0)
  v_cmp_eq_u32 vcc, -1, v244
  s_and_b32 vcc_lo, vcc_lo, 8
  s_cbranch_scc1 gated_mix__softmax_full_mha__geglu_ffn__prompt_kernel_ort3
  s_branch gated_mix__softmax_full_mha__geglu_ffn__prompt_kernel_orl3
gated_mix__softmax_full_mha__geglu_ffn__prompt_kernel_ort4:
  s_setprio 0
  s_sleep 4
  buffer_load_dword v244, v254, s[44:47], s15 offen offset:2176 sc1
  s_mov_b32 s13, 4
  s_add_u32 s14, s14, 1
  s_cmp_ge_u32 s14, 0x8000
  s_cbranch_scc1 gated_mix__softmax_full_mha__geglu_ffn__prompt_kernel_ogo4
  s_waitcnt vmcnt(0)
  v_cmp_eq_u32 vcc, -1, v244
  s_and_b32 vcc_lo, vcc_lo, 16
  s_cbranch_scc1 gated_mix__softmax_full_mha__geglu_ffn__prompt_kernel_ort4
  s_branch gated_mix__softmax_full_mha__geglu_ffn__prompt_kernel_orl4
gated_mix__softmax_full_mha__geglu_ffn__prompt_kernel_ort5:
  s_setprio 0
  s_sleep 4
  buffer_load_dword v244, v254, s[44:47], s15 offen offset:2176 sc1
  s_mov_b32 s13, 5
  s_add_u32 s14, s14, 1
  s_cmp_ge_u32 s14, 0x8000
  s_cbranch_scc1 gated_mix__softmax_full_mha__geglu_ffn__prompt_kernel_ogo5
  s_waitcnt vmcnt(0)
  v_cmp_eq_u32 vcc, -1, v244
  s_and_b32 vcc_lo, vcc_lo, 32
  s_cbranch_scc1 gated_mix__softmax_full_mha__geglu_ffn__prompt_kernel_ort5
  s_branch gated_mix__softmax_full_mha__geglu_ffn__prompt_kernel_orl5
gated_mix__softmax_full_mha__geglu_ffn__prompt_kernel_ort6:
  s_setprio 0
  s_sleep 4
  buffer_load_dword v244, v254, s[44:47], s15 offen offset:2176 sc1
  s_mov_b32 s13, 6
  s_add_u32 s14, s14, 1
  s_cmp_ge_u32 s14, 0x8000
  s_cbranch_scc1 gated_mix__softmax_full_mha__geglu_ffn__prompt_kernel_ogo6
  s_waitcnt vmcnt(0)
  v_cmp_eq_u32 vcc, -1, v244
  s_and_b32 vcc_lo, vcc_lo, 64
  s_cbranch_scc1 gated_mix__softmax_full_mha__geglu_ffn__prompt_kernel_ort6
  s_branch gated_mix__softmax_full_mha__geglu_ffn__prompt_kernel_orl6
gated_mix__softmax_full_mha__geglu_ffn__prompt_kernel_ort7:
  s_setprio 0
  s_sleep 4
  buffer_load_dword v244, v254, s[44:47], s15 offen offset:2176 sc1
  s_mov_b32 s13, 7
  s_add_u32 s14, s14, 1
  s_cmp_ge_u32 s14, 0x8000
  s_cbranch_scc1 gated_mix__softmax_full_mha__geglu_ffn__prompt_kernel_ogo7
  s_waitcnt vmcnt(0)
  v_cmp_eq_u32 vcc, -1, v244
  s_and_b32 vcc_lo, vcc_lo, 128
  s_cbranch_scc1 gated_mix__softmax_full_mha__geglu_ffn__prompt_kernel_ort7
  s_branch gated_mix__softmax_full_mha__geglu_ffn__prompt_kernel_orl7
gated_mix__softmax_full_mha__geglu_ffn__prompt_kernel_ort8:
  s_setprio 0
  s_sleep 4
  buffer_load_dword v244, v254, s[44:47], s15 offen offset:2176 sc1
  s_mov_b32 s13, 8
  s_add_u32 s14, s14, 1
  s_cmp_ge_u32 s14, 0x8000
  s_cbranch_scc1 gated_mix__softmax_full_mha__geglu_ffn__prompt_kernel_ogo8
  s_waitcnt vmcnt(0)
  v_cmp_eq_u32 vcc, -1, v244
  s_and_b32 vcc_lo, vcc_lo, 255
  s_cbranch_scc1 gated_mix__softmax_full_mha__geglu_ffn__prompt_kernel_ort8
  s_branch gated_mix__softmax_full_mha__geglu_ffn__prompt_kernel_orl8
gated_mix__softmax_full_mha__geglu_ffn__prompt_kernel_orl0:
  s_add_u32 s64, s15, 0
  buffer_load_dwordx4 v[76:79], v1, s[44:47], s64 offen sc1
  buffer_load_dwordx4 v[80:83], v1, s[44:47], s64 offen offset:1152 sc1
gated_mix__softmax_full_mha__geglu_ffn__prompt_kernel_orl1:
  s_add_u32 s64, s15, 2304
  buffer_load_dwordx4 v[84:87], v1, s[44:47], s64 offen sc1
  buffer_load_dwordx4 v[88:91], v1, s[44:47], s64 offen offset:1152 sc1
gated_mix__softmax_full_mha__geglu_ffn__prompt_kernel_orl2:
  s_add_u32 s64, s15, 4608
  buffer_load_dwordx4 v[92:95], v1, s[44:47], s64 offen sc1
  buffer_load_dwordx4 v[96:99], v1, s[44:47], s64 offen offset:1152 sc1
gated_mix__softmax_full_mha__geglu_ffn__prompt_kernel_orl3:
  s_add_u32 s64, s15, 6912
  buffer_load_dwordx4 v[100:103], v1, s[44:47], s64 offen sc1
  buffer_load_dwordx4 v[104:107], v1, s[44:47], s64 offen offset:1152 sc1
gated_mix__softmax_full_mha__geglu_ffn__prompt_kernel_orl4:
  s_add_u32 s64, s15, 9216
  buffer_load_dwordx4 v[108:111], v1, s[44:47], s64 offen sc1
  buffer_load_dwordx4 v[112:115], v1, s[44:47], s64 offen offset:1152 sc1
gated_mix__softmax_full_mha__geglu_ffn__prompt_kernel_orl5:
  s_add_u32 s64, s15, 11520
  buffer_load_dwordx4 v[116:119], v1, s[44:47], s64 offen sc1
  buffer_load_dwordx4 v[120:123], v1, s[44:47], s64 offen offset:1152 sc1
gated_mix__softmax_full_mha__geglu_ffn__prompt_kernel_orl6:
  s_add_u32 s64, s15, 13824
  buffer_load_dwordx4 v[124:127], v1, s[44:47], s64 offen sc1
  buffer_load_dwordx4 v[128:131], v1, s[44:47], s64 offen offset:1152 sc1
gated_mix__softmax_full_mha__geglu_ffn__prompt_kernel_orl7:
  s_add_u32 s64, s15, 16128
  buffer_load_dwordx4 v[132:135], v1, s[44:47], s64 offen sc1
  buffer_load_dwordx4 v[136:139], v1, s[44:47], s64 offen offset:1152 sc1
gated_mix__softmax_full_mha__geglu_ffn__prompt_kernel_orl8:
  s_add_u32 s64, s15, 0
  buffer_load_dword v140, v250, s[44:47], s64 offen offset:1024 sc1
  buffer_load_dword v144, v250, s[44:47], s64 offen offset:2176 sc1
  s_add_u32 s64, s15, 2304
  buffer_load_dword v141, v250, s[44:47], s64 offen offset:1024 sc1
  buffer_load_dword v145, v250, s[44:47], s64 offen offset:2176 sc1
  s_add_u32 s64, s15, 4608
  buffer_load_dword v142, v250, s[44:47], s64 offen offset:1024 sc1
  buffer_load_dword v146, v250, s[44:47], s64 offen offset:2176 sc1
  s_add_u32 s64, s15, 6912
  buffer_load_dword v143, v250, s[44:47], s64 offen offset:1024 sc1
  buffer_load_dword v147, v250, s[44:47], s64 offen offset:2176 sc1
gated_mix__softmax_full_mha__geglu_ffn__prompt_kernel_orlend:
  s_setprio 2
  s_waitcnt vmcnt(0)
  s_cmp_eq_u32 s13, 0
  s_cbranch_scc1 gated_mix__softmax_full_mha__geglu_ffn__prompt_kernel_ock0
  s_cmp_eq_u32 s13, 1
  s_cbranch_scc1 gated_mix__softmax_full_mha__geglu_ffn__prompt_kernel_ock1
  s_cmp_eq_u32 s13, 2
  s_cbranch_scc1 gated_mix__softmax_full_mha__geglu_ffn__prompt_kernel_ock2
  s_cmp_eq_u32 s13, 3
  s_cbranch_scc1 gated_mix__softmax_full_mha__geglu_ffn__prompt_kernel_ock3
  s_cmp_eq_u32 s13, 4
  s_cbranch_scc1 gated_mix__softmax_full_mha__geglu_ffn__prompt_kernel_ock4
  s_cmp_eq_u32 s13, 5
  s_cbranch_scc1 gated_mix__softmax_full_mha__geglu_ffn__prompt_kernel_ock5
  s_cmp_eq_u32 s13, 6
  s_cbranch_scc1 gated_mix__softmax_full_mha__geglu_ffn__prompt_kernel_ock6
  s_cmp_eq_u32 s13, 7
  s_cbranch_scc1 gated_mix__softmax_full_mha__geglu_ffn__prompt_kernel_ock7
  s_branch gated_mix__softmax_full_mha__geglu_ffn__prompt_kernel_ock8
gated_mix__softmax_full_mha__geglu_ffn__prompt_kernel_end:
  s_endpgm

all_code_end:
  s_endpgm
.section .rodata,"a"
.p2align 6
.amdhsa_kernel gated_mix__softmax_full_mha__geglu_ffn__prompt_kernel
  .amdhsa_next_free_vgpr 256
  .amdhsa_next_free_sgpr 102
  .amdhsa_accum_offset 256
  .amdhsa_group_segment_fixed_size 0
  .amdhsa_kernarg_size 88
  .amdhsa_user_sgpr_count 2
  .amdhsa_user_sgpr_kernarg_segment_ptr 1
  .amdhsa_system_sgpr_workgroup_id_x 1
.end_amdhsa_kernel
```
